```python
import torch

def _softmax(x, axis=-1):
    return torch.softmax(x, dim=axis)
def _gelu(x):
    return torch.nn.functional.gelu(x, approximate="tanh")
def _silu(x):
    return torch.nn.functional.silu(x)
def _sigmoid(x):
    return torch.sigmoid(x)
def _layernorm(x, axis=-1, eps=1e-5):
    m = x.mean(dim=axis, keepdim=True)
    v = x.var(dim=axis, keepdim=True, unbiased=False)
    return (x - m) / torch.sqrt(v + eps)
def _scatter_add(tgt, idx, src, axis=0):
    return tgt.clone().index_add_(axis, idx, src)
def _segment_sum(src, seg, n):
    out = torch.zeros((n,) + src.shape[1:], dtype=src.dtype)
    return out.index_add_(0, seg, src)
def _pad(x, pw):
    flat = tuple(v for pair in reversed(pw) for v in pair)
    return torch.nn.functional.pad(x, flat)

kernel_name = 'sequential_preLN__spectral_fnet__dense_activation_squared_relu__prompt'

def setup_inputs():

    _w = (lambda a: (lambda t: t.to(torch.bfloat16) if t.is_floating_point() else t)(torch.as_tensor(a)))
    def _A_setup():
        B, S, D = 1, 2048, 1024
        ns = torch.arange(S)[:, None] * torch.arange(S)[None, :]
        nd = torch.arange(D)[:, None] * torch.arange(D)[None, :]
        Ws_re = torch.cos(-2.0 * torch.pi * ns / S).to(float)
        Ws_im = torch.sin(-2.0 * torch.pi * ns / S).to(float)
        Wd_re = torch.cos(-2.0 * torch.pi * nd / D).to(float)
        Wd_im = torch.sin(-2.0 * torch.pi * nd / D).to(float)
        return {
            "x": _w((lambda *s: torch.randn(*s, dtype=torch.bfloat16) * 0.05)(B, S, D)),
            "dft_seq_re": _w(Ws_re),
            "dft_seq_im": _w(Ws_im),
            "dft_hid_re": _w(Wd_re),
            "dft_hid_im": _w(Wd_im),
        }
    _A_in = _A_setup()

    def _B_setup():
        B, S, D, F = 1, 2048, 1024, 3584
        return {
            "x": _w((lambda *s: torch.randn(*s, dtype=torch.bfloat16) * 0.05)(B, S, D)),
            "w1": _w((lambda *s: torch.randn(*s, dtype=torch.bfloat16) * 0.2)(D, F)),
            "b1": _w((lambda *s: torch.randn(*s, dtype=torch.bfloat16) * 0.2)(F)),
            "w2": _w((lambda *s: torch.randn(*s, dtype=torch.bfloat16) * 0.2)(F, D)),
            "b2": _w((lambda *s: torch.randn(*s, dtype=torch.bfloat16) * 0.2)(D)),
        }
    _B_in = _B_setup()

    return {
        "A_x": _A_in["x"],
        "A_dft_seq_re": _A_in["dft_seq_re"],
        "A_dft_seq_im": _A_in["dft_seq_im"],
        "A_dft_hid_re": _A_in["dft_hid_re"],
        "A_dft_hid_im": _A_in["dft_hid_im"],
        "B_x": _B_in["x"],
        "B_w1": _B_in["w1"],
        "B_b1": _B_in["b1"],
        "B_w2": _B_in["w2"],
        "B_b2": _B_in["b2"],
    }

def reference(A_x, A_dft_seq_re, A_dft_seq_im, A_dft_hid_re, A_dft_hid_im, B_x, B_w1, B_b1, B_w2, B_b2):
    def _A_ref(x, dft_seq_re, dft_seq_im, dft_hid_re, dft_hid_im):
        a = torch.einsum("bsd,ed->bse", x, dft_hid_re)
        b = torch.einsum("bsd,ed->bse", x, dft_hid_im)
        y = torch.einsum("ts,bse->bte", dft_seq_re, a) - torch.einsum("ts,bse->bte", dft_seq_im, b)
        return y

    def _B_ref(x, w1, b1, w2, b2):
        h = torch.einsum("bsd,df->bsf", x, w1) + b1
        zero = torch.zeros_like(h)
        r = torch.where(h > zero, h, zero)
        h = r * r
        out = torch.einsum("bsf,fd->bsd", h, w2) + b2
        return out

    x = A_x
    h = x + _A_ref(_layernorm(x, axis=-1), A_dft_seq_re, A_dft_seq_im, A_dft_hid_re, A_dft_hid_im)
    h2 = h + _B_ref(_layernorm(h, axis=-1), B_w1, B_b1, B_w2, B_b2)
    return h2
```

```asm
; @launch grid=(256,1,1) block=(256,1,1) lds=153152
.amdgcn_target "amdgcn-amd-amdhsa--gfx950"
.text
.globl sequential_preLN__spectral_fnet__dense_activation_squared_relu__prompt_kernel
.p2align 8
.type sequential_preLN__spectral_fnet__dense_activation_squared_relu__prompt_kernel,@function
sequential_preLN__spectral_fnet__dense_activation_squared_relu__prompt_kernel:
  s_cmp_ge_u32 s2, 256
  s_cbranch_scc1 sequential_preLN__spectral_fnet__dense_activation_squared_relu__prompt_kernel_end
  s_load_dwordx2 s[86:87], s[0:1], 0
  s_load_dwordx8 s[88:95], s[0:1], 48
  s_load_dwordx4 s[96:99], s[0:1], 80
  s_load_dwordx2 s[100:101], s[0:1], 96
  s_memrealtime s[42:43]
  v_lshrrev_b32 v164, 6, v0
  v_and_b32 v248, 63, v0
  v_and_b32 v249, 15, v0
  v_readfirstlane_b32 s36, v164
  s_and_b32 s3, s2, 7
  s_lshl_b32 s3, s3, 4
  s_lshr_b32 s50, s2, 4
  s_add_u32 s50, s50, s3
  s_bfe_u32 s46, s2, 0x10003
  v_lshrrev_b32 v164, 3, v248
  v_and_b32 v165, 6, v164
  v_and_b32 v166, 7, v248
  v_xor_b32 v165, v165, v166
  v_lshlrev_b32 v164, 18, v164
  v_lshl_add_u32 v164, v165, 4, v164
  s_lshl_b32 s52, s50, 11
  s_lshl_b32 s53, s36, 9
  s_add_u32 s52, s52, s53
  s_add_u32 s54, s52, 2097152
  s_lshl_b32 s55, s36, 13
  s_add_u32 s55, s55, 101376
  s_getpc_b64 s[48:49]
  s_lshr_b32 s3, s2, 3
  s_mul_i32 s3, s3, 2048
  v_lshlrev_b32 v242, 7, v0
  v_add_u32 v242, s3, v242
  v_min_u32 v242, sequential_preLN__spectral_fnet__dense_activation_squared_relu__prompt_kernel_end-sequential_preLN__spectral_fnet__dense_activation_squared_relu__prompt_kernel-512, v242
  v_cmp_gt_u32 vcc, 16, v0
  s_and_saveexec_b64 s[16:17], vcc
  s_cbranch_execz sequential_preLN__spectral_fnet__dense_activation_squared_relu__prompt_kernel_nocpf
  global_load_dword a255, v242, s[48:49]
sequential_preLN__spectral_fnet__dense_activation_squared_relu__prompt_kernel_nocpf:
  s_mov_b64 exec, s[16:17]
  s_waitcnt lgkmcnt(0)
  s_mov_b32 s4, s86
  s_and_b32 s5, s87, 0xffff
  s_mov_b32 s6, 4194304
  s_mov_b32 s7, 0x20000
  s_add_u32 m0, s55, 0
  s_nop 0
  buffer_load_dwordx4 v164, s[4:7], s52 offen offset:0 lds
  s_add_u32 m0, s55, 1024
  s_nop 0
  buffer_load_dwordx4 v164, s[4:7], s54 offen offset:0 lds
  s_add_u32 m0, s55, 1920
  s_nop 0
  buffer_load_dwordx4 v164, s[4:7], s52 offen offset:128 lds
  s_add_u32 m0, s55, 2944
  s_nop 0
  buffer_load_dwordx4 v164, s[4:7], s54 offen offset:128 lds
  s_add_u32 m0, s55, 3840
  s_nop 0
  buffer_load_dwordx4 v164, s[4:7], s52 offen offset:256 lds
  s_add_u32 m0, s55, 4864
  s_nop 0
  buffer_load_dwordx4 v164, s[4:7], s54 offen offset:256 lds
  s_add_u32 m0, s55, 5760
  s_nop 0
  buffer_load_dwordx4 v164, s[4:7], s52 offen offset:384 lds
  s_add_u32 m0, s55, 6784
  s_nop 0
  buffer_load_dwordx4 v164, s[4:7], s54 offen offset:384 lds
  v_bfe_u32 v250, v0, 4, 2
  v_lshlrev_b32 v251, 4, v248
  s_lshl_b32 s51, s46, 2
  s_add_u32 s51, s51, s36
  s_bfe_u32 s37, s2, 0x20001
  s_lshl_b32 s37, s37, 2
  s_bfe_u32 s3, s2, 0x20003
  s_add_u32 s3, s3, s37
  s_lshl_b32 s3, s3, 2
  s_mov_b32 s48, 0xd3e2f180
  s_mov_b32 s49, 0x97a6b5c4
  s_lshr_b64 s[48:49], s[48:49], s3
  s_and_b32 s37, s48, 15
  s_and_b32 s38, s2, 1
  s_lshr_b32 s39, s2, 5
  s_lshl_b32 s41, s38, 3
  s_add_u32 s41, s41, s39
  s_lshl_b32 s40, s37, 2
  s_add_u32 s40, s40, s36
  s_mul_i32 s57, s41, 448
  s_mov_b32 s8, s100
  s_and_b32 s9, s101, 0xffff
  s_mov_b32 s10, 10485760
  s_mov_b32 s11, 0x20000
  s_mov_b32 s24, s98
  s_and_b32 s25, s99, 0xffff
  s_mov_b32 s26, 256
  s_mov_b32 s27, 0x20000
  s_or_b32 s3, s2, s36
  s_cmp_lg_u32 s3, 0
  s_cbranch_scc1 sequential_preLN__spectral_fnet__dense_activation_squared_relu__prompt_kernel_non1
  s_and_b32 s48, s42, -8
  s_or_b32 s48, s48, 8
  v_mov_b32 v244, s48
  v_mov_b32 v245, s43
  v_mov_b32 v247, 0
  s_mov_b64 exec, 1
  buffer_store_dwordx2 v[244:245], v247, s[24:27], 0 offen sc1
  s_mov_b64 exec, -1
sequential_preLN__spectral_fnet__dense_activation_squared_relu__prompt_kernel_non1:
  s_sub_u32 s3, 7340032, s57
  s_add_u32 s12, s88, s57
  s_addc_u32 s13, s89, 0
  s_and_b32 s13, s13, 0xffff
  s_mov_b32 s14, s3
  s_mov_b32 s15, 0x20000
  v_and_b32 v165, 6, v249
  v_xor_b32 v165, v165, v250
  v_lshlrev_b32 v166, 7, v249
  v_add_u32 v166, s55, v166
  v_lshl_add_u32 v1, v165, 4, v166
  v_xor_b32 v2, 64, v1
  v_bfe_u32 v165, v0, 2, 3
  v_lshlrev_b32 v166, 7, v165
  v_and_b32 v165, 6, v165
  v_lshlrev_b32 v165, 4, v165
  v_and_b32 v167, 32, v248
  v_lshlrev_b32 v167, 1, v167
  v_xor_b32 v165, v165, v167
  v_and_b32 v167, 3, v0
  v_lshlrev_b32 v167, 3, v167
  v_add3_u32 v166, v166, v167, s55
  v_add_u32 v3, v166, v165
  v_xor_b32 v4, 32, v3
  v_and_b32 v165, 7, v0
  v_mul_u32_u24 v5, 2056, v165
  v_and_b32 v166, 8, v0
  v_lshlrev_b32 v166, 3, v166
  v_lshl_add_u32 v166, v250, 3, v166
  s_add_u32 s3, s53, 135168
  v_add3_u32 v5, v5, v166, s3
  v_lshrrev_b32 v168, 5, v248
  v_lshlrev_b32 v168, 9, v168
  v_bfe_u32 v169, v0, 2, 2
  v_lshl_add_u32 v168, v169, 6, v168
  v_and_b32 v169, 16, v0
  v_lshlrev_b32 v169, 1, v169
  v_add3_u32 v168, v168, v169, v167
  s_mul_i32 s3, s36, 4112
  s_add_u32 s3, s3, 135168
  v_add_u32 v6, s3, v168
  v_lshrrev_b32 v168, 2, v249
  v_cmp_eq_u32 vcc, v168, v250
  s_lshl_b32 s3, s36, 3
  s_add_u32 s3, s3, 151616
  v_lshl_add_u32 v169, v249, 5, s3
  v_lshlrev_b32 v170, 3, v248
  v_add_u32 v170, 152128, v170
  v_cndmask_b32 v7, v170, v169, vcc
  v_and_b32 v168, 1, v250
  v_lshlrev_b32 v168, 2, v168
  v_xor_b32 v169, v249, v168
  v_lshlrev_b32 v170, 5, v169
  v_add_u32 v236, 151616, v170
  s_lshl_b32 s31, s46, 7
  s_add_u32 s31, s31, s50
  s_lshl_b32 s31, s31, 7
  s_add_u32 s31, s31, 4194304
  v_lshlrev_b32 v238, 2, v169
  v_cmp_gt_u32 vcc, 16, v0
  v_mov_b32 v239, 0x40000000
  s_nop 0
  v_cndmask_b32 v238, v239, v238, vcc
  v_and_b32 v169, 3, v0
  v_cmp_eq_u32 s[16:17], 1, v169
  v_cmp_eq_u32 s[18:19], 2, v169
  v_cmp_eq_u32 s[20:21], 3, v169
  s_mov_b32 s28, 0x10001
  s_mov_b32 s29, 0
  s_lshl_b32 s3, s46, 3
  v_add_u32 v171, s3, v165
  v_lshrrev_b32 v169, 1, v171
  v_cmp_eq_u32 vcc, 1, v171
  v_and_b32 v170, 1, v171
  s_nop 0
  v_cndmask_b32 v169, v169, 8, vcc
  v_cndmask_b32 v170, v170, 0, vcc
  v_and_b32 v239, 3, v0
  v_mul_u32_u24 v239, 4112, v239
  v_add_u32 v239, 135168, v239
  v_cvt_f32_u32 v169, v169
  v_cvt_f32_u32 v170, v170
  v_cvt_f32_u32 v168, v168
  v_mul_f32 v169, 0x3d800000, v169
  v_mul_f32 v170, 0x3e800000, v170
  v_fmac_f32 v170, v169, v168
  v_fmamk_f32 v72, v169, 0x0, v170
  v_fmamk_f32 v73, v169, 0x3f800000, v170
  v_fmamk_f32 v74, v169, 0x40000000, v170
  v_fmamk_f32 v75, v169, 0x40400000, v170
  v_fmamk_f32 v76, v169, 0x41000000, v170
  v_fmamk_f32 v77, v169, 0x41100000, v170
  v_fmamk_f32 v78, v169, 0x41200000, v170
  v_fmamk_f32 v79, v169, 0x41300000, v170
  v_cos_f32 v72, v72
  v_cos_f32 v73, v73
  v_cos_f32 v74, v74
  v_cos_f32 v75, v75
  v_cos_f32 v76, v76
  v_cos_f32 v77, v77
  v_cos_f32 v78, v78
  v_cos_f32 v79, v79
  v_lshrrev_b32 v168, 3, v249
  v_lshrrev_b32 v169, 1, v250
  v_cmp_eq_u32 vcc, v168, v169
  v_mov_b32 v160, 0x3f803f80
  v_mov_b32 v161, 0x3f803f80
  v_mov_b32 v162, 0x3f803f80
  v_mov_b32 v163, 0x3f803f80
  v_cndmask_b32 v72, 0, v72, vcc
  v_cndmask_b32 v73, 0, v73, vcc
  v_cndmask_b32 v74, 0, v74, vcc
  v_cndmask_b32 v75, 0, v75, vcc
  v_cndmask_b32 v76, 0, v76, vcc
  v_cndmask_b32 v77, 0, v77, vcc
  v_cndmask_b32 v78, 0, v78, vcc
  v_cndmask_b32 v79, 0, v79, vcc
  v_and_b32 v174, 4, v0
  v_lshlrev_b32 v174, 2, v174
  v_and_b32 v175, 3, v0
  v_bfe_u32 v176, v0, 3, 2
  v_lshl_add_u32 v175, v176, 2, v175
  v_add_u32 v174, v174, v175
  v_lshlrev_b32 v179, 31, v174
  v_lshrrev_b32 v180, 16, v179
  v_or_b32 v179, v179, v180
  v_cvt_f32_u32 v177, v174
  v_lshrrev_b32 v178, 5, v248
  v_cvt_f32_u32 v178, v178
  v_mul_f32 v174, 0x3a800000, v177
  v_mul_f32 v175, 4.0, v178
  v_mul_f32 v175, v175, v174
  v_fmamk_f32 v128, v174, 0x0, v175
  v_fmamk_f32 v129, v174, 0x3f800000, v175
  v_fmamk_f32 v130, v174, 0x40000000, v175
  v_fmamk_f32 v131, v174, 0x40400000, v175
  v_fmamk_f32 v132, v174, 0x41000000, v175
  v_fmamk_f32 v133, v174, 0x41100000, v175
  v_fmamk_f32 v134, v174, 0x41200000, v175
  v_fmamk_f32 v135, v174, 0x41300000, v175
  v_fmamk_f32 v136, v174, 0x41800000, v175
  v_fmamk_f32 v137, v174, 0x41880000, v175
  v_fmamk_f32 v138, v174, 0x41900000, v175
  v_fmamk_f32 v139, v174, 0x41980000, v175
  v_fmamk_f32 v140, v174, 0x41c00000, v175
  v_fmamk_f32 v141, v174, 0x41c80000, v175
  v_fmamk_f32 v142, v174, 0x41d00000, v175
  v_fmamk_f32 v143, v174, 0x41d80000, v175
  v_sin_f32 v144, v128
  v_sin_f32 v145, v129
  v_sin_f32 v146, v130
  v_sin_f32 v147, v131
  v_sin_f32 v148, v132
  v_sin_f32 v149, v133
  v_sin_f32 v150, v134
  v_sin_f32 v151, v135
  v_sin_f32 v152, v136
  v_sin_f32 v153, v137
  v_sin_f32 v154, v138
  v_sin_f32 v155, v139
  v_sin_f32 v156, v140
  v_sin_f32 v157, v141
  v_sin_f32 v158, v142
  v_sin_f32 v159, v143
  v_cos_f32 v128, v128
  v_cos_f32 v129, v129
  v_cos_f32 v130, v130
  v_cos_f32 v131, v131
  v_cos_f32 v132, v132
  v_cos_f32 v133, v133
  v_cos_f32 v134, v134
  v_cos_f32 v135, v135
  v_cos_f32 v136, v136
  v_cos_f32 v137, v137
  v_cos_f32 v138, v138
  v_cos_f32 v139, v139
  v_cos_f32 v140, v140
  v_cos_f32 v141, v141
  v_cos_f32 v142, v142
  v_cos_f32 v143, v143
  v_cvt_pk_f16_f32 v144, v144, v145
  v_cvt_pk_f16_f32 v145, v146, v147
  v_cvt_pk_f16_f32 v146, v148, v149
  v_cvt_pk_f16_f32 v147, v150, v151
  v_cvt_pk_f16_f32 v148, v152, v153
  v_cvt_pk_f16_f32 v149, v154, v155
  v_cvt_pk_f16_f32 v150, v156, v157
  v_cvt_pk_f16_f32 v151, v158, v159
  v_cvt_pk_f16_f32 v128, v128, v129
  v_cvt_pk_f16_f32 v129, v130, v131
  v_cvt_pk_f16_f32 v130, v132, v133
  v_cvt_pk_f16_f32 v131, v134, v135
  v_cvt_pk_f16_f32 v132, v136, v137
  v_cvt_pk_f16_f32 v133, v138, v139
  v_cvt_pk_f16_f32 v134, v140, v141
  v_cvt_pk_f16_f32 v135, v142, v143
  v_mul_f32 v174, 0x3d000000, v177
  v_mul_f32 v175, 0x41000000, v178
  v_mul_f32 v175, v175, v174
  v_fmamk_f32 v200, v174, 0x0, v175
  v_fmamk_f32 v201, v174, 0x3f800000, v175
  v_fmamk_f32 v202, v174, 0x40000000, v175
  v_fmamk_f32 v203, v174, 0x40400000, v175
  v_fmamk_f32 v204, v174, 0x40800000, v175
  v_fmamk_f32 v205, v174, 0x40a00000, v175
  v_fmamk_f32 v206, v174, 0x40c00000, v175
  v_fmamk_f32 v207, v174, 0x40e00000, v175
  v_sin_f32 v208, v200
  v_sin_f32 v209, v201
  v_sin_f32 v210, v202
  v_sin_f32 v211, v203
  v_sin_f32 v212, v204
  v_sin_f32 v213, v205
  v_sin_f32 v214, v206
  v_sin_f32 v215, v207
  v_cos_f32 v200, v200
  v_cos_f32 v201, v201
  v_cos_f32 v202, v202
  v_cos_f32 v203, v203
  v_cos_f32 v204, v204
  v_cos_f32 v205, v205
  v_cos_f32 v206, v206
  v_cos_f32 v207, v207
  v_cvt_pk_f16_f32 v88, -v208, -v209
  v_cvt_pk_f16_f32 v89, -v210, -v211
  v_cvt_pk_f16_f32 v90, -v212, -v213
  v_cvt_pk_f16_f32 v91, -v214, -v215
  v_cvt_pk_f16_f32 v80, v200, v201
  v_cvt_pk_f16_f32 v81, v202, v203
  v_cvt_pk_f16_f32 v82, v204, v205
  v_cvt_pk_f16_f32 v83, v206, v207
  v_xor_b32 v84, v80, v179
  v_xor_b32 v92, v88, v179
  v_xor_b32 v85, v81, v179
  v_xor_b32 v93, v89, v179
  v_xor_b32 v86, v82, v179
  v_xor_b32 v94, v90, v179
  v_xor_b32 v87, v83, v179
  v_xor_b32 v95, v91, v179
  v_cvt_f32_u32 v168, v249
  v_mul_f32 v168, 0x3d000000, v168
  v_mul_f32 v169, 4.0, v178
  v_mul_f32 v169, v169, v168
  v_and_b32 v170, 1, v250
  v_cvt_f32_u32 v170, v170
  v_fmac_f32 v169, 0x3e800000, v170
  v_lshlrev_b32 v173, 31, v249
  v_lshrrev_b32 v174, 16, v173
  v_or_b32 v173, v173, v174
  v_fmamk_f32 v200, v168, 0x0, v169
  v_fmamk_f32 v201, v168, 0x3f800000, v169
  v_fmamk_f32 v202, v168, 0x40000000, v169
  v_fmamk_f32 v203, v168, 0x40400000, v169
  v_fmamk_f32 v204, v168, 0x41000000, v169
  v_fmamk_f32 v205, v168, 0x41100000, v169
  v_fmamk_f32 v206, v168, 0x41200000, v169
  v_fmamk_f32 v207, v168, 0x41300000, v169
  v_sin_f32 v208, v200
  v_sin_f32 v209, v201
  v_sin_f32 v210, v202
  v_sin_f32 v211, v203
  v_sin_f32 v212, v204
  v_sin_f32 v213, v205
  v_sin_f32 v214, v206
  v_sin_f32 v215, v207
  v_cos_f32 v200, v200
  v_cos_f32 v201, v201
  v_cos_f32 v202, v202
  v_cos_f32 v203, v203
  v_cos_f32 v204, v204
  v_cos_f32 v205, v205
  v_cos_f32 v206, v206
  v_cos_f32 v207, v207
  v_cvt_pk_f16_f32 v104, v208, v209
  v_cvt_pk_f16_f32 v105, v210, v211
  v_cvt_pk_f16_f32 v106, v212, v213
  v_cvt_pk_f16_f32 v107, v214, v215
  v_cvt_pk_f16_f32 v96, v200, v201
  v_cvt_pk_f16_f32 v97, v202, v203
  v_cvt_pk_f16_f32 v98, v204, v205
  v_cvt_pk_f16_f32 v99, v206, v207
  v_xor_b32 v100, v96, v173
  v_xor_b32 v108, v104, v173
  v_xor_b32 v101, v97, v173
  v_xor_b32 v109, v105, v173
  v_xor_b32 v102, v98, v173
  v_xor_b32 v110, v106, v173
  v_xor_b32 v103, v99, v173
  v_xor_b32 v111, v107, v173
  v_xor_b32 v112, 0x80000000, v96
  v_xor_b32 v113, 0x80000000, v97
  v_xor_b32 v114, 0x80000000, v98
  v_xor_b32 v115, 0x80000000, v99
  v_xor_b32 v116, 0x80000000, v100
  v_xor_b32 v117, 0x80000000, v101
  v_xor_b32 v118, 0x80000000, v102
  v_xor_b32 v119, 0x80000000, v103
  v_xor_b32 v120, 0x80000000, v104
  v_xor_b32 v121, 0x80000000, v105
  v_xor_b32 v122, 0x80000000, v106
  v_xor_b32 v123, 0x80000000, v107
  v_xor_b32 v124, 0x80000000, v108
  v_xor_b32 v125, 0x80000000, v109
  v_xor_b32 v126, 0x80000000, v110
  v_xor_b32 v127, 0x80000000, v111
  v_lshlrev_b32 v169, 4, v250
  v_lshl_add_u32 v169, v249, 14, v169
  s_lshl_b32 s3, s50, 6
  v_add_u32 v237, s3, v169
  v_add_u32 v246, 0x2000, v237
  s_lshl_b32 s58, s51, 18
  s_sub_u32 s59, 16, s51
  s_cmp_eq_u32 s51, 0
  s_cselect_b32 s59, 8, s59
  s_lshl_b32 s59, s59, 18
  v_mov_b32 v247, 0
  s_mov_b32 s32, s88
  s_and_b32 s33, s89, 0xffff
  s_mov_b32 s34, 7340032
  s_mov_b32 s35, 0x20000
  s_lshl_b32 s3, s2, 2
  s_add_u32 s3, s3, s36
  s_mul_i32 s45, s3, 7168
  v_lshlrev_b32 v234, 7, v248
  v_cmp_gt_u32 vcc, 56, v248
  v_mov_b32 v235, 0x40000000
  s_nop 0
  v_cndmask_b32 v234, v235, v234, vcc
  s_waitcnt vmcnt(6)
  ds_read_b128 v[8:11], v1 offset:0
  ds_read_b128 v[12:15], v2 offset:0
  s_waitcnt vmcnt(4)
  ds_read_b128 v[16:19], v1 offset:2048
  ds_read_b128 v[20:23], v2 offset:2048
  s_waitcnt vmcnt(2)
  ds_read_b128 v[24:27], v1 offset:4096
  ds_read_b128 v[28:31], v2 offset:4096
  s_waitcnt vmcnt(0)
  ds_read_b128 v[32:35], v1 offset:6144
  ds_read_b128 v[36:39], v2 offset:6144
  buffer_load_dwordx2 v[244:245], v247, s[24:27], 0 offen sc1
  buffer_load_dword a255, v234, s[32:35], s45 offen
  s_waitcnt lgkmcnt(7)
  v_mfma_f32_16x16x32_bf16 v[164:167], v[8:11], v[8:11], 0
  v_mfma_f32_16x16x32_bf16 v[168:171], v[160:163], v[8:11], 0
  s_waitcnt lgkmcnt(6)
  v_mfma_f32_16x16x32_bf16 v[164:167], v[12:15], v[12:15], v[164:167]
  v_mfma_f32_16x16x32_bf16 v[168:171], v[160:163], v[12:15], v[168:171]
  s_waitcnt lgkmcnt(5)
  v_mfma_f32_16x16x32_bf16 v[164:167], v[16:19], v[16:19], v[164:167]
  v_mfma_f32_16x16x32_bf16 v[168:171], v[160:163], v[16:19], v[168:171]
  s_waitcnt lgkmcnt(4)
  v_mfma_f32_16x16x32_bf16 v[164:167], v[20:23], v[20:23], v[164:167]
  v_mfma_f32_16x16x32_bf16 v[168:171], v[160:163], v[20:23], v[168:171]
  s_waitcnt lgkmcnt(3)
  v_mfma_f32_16x16x32_bf16 v[164:167], v[24:27], v[24:27], v[164:167]
  v_mfma_f32_16x16x32_bf16 v[168:171], v[160:163], v[24:27], v[168:171]
  s_waitcnt lgkmcnt(2)
  v_mfma_f32_16x16x32_bf16 v[164:167], v[28:31], v[28:31], v[164:167]
  v_mfma_f32_16x16x32_bf16 v[168:171], v[160:163], v[28:31], v[168:171]
  s_waitcnt lgkmcnt(1)
  v_mfma_f32_16x16x32_bf16 v[164:167], v[32:35], v[32:35], v[164:167]
  v_mfma_f32_16x16x32_bf16 v[168:171], v[160:163], v[32:35], v[168:171]
  s_waitcnt lgkmcnt(0)
  v_mfma_f32_16x16x32_bf16 v[164:167], v[36:39], v[36:39], v[164:167]
  v_mfma_f32_16x16x32_bf16 v[168:171], v[160:163], v[36:39], v[168:171]
  ds_read_b64_tr_b16 v[40:41], v3 offset:0
  ds_read_b64_tr_b16 v[42:43], v3 offset:1024
  ds_read_b64_tr_b16 v[44:45], v4 offset:0
  ds_read_b64_tr_b16 v[46:47], v4 offset:1024
  ds_read_b64_tr_b16 v[48:49], v3 offset:2048
  ds_read_b64_tr_b16 v[50:51], v3 offset:3072
  ds_read_b64_tr_b16 v[52:53], v4 offset:2048
  ds_read_b64_tr_b16 v[54:55], v4 offset:3072
  v_cndmask_b32 v169, v164, v165, s[16:17]
  v_cndmask_b32 v169, v169, v166, s[18:19]
  v_cndmask_b32 v169, v169, v167, s[20:21]
  ds_write_b64 v7, v[168:169]
  ds_read_b64_tr_b16 v[56:57], v3 offset:4096
  ds_read_b64_tr_b16 v[58:59], v3 offset:5120
  ds_read_b64_tr_b16 v[60:61], v4 offset:4096
  ds_read_b64_tr_b16 v[62:63], v4 offset:5120
  ds_read_b64_tr_b16 v[64:65], v3 offset:6144
  ds_read_b64_tr_b16 v[66:67], v3 offset:7168
  ds_read_b64_tr_b16 v[68:69], v4 offset:6144
  ds_read_b64_tr_b16 v[70:71], v4 offset:7168
  s_waitcnt lgkmcnt(8)
  s_barrier
  ds_read_b128 v[184:187], v236 offset:0
  ds_read_b128 v[188:191], v236 offset:16
  s_waitcnt lgkmcnt(0)
  v_pk_add_f32 v[184:185], v[184:185], v[186:187]
  v_pk_add_f32 v[188:189], v[188:189], v[190:191]
  v_pk_add_f32 v[184:185], v[184:185], v[188:189]
  v_mul_f32 v187, 0x3a800000, v184
  v_mul_f32 v186, v187, v187
  v_mul_f32 v185, 0x3a800000, v185
  v_sub_f32 v185, v185, v186
  v_max_f32 v185, 0, v185
  v_add_f32 v185, 0x3727c5ac, v185
  v_rsq_f32 v185, v185
  s_nop 0
  v_mul_f32 v184, -v187, v185
  v_mov_b32 v236, v187
  s_nop 0
  v_mul_f32_dpp v188, v185, v72 row_newbcast:0 row_mask:0xf bank_mask:0xf
  v_mul_f32_dpp v164, v184, v72 row_newbcast:0 row_mask:0xf bank_mask:0xf
  v_mul_f32_dpp v189, v185, v73 row_newbcast:1 row_mask:0xf bank_mask:0xf
  v_mul_f32_dpp v165, v184, v73 row_newbcast:1 row_mask:0xf bank_mask:0xf
  v_mul_f32_dpp v190, v185, v74 row_newbcast:2 row_mask:0xf bank_mask:0xf
  v_fmac_f32_dpp v164, v184, v74 row_newbcast:2 row_mask:0xf bank_mask:0xf
  v_mul_f32_dpp v191, v185, v75 row_newbcast:3 row_mask:0xf bank_mask:0xf
  v_fmac_f32_dpp v165, v184, v75 row_newbcast:3 row_mask:0xf bank_mask:0xf
  v_mul_f32_dpp v192, v185, v76 row_newbcast:8 row_mask:0xf bank_mask:0xf
  v_fmac_f32_dpp v164, v184, v76 row_newbcast:8 row_mask:0xf bank_mask:0xf
  v_mul_f32_dpp v193, v185, v77 row_newbcast:9 row_mask:0xf bank_mask:0xf
  v_fmac_f32_dpp v165, v184, v77 row_newbcast:9 row_mask:0xf bank_mask:0xf
  v_mul_f32_dpp v194, v185, v78 row_newbcast:10 row_mask:0xf bank_mask:0xf
  v_fmac_f32_dpp v164, v184, v78 row_newbcast:10 row_mask:0xf bank_mask:0xf
  v_mul_f32_dpp v195, v185, v79 row_newbcast:11 row_mask:0xf bank_mask:0xf
  v_fmac_f32_dpp v165, v184, v79 row_newbcast:11 row_mask:0xf bank_mask:0xf
  v_add_f32 v164, v164, v165
  v_cvt_pk_bf16_f32 v168, v188, v189
  v_cvt_pk_bf16_f32 v169, v190, v191
  v_cvt_pk_bf16_f32 v170, v192, v193
  v_cvt_pk_bf16_f32 v171, v194, v195
  v_mov_b32 v165, v164
  s_nop 1
  v_permlane16_swap_b32 v164, v165
  v_add_f32 v164, v164, v165
  v_mov_b32 v165, v164
  s_nop 1
  v_permlane32_swap_b32 v164, v165
  v_add_f32 v164, v164, v165
  v_mov_b32 v165, v164
  v_mov_b32 v166, v164
  v_mov_b32 v167, v164
  s_nop 1
  v_mfma_f32_16x16x32_bf16 v[200:203], v[40:43], v[168:171], v[164:167]
  v_mfma_f32_16x16x32_bf16 v[204:207], v[44:47], v[168:171], v[164:167]
  v_mfma_f32_16x16x32_bf16 v[208:211], v[48:51], v[168:171], v[164:167]
  v_mfma_f32_16x16x32_bf16 v[212:215], v[52:55], v[168:171], v[164:167]
  v_mfma_f32_16x16x32_bf16 v[216:219], v[56:59], v[168:171], v[164:167]
  v_mfma_f32_16x16x32_bf16 v[220:223], v[60:63], v[168:171], v[164:167]
  v_mfma_f32_16x16x32_bf16 v[224:227], v[64:67], v[168:171], v[164:167]
  v_mfma_f32_16x16x32_bf16 v[228:231], v[68:71], v[168:171], v[164:167]
  s_nop 0
  v_cvt_pk_f16_f32 v200, v200, v201
  v_cvt_pk_f16_f32 v201, v202, v203
  ds_write_b64 v5, v[200:201] offset:0
  v_cvt_pk_f16_f32 v204, v204, v205
  v_cvt_pk_f16_f32 v205, v206, v207
  ds_write_b64 v5, v[204:205] offset:32
  v_cvt_pk_f16_f32 v208, v208, v209
  v_cvt_pk_f16_f32 v209, v210, v211
  ds_write_b64 v5, v[208:209] offset:128
  v_cvt_pk_f16_f32 v212, v212, v213
  v_cvt_pk_f16_f32 v213, v214, v215
  ds_write_b64 v5, v[212:213] offset:160
  v_cvt_pk_f16_f32 v216, v216, v217
  v_cvt_pk_f16_f32 v217, v218, v219
  ds_write_b64 v5, v[216:217] offset:256
  v_cvt_pk_f16_f32 v220, v220, v221
  v_cvt_pk_f16_f32 v221, v222, v223
  ds_write_b64 v5, v[220:221] offset:288
  v_cvt_pk_f16_f32 v224, v224, v225
  v_cvt_pk_f16_f32 v225, v226, v227
  ds_write_b64 v5, v[224:225] offset:384
  v_cvt_pk_f16_f32 v228, v228, v229
  v_cvt_pk_f16_f32 v229, v230, v231
  ds_write_b64 v5, v[228:229] offset:416
  s_waitcnt lgkmcnt(0)
  s_barrier
  ds_read_b64_tr_b16 v[184:185], v6 offset:0
  ds_read_b64_tr_b16 v[186:187], v6 offset:256
  ds_read_b64_tr_b16 v[188:189], v6 offset:1024
  ds_read_b64_tr_b16 v[190:191], v6 offset:1280
  ds_read_b64_tr_b16 v[192:193], v6 offset:2056
  ds_read_b64_tr_b16 v[194:195], v6 offset:2312
  ds_read_b64_tr_b16 v[196:197], v6 offset:3080
  ds_read_b64_tr_b16 v[198:199], v6 offset:3336
  ds_read_u16 v242, v239
  ds_read_u16 v243, v239 offset:2056
  s_waitcnt lgkmcnt(8)
  v_mfma_f32_32x32x16_f16 v[8:23], v[184:187], v[80:83], 0
  v_mfma_f32_32x32x16_f16 v[24:39], v[184:187], v[88:91], 0
  s_waitcnt lgkmcnt(6)
  v_mfma_f32_32x32x16_f16 v[8:23], v[188:191], v[84:87], v[8:23]
  v_mfma_f32_32x32x16_f16 v[24:39], v[188:191], v[92:95], v[24:39]
  s_waitcnt lgkmcnt(4)
  v_mfma_f32_32x32x16_f16 v[40:55], v[192:195], v[80:83], 0
  v_mfma_f32_32x32x16_f16 v[56:71], v[192:195], v[88:91], 0
  s_waitcnt lgkmcnt(2)
  v_mfma_f32_32x32x16_f16 v[40:55], v[196:199], v[84:87], v[40:55]
  v_mfma_f32_32x32x16_f16 v[56:71], v[196:199], v[92:95], v[56:71]
  s_waitcnt lgkmcnt(0)
  s_xor_b32 s30, s46, 1
  s_mov_b32 s29, 0
  v_lshl_or_b32 v232, v243, 16, v242
  v_xor_b32 v233, 0x80000000, v232
  s_mov_b32 s16, s30
  s_mov_b32 s17, 0
  s_nop 0
  v_cndmask_b32 v242, v232, v242, s[16:17]
  v_cndmask_b32 v243, v233, v243, s[16:17]
  s_nop 4
  s_cmp_eq_u32 s51, 0
  s_cbranch_scc1 sequential_preLN__spectral_fnet__dense_activation_squared_relu__prompt_kernel_nocomb
  v_cvt_pk_f16_f32 v8, v8, v9
  v_cvt_pk_f16_f32 v9, v10, v11
  v_cvt_pk_f16_f32 v10, v12, v13
  v_cvt_pk_f16_f32 v11, v14, v15
  v_cvt_pk_f16_f32 v12, v16, v17
  v_cvt_pk_f16_f32 v13, v18, v19
  v_cvt_pk_f16_f32 v14, v20, v21
  v_cvt_pk_f16_f32 v15, v22, v23
  v_cvt_pk_f16_f32 v24, v24, v25
  v_cvt_pk_f16_f32 v25, v26, v27
  v_cvt_pk_f16_f32 v26, v28, v29
  v_cvt_pk_f16_f32 v27, v30, v31
  v_cvt_pk_f16_f32 v28, v32, v33
  v_cvt_pk_f16_f32 v29, v34, v35
  v_cvt_pk_f16_f32 v30, v36, v37
  v_cvt_pk_f16_f32 v31, v38, v39
  v_cvt_pk_f16_f32 v40, v40, v41
  v_cvt_pk_f16_f32 v41, v42, v43
  v_cvt_pk_f16_f32 v42, v44, v45
  v_cvt_pk_f16_f32 v43, v46, v47
  v_cvt_pk_f16_f32 v44, v48, v49
  v_cvt_pk_f16_f32 v45, v50, v51
  v_cvt_pk_f16_f32 v46, v52, v53
  v_cvt_pk_f16_f32 v47, v54, v55
  v_cvt_pk_f16_f32 v56, v56, v57
  v_cvt_pk_f16_f32 v57, v58, v59
  v_cvt_pk_f16_f32 v58, v60, v61
  v_cvt_pk_f16_f32 v59, v62, v63
  v_cvt_pk_f16_f32 v60, v64, v65
  v_cvt_pk_f16_f32 v61, v66, v67
  v_cvt_pk_f16_f32 v62, v68, v69
  v_cvt_pk_f16_f32 v63, v70, v71
  v_pk_add_f16 v200, v8, v56 neg_lo:[0,1] neg_hi:[0,1]
  v_pk_add_f16 v208, v24, v40
  v_pk_add_f16 v201, v9, v57 neg_lo:[0,1] neg_hi:[0,1]
  v_pk_add_f16 v209, v25, v41
  v_pk_add_f16 v202, v10, v58 neg_lo:[0,1] neg_hi:[0,1]
  v_pk_add_f16 v210, v26, v42
  v_pk_add_f16 v203, v11, v59 neg_lo:[0,1] neg_hi:[0,1]
  v_pk_add_f16 v211, v27, v43
  v_pk_add_f16 v204, v12, v60 neg_lo:[0,1] neg_hi:[0,1]
  v_pk_add_f16 v212, v28, v44
  v_pk_add_f16 v205, v13, v61 neg_lo:[0,1] neg_hi:[0,1]
  v_pk_add_f16 v213, v29, v45
  v_pk_add_f16 v206, v14, v62 neg_lo:[0,1] neg_hi:[0,1]
  v_pk_add_f16 v214, v30, v46
  v_pk_add_f16 v207, v15, v63 neg_lo:[0,1] neg_hi:[0,1]
  v_pk_add_f16 v215, v31, v47
  v_pk_add_f16 v216, v8, v56
  v_pk_add_f16 v224, v24, v40 neg_lo:[0,1] neg_hi:[0,1]
  v_pk_add_f16 v217, v9, v57
  v_pk_add_f16 v225, v25, v41 neg_lo:[0,1] neg_hi:[0,1]
  v_pk_add_f16 v218, v10, v58
  v_pk_add_f16 v226, v26, v42 neg_lo:[0,1] neg_hi:[0,1]
  v_pk_add_f16 v219, v11, v59
  v_pk_add_f16 v227, v27, v43 neg_lo:[0,1] neg_hi:[0,1]
  v_pk_add_f16 v220, v12, v60
  v_pk_add_f16 v228, v28, v44 neg_lo:[0,1] neg_hi:[0,1]
  v_pk_add_f16 v221, v13, v61
  v_pk_add_f16 v229, v29, v45 neg_lo:[0,1] neg_hi:[0,1]
  v_pk_add_f16 v222, v14, v62
  v_pk_add_f16 v230, v30, v46 neg_lo:[0,1] neg_hi:[0,1]
  v_pk_add_f16 v223, v15, v63
  v_pk_add_f16 v231, v31, v47 neg_lo:[0,1] neg_hi:[0,1]
  s_branch sequential_preLN__spectral_fnet__dense_activation_squared_relu__prompt_kernel_comb
sequential_preLN__spectral_fnet__dense_activation_squared_relu__prompt_kernel_nocomb:
  v_cvt_pk_f16_f32 v200, v8, v9
  v_cvt_pk_f16_f32 v201, v10, v11
  v_cvt_pk_f16_f32 v202, v12, v13
  v_cvt_pk_f16_f32 v203, v14, v15
  v_cvt_pk_f16_f32 v204, v16, v17
  v_cvt_pk_f16_f32 v205, v18, v19
  v_cvt_pk_f16_f32 v206, v20, v21
  v_cvt_pk_f16_f32 v207, v22, v23
  v_cvt_pk_f16_f32 v208, v24, v25
  v_cvt_pk_f16_f32 v209, v26, v27
  v_cvt_pk_f16_f32 v210, v28, v29
  v_cvt_pk_f16_f32 v211, v30, v31
  v_cvt_pk_f16_f32 v212, v32, v33
  v_cvt_pk_f16_f32 v213, v34, v35
  v_cvt_pk_f16_f32 v214, v36, v37
  v_cvt_pk_f16_f32 v215, v38, v39
  v_cvt_pk_f16_f32 v216, v40, v41
  v_cvt_pk_f16_f32 v217, v42, v43
  v_cvt_pk_f16_f32 v218, v44, v45
  v_cvt_pk_f16_f32 v219, v46, v47
  v_cvt_pk_f16_f32 v220, v48, v49
  v_cvt_pk_f16_f32 v221, v50, v51
  v_cvt_pk_f16_f32 v222, v52, v53
  v_cvt_pk_f16_f32 v223, v54, v55
  v_cvt_pk_f16_f32 v224, v56, v57
  v_cvt_pk_f16_f32 v225, v58, v59
  v_cvt_pk_f16_f32 v226, v60, v61
  v_cvt_pk_f16_f32 v227, v62, v63
  v_cvt_pk_f16_f32 v228, v64, v65
  v_cvt_pk_f16_f32 v229, v66, v67
  v_cvt_pk_f16_f32 v230, v68, v69
  v_cvt_pk_f16_f32 v231, v70, v71
sequential_preLN__spectral_fnet__dense_activation_squared_relu__prompt_kernel_comb:
  v_pk_mul_f16 v164, v208, v144
  v_pk_mul_f16 v165, v200, v144
  v_pk_mul_f16 v166, v209, v145
  v_pk_mul_f16 v167, v201, v145
  v_pk_mul_f16 v168, v210, v146
  v_pk_mul_f16 v169, v202, v146
  v_pk_mul_f16 v170, v211, v147
  v_pk_mul_f16 v171, v203, v147
  v_pk_fma_f16 v200, v200, v128, v164
  v_pk_fma_f16 v201, v201, v129, v166
  v_pk_fma_f16 v202, v202, v130, v168
  v_pk_fma_f16 v203, v203, v131, v170
  v_pk_fma_f16 v208, v208, v128, v165 neg_lo:[0,0,1] neg_hi:[0,0,1]
  v_pk_fma_f16 v209, v209, v129, v167 neg_lo:[0,0,1] neg_hi:[0,0,1]
  v_pk_fma_f16 v210, v210, v130, v169 neg_lo:[0,0,1] neg_hi:[0,0,1]
  v_pk_fma_f16 v211, v211, v131, v171 neg_lo:[0,0,1] neg_hi:[0,0,1]
  v_mfma_f32_32x32x16_f16 v[184:199], v[200:203], v[112:115], 0
  v_mfma_f32_32x32x16_f16 v[80:95], v[200:203], v[96:99], 0
  v_mfma_f32_32x32x16_f16 v[184:199], v[208:211], v[120:123], v[184:199]
  v_mfma_f32_32x32x16_f16 v[80:95], v[208:211], v[104:107], v[80:95]
  v_pk_mul_f16 v164, v212, v148
  v_pk_mul_f16 v165, v204, v148
  v_pk_mul_f16 v166, v213, v149
  v_pk_mul_f16 v167, v205, v149
  v_pk_mul_f16 v168, v214, v150
  v_pk_mul_f16 v169, v206, v150
  v_pk_mul_f16 v170, v215, v151
  v_pk_mul_f16 v171, v207, v151
  v_pk_fma_f16 v204, v204, v132, v164
  v_pk_fma_f16 v205, v205, v133, v166
  v_pk_fma_f16 v206, v206, v134, v168
  v_pk_fma_f16 v207, v207, v135, v170
  v_pk_fma_f16 v212, v212, v132, v165 neg_lo:[0,0,1] neg_hi:[0,0,1]
  v_pk_fma_f16 v213, v213, v133, v167 neg_lo:[0,0,1] neg_hi:[0,0,1]
  v_pk_fma_f16 v214, v214, v134, v169 neg_lo:[0,0,1] neg_hi:[0,0,1]
  v_pk_fma_f16 v215, v215, v135, v171 neg_lo:[0,0,1] neg_hi:[0,0,1]
  v_mfma_f32_32x32x16_f16 v[184:199], v[204:207], v[116:119], v[184:199]
  v_mfma_f32_32x32x16_f16 v[80:95], v[204:207], v[100:103], v[80:95]
  v_mfma_f32_32x32x16_f16 v[184:199], v[212:215], v[124:127], v[184:199]
  v_mfma_f32_32x32x16_f16 v[80:95], v[212:215], v[108:111], v[80:95]
  v_pk_mul_f16 v164, v224, v144
  v_pk_mul_f16 v165, v216, v144
  v_pk_mul_f16 v166, v225, v145
  v_pk_mul_f16 v167, v217, v145
  v_pk_mul_f16 v168, v226, v146
  v_pk_mul_f16 v169, v218, v146
  v_pk_mul_f16 v170, v227, v147
  v_pk_mul_f16 v171, v219, v147
  v_pk_fma_f16 v216, v216, v128, v164
  v_pk_fma_f16 v217, v217, v129, v166
  v_pk_fma_f16 v218, v218, v130, v168
  v_pk_fma_f16 v219, v219, v131, v170
  v_pk_fma_f16 v224, v224, v128, v165 neg_lo:[0,0,1] neg_hi:[0,0,1]
  v_pk_fma_f16 v225, v225, v129, v167 neg_lo:[0,0,1] neg_hi:[0,0,1]
  v_pk_fma_f16 v226, v226, v130, v169 neg_lo:[0,0,1] neg_hi:[0,0,1]
  v_pk_fma_f16 v227, v227, v131, v171 neg_lo:[0,0,1] neg_hi:[0,0,1]
  v_mfma_f32_32x32x16_f16 v[24:39], v[216:219], v[112:115], 0
  v_mfma_f32_32x32x16_f16 v[8:23], v[216:219], v[96:99], 0
  v_mfma_f32_32x32x16_f16 v[24:39], v[224:227], v[120:123], v[24:39]
  v_mfma_f32_32x32x16_f16 v[8:23], v[224:227], v[104:107], v[8:23]
  buffer_store_dword v236, v238, s[8:11], s31 offen offset:64 sc1
  v_cndmask_b32 v80, v80, v184, s[28:29]
  v_cvt_pk_f16_f32 v80, v80, v81
  v_cvt_pk_f16_f32 v81, v82, v83
  v_cvt_pk_f16_f32 v82, v84, v85
  v_cvt_pk_f16_f32 v83, v86, v87
  v_cvt_pk_f16_f32 v84, v88, v89
  v_cvt_pk_f16_f32 v85, v90, v91
  v_cvt_pk_f16_f32 v86, v92, v93
  v_cvt_pk_f16_f32 v87, v94, v95
  s_nop 1
  v_permlane16_swap_b32 v80, v84
  v_permlane16_swap_b32 v81, v85
  v_permlane16_swap_b32 v82, v86
  v_permlane16_swap_b32 v83, v87
  buffer_store_dwordx4 v[80:83], v237, s[8:11], s58 offen sc1
  buffer_store_dwordx4 v[84:87], v246, s[8:11], s58 offen sc1
  v_pk_mul_f16 v164, v228, v148
  v_pk_mul_f16 v165, v220, v148
  v_pk_mul_f16 v166, v229, v149
  v_pk_mul_f16 v167, v221, v149
  v_pk_mul_f16 v168, v230, v150
  v_pk_mul_f16 v169, v222, v150
  v_pk_mul_f16 v170, v231, v151
  v_pk_mul_f16 v171, v223, v151
  v_pk_fma_f16 v220, v220, v132, v164
  v_pk_fma_f16 v221, v221, v133, v166
  v_pk_fma_f16 v222, v222, v134, v168
  v_pk_fma_f16 v223, v223, v135, v170
  v_pk_fma_f16 v228, v228, v132, v165 neg_lo:[0,0,1] neg_hi:[0,0,1]
  v_pk_fma_f16 v229, v229, v133, v167 neg_lo:[0,0,1] neg_hi:[0,0,1]
  v_pk_fma_f16 v230, v230, v134, v169 neg_lo:[0,0,1] neg_hi:[0,0,1]
  v_pk_fma_f16 v231, v231, v135, v171 neg_lo:[0,0,1] neg_hi:[0,0,1]
  v_mfma_f32_32x32x16_f16 v[24:39], v[220:223], v[116:119], v[24:39]
  v_mfma_f32_32x32x16_f16 v[8:23], v[220:223], v[100:103], v[8:23]
  v_mfma_f32_32x32x16_f16 v[24:39], v[228:231], v[124:127], v[24:39]
  v_mfma_f32_32x32x16_f16 v[8:23], v[228:231], v[108:111], v[8:23]
  s_nop 11
  v_cndmask_b32 v8, v8, v24, s[28:29]
  v_cvt_pk_f16_f32 v8, v8, v9
  v_cvt_pk_f16_f32 v9, v10, v11
  v_cvt_pk_f16_f32 v10, v12, v13
  v_cvt_pk_f16_f32 v11, v14, v15
  v_cvt_pk_f16_f32 v12, v16, v17
  v_cvt_pk_f16_f32 v13, v18, v19
  v_cvt_pk_f16_f32 v14, v20, v21
  v_cvt_pk_f16_f32 v15, v22, v23
  s_nop 1
  v_permlane16_swap_b32 v8, v12
  v_permlane16_swap_b32 v9, v13
  v_permlane16_swap_b32 v10, v14
  v_permlane16_swap_b32 v11, v15
  buffer_store_dwordx4 v[8:11], v237, s[8:11], s59 offen sc1
  buffer_store_dwordx4 v[12:15], v246, s[8:11], s59 offen sc1
  s_lshl_b32 s3, s36, 9
  s_add_u32 s52, s3, s37
  v_lshl_add_u32 v6, v249, 4, s52
  s_waitcnt vmcnt(6)
  s_mov_b32 s47, 262144
sequential_preLN__spectral_fnet__dense_activation_squared_relu__prompt_kernel_nspin2:
  v_readfirstlane_b32 s42, v244
  v_readfirstlane_b32 s43, v245
  s_sub_u32 s47, s47, 1
  s_cbranch_scc1 sequential_preLN__spectral_fnet__dense_activation_squared_relu__prompt_kernel_nok3
  s_cmp_lg_u32 s42, 0
  s_cbranch_scc1 sequential_preLN__spectral_fnet__dense_activation_squared_relu__prompt_kernel_nok3
  s_sleep 1
  buffer_load_dwordx2 v[244:245], v247, s[24:27], 0 offen sc1
  s_waitcnt vmcnt(0)
  s_branch sequential_preLN__spectral_fnet__dense_activation_squared_relu__prompt_kernel_nspin2
sequential_preLN__spectral_fnet__dense_activation_squared_relu__prompt_kernel_nok3:
  s_cmp_eq_u32 s41, 0
  s_cselect_b32 s16, 0xffff, 0
  s_mov_b32 s17, 0
  v_sub_u32 v244, 2048, v6
  v_and_b32 v244, 2047, v244
  v_sub_u32 v245, 1792, v6
  v_and_b32 v245, 2047, v245
  v_cvt_f32_u32 v232, v6
  v_cvt_f32_u32 v236, v250
  v_mul_f32 v232, 0x3a000000, v232
  v_add_f32 v233, 0x3e000000, v232
  v_mul_f32 v236, 4.0, v236
  v_mul_f32 v234, v232, v236
  v_mul_f32 v235, v233, v236
  v_fmamk_f32 v72, v232, 0x0, v234
  v_fmamk_f32 v73, v232, 0x3f800000, v234
  v_fmamk_f32 v74, v232, 0x40000000, v234
  v_fmamk_f32 v75, v232, 0x40400000, v234
  v_fmamk_f32 v76, v232, 0x41800000, v234
  v_fmamk_f32 v77, v232, 0x41880000, v234
  v_fmamk_f32 v78, v232, 0x41900000, v234
  v_fmamk_f32 v79, v232, 0x41980000, v234
  v_sin_f32 v80, v72
  v_sin_f32 v81, v73
  v_sin_f32 v82, v74
  v_sin_f32 v83, v75
  v_sin_f32 v84, v76
  v_sin_f32 v85, v77
  v_sin_f32 v86, v78
  v_sin_f32 v87, v79
  v_cos_f32 v72, v72
  v_cos_f32 v73, v73
  v_cos_f32 v74, v74
  v_cos_f32 v75, v75
  v_cos_f32 v76, v76
  v_cos_f32 v77, v77
  v_cos_f32 v78, v78
  v_cos_f32 v79, v79
  v_cvt_pk_f16_f32 v40, v80, v81
  v_cvt_pk_f16_f32 v41, v82, v83
  v_cvt_pk_f16_f32 v42, v84, v85
  v_cvt_pk_f16_f32 v43, v86, v87
  v_cvt_pk_f16_f32 v8, v72, v73
  v_cvt_pk_f16_f32 v9, v74, v75
  v_cvt_pk_f16_f32 v10, v76, v77
  v_cvt_pk_f16_f32 v11, v78, v79
  v_fmamk_f32 v88, v233, 0x0, v235
  v_fmamk_f32 v89, v233, 0x3f800000, v235
  v_fmamk_f32 v90, v233, 0x40000000, v235
  v_fmamk_f32 v91, v233, 0x40400000, v235
  v_fmamk_f32 v92, v233, 0x41800000, v235
  v_fmamk_f32 v93, v233, 0x41880000, v235
  v_fmamk_f32 v94, v233, 0x41900000, v235
  v_fmamk_f32 v95, v233, 0x41980000, v235
  v_sin_f32 v96, v88
  v_sin_f32 v97, v89
  v_sin_f32 v98, v90
  v_sin_f32 v99, v91
  v_sin_f32 v100, v92
  v_sin_f32 v101, v93
  v_sin_f32 v102, v94
  v_sin_f32 v103, v95
  v_cos_f32 v88, v88
  v_cos_f32 v89, v89
  v_cos_f32 v90, v90
  v_cos_f32 v91, v91
  v_cos_f32 v92, v92
  v_cos_f32 v93, v93
  v_cos_f32 v94, v94
  v_cos_f32 v95, v95
  v_cvt_pk_f16_f32 v44, v96, v97
  v_cvt_pk_f16_f32 v45, v98, v99
  v_cvt_pk_f16_f32 v46, v100, v101
  v_cvt_pk_f16_f32 v47, v102, v103
  v_cvt_pk_f16_f32 v12, v88, v89
  v_cvt_pk_f16_f32 v13, v90, v91
  v_cvt_pk_f16_f32 v14, v92, v93
  v_cvt_pk_f16_f32 v15, v94, v95
  v_fmamk_f32 v72, v232, 0x42000000, v234
  v_fmamk_f32 v73, v232, 0x42040000, v234
  v_fmamk_f32 v74, v232, 0x42080000, v234
  v_fmamk_f32 v75, v232, 0x420c0000, v234
  v_fmamk_f32 v76, v232, 0x42400000, v234
  v_fmamk_f32 v77, v232, 0x42440000, v234
  v_fmamk_f32 v78, v232, 0x42480000, v234
  v_fmamk_f32 v79, v232, 0x424c0000, v234
  v_sin_f32 v80, v72
  v_sin_f32 v81, v73
  v_sin_f32 v82, v74
  v_sin_f32 v83, v75
  v_sin_f32 v84, v76
  v_sin_f32 v85, v77
  v_sin_f32 v86, v78
  v_sin_f32 v87, v79
  v_cos_f32 v72, v72
  v_cos_f32 v73, v73
  v_cos_f32 v74, v74
  v_cos_f32 v75, v75
  v_cos_f32 v76, v76
  v_cos_f32 v77, v77
  v_cos_f32 v78, v78
  v_cos_f32 v79, v79
  v_cvt_pk_f16_f32 v48, v80, v81
  v_cvt_pk_f16_f32 v49, v82, v83
  v_cvt_pk_f16_f32 v50, v84, v85
  v_cvt_pk_f16_f32 v51, v86, v87
  v_cvt_pk_f16_f32 v16, v72, v73
  v_cvt_pk_f16_f32 v17, v74, v75
  v_cvt_pk_f16_f32 v18, v76, v77
  v_cvt_pk_f16_f32 v19, v78, v79
  v_fmamk_f32 v88, v233, 0x42000000, v235
  v_fmamk_f32 v89, v233, 0x42040000, v235
  v_fmamk_f32 v90, v233, 0x42080000, v235
  v_fmamk_f32 v91, v233, 0x420c0000, v235
  v_fmamk_f32 v92, v233, 0x42400000, v235
  v_fmamk_f32 v93, v233, 0x42440000, v235
  v_fmamk_f32 v94, v233, 0x42480000, v235
  v_fmamk_f32 v95, v233, 0x424c0000, v235
  v_sin_f32 v96, v88
  v_sin_f32 v97, v89
  v_sin_f32 v98, v90
  v_sin_f32 v99, v91
  v_sin_f32 v100, v92
  v_sin_f32 v101, v93
  v_sin_f32 v102, v94
  v_sin_f32 v103, v95
  v_cos_f32 v88, v88
  v_cos_f32 v89, v89
  v_cos_f32 v90, v90
  v_cos_f32 v91, v91
  v_cos_f32 v92, v92
  v_cos_f32 v93, v93
  v_cos_f32 v94, v94
  v_cos_f32 v95, v95
  v_cvt_pk_f16_f32 v52, v96, v97
  v_cvt_pk_f16_f32 v53, v98, v99
  v_cvt_pk_f16_f32 v54, v100, v101
  v_cvt_pk_f16_f32 v55, v102, v103
  v_cvt_pk_f16_f32 v20, v88, v89
  v_cvt_pk_f16_f32 v21, v90, v91
  v_cvt_pk_f16_f32 v22, v92, v93
  v_cvt_pk_f16_f32 v23, v94, v95
  s_waitcnt vmcnt(0)
  s_barrier
  s_cmp_lg_u32 s36, 3
  s_cbranch_scc1 sequential_preLN__spectral_fnet__dense_activation_squared_relu__prompt_kernel_sig4
  v_mov_b32 v240, s42
  v_mov_b32 v241, s43
  s_mov_b64 exec, 15
  buffer_store_dwordx4 v[240:243], v251, s[8:11], s31 offen sc1
  s_mov_b64 exec, -1
sequential_preLN__spectral_fnet__dense_activation_squared_relu__prompt_kernel_sig4:
  s_lshl_b32 s3, s36, 9
  s_add_u32 s3, s3, s37
  v_lshl_add_u32 v104, v249, 4, s3
  v_lshlrev_b32 v106, 3, v250
  s_lshl_b32 s3, s41, 6
  v_add_u32 v106, s3, v106
  v_lshl_add_u32 v107, v104, 11, v106
  v_cmp_eq_u32 vcc, 0, v106
  v_mov_b32 v112, 0x40000000
  s_mov_b32 s3, 524288
  v_sub_u32 v105, 2048, v104
  v_and_b32 v105, 2047, v105
  v_lshlrev_b32 v110, 11, v105
  v_sub_u32 v108, v110, v106
  v_add_u32 v108, 2008, v108
  v_cndmask_b32 v110, v112, v110, vcc
  v_sub_u32 v105, 1792, v104
  v_and_b32 v105, 2047, v105
  v_lshlrev_b32 v111, 11, v105
  v_sub_u32 v109, v111, v106
  v_add_u32 v109, 2008, v109
  v_cndmask_b32 v111, v112, v111, vcc
  buffer_load_dwordx2 a[0:1], v107, s[4:7], 0 offen offset:0
  buffer_load_dwordx2 a[2:3], v107, s[4:7], 0 offen offset:32
  buffer_load_dwordx2 a[4:5], v107, s[4:7], s3 offen offset:0
  buffer_load_dwordx2 a[6:7], v107, s[4:7], s3 offen offset:32
  buffer_load_dwordx3 a[8:10], v108, s[4:7], 0 offen offset:32
  buffer_load_dwordx3 a[12:14], v108, s[4:7], 0 offen offset:0
  buffer_load_dword a11, v110, s[4:7], 0 offen offset:1024
  buffer_load_dwordx3 a[16:18], v109, s[4:7], 0 offen offset:32
  buffer_load_dwordx3 a[20:22], v109, s[4:7], 0 offen offset:0
  buffer_load_dword a19, v111, s[4:7], 0 offen offset:1024
  v_fmamk_f32 v72, v232, 0x42800000, v234
  v_fmamk_f32 v73, v232, 0x42820000, v234
  v_fmamk_f32 v74, v232, 0x42840000, v234
  v_fmamk_f32 v75, v232, 0x42860000, v234
  v_fmamk_f32 v76, v232, 0x42a00000, v234
  v_fmamk_f32 v77, v232, 0x42a20000, v234
  v_fmamk_f32 v78, v232, 0x42a40000, v234
  v_fmamk_f32 v79, v232, 0x42a60000, v234
  v_sin_f32 v80, v72
  v_sin_f32 v81, v73
  v_sin_f32 v82, v74
  v_sin_f32 v83, v75
  v_sin_f32 v84, v76
  v_sin_f32 v85, v77
  v_sin_f32 v86, v78
  v_sin_f32 v87, v79
  v_cos_f32 v72, v72
  v_cos_f32 v73, v73
  v_cos_f32 v74, v74
  v_cos_f32 v75, v75
  v_cos_f32 v76, v76
  v_cos_f32 v77, v77
  v_cos_f32 v78, v78
  v_cos_f32 v79, v79
  v_cvt_pk_f16_f32 v56, v80, v81
  v_cvt_pk_f16_f32 v57, v82, v83
  v_cvt_pk_f16_f32 v58, v84, v85
  v_cvt_pk_f16_f32 v59, v86, v87
  v_cvt_pk_f16_f32 v24, v72, v73
  v_cvt_pk_f16_f32 v25, v74, v75
  v_cvt_pk_f16_f32 v26, v76, v77
  v_cvt_pk_f16_f32 v27, v78, v79
  v_fmamk_f32 v88, v233, 0x42800000, v235
  v_fmamk_f32 v89, v233, 0x42820000, v235
  v_fmamk_f32 v90, v233, 0x42840000, v235
  v_fmamk_f32 v91, v233, 0x42860000, v235
  v_fmamk_f32 v92, v233, 0x42a00000, v235
  v_fmamk_f32 v93, v233, 0x42a20000, v235
  v_fmamk_f32 v94, v233, 0x42a40000, v235
  v_fmamk_f32 v95, v233, 0x42a60000, v235
  v_sin_f32 v96, v88
  v_sin_f32 v97, v89
  v_sin_f32 v98, v90
  v_sin_f32 v99, v91
  v_sin_f32 v100, v92
  v_sin_f32 v101, v93
  v_sin_f32 v102, v94
  v_sin_f32 v103, v95
  v_cos_f32 v88, v88
  v_cos_f32 v89, v89
  v_cos_f32 v90, v90
  v_cos_f32 v91, v91
  v_cos_f32 v92, v92
  v_cos_f32 v93, v93
  v_cos_f32 v94, v94
  v_cos_f32 v95, v95
  v_cvt_pk_f16_f32 v60, v96, v97
  v_cvt_pk_f16_f32 v61, v98, v99
  v_cvt_pk_f16_f32 v62, v100, v101
  v_cvt_pk_f16_f32 v63, v102, v103
  v_cvt_pk_f16_f32 v28, v88, v89
  v_cvt_pk_f16_f32 v29, v90, v91
  v_cvt_pk_f16_f32 v30, v92, v93
  v_cvt_pk_f16_f32 v31, v94, v95
  v_fmamk_f32 v72, v232, 0x42c00000, v234
  v_fmamk_f32 v73, v232, 0x42c20000, v234
  v_fmamk_f32 v74, v232, 0x42c40000, v234
  v_fmamk_f32 v75, v232, 0x42c60000, v234
  v_fmamk_f32 v76, v232, 0x42e00000, v234
  v_fmamk_f32 v77, v232, 0x42e20000, v234
  v_fmamk_f32 v78, v232, 0x42e40000, v234
  v_fmamk_f32 v79, v232, 0x42e60000, v234
  v_sin_f32 v80, v72
  v_sin_f32 v81, v73
  v_sin_f32 v82, v74
  v_sin_f32 v83, v75
  v_sin_f32 v84, v76
  v_sin_f32 v85, v77
  v_sin_f32 v86, v78
  v_sin_f32 v87, v79
  v_cos_f32 v72, v72
  v_cos_f32 v73, v73
  v_cos_f32 v74, v74
  v_cos_f32 v75, v75
  v_cos_f32 v76, v76
  v_cos_f32 v77, v77
  v_cos_f32 v78, v78
  v_cos_f32 v79, v79
  v_cvt_pk_f16_f32 v64, v80, v81
  v_cvt_pk_f16_f32 v65, v82, v83
  v_cvt_pk_f16_f32 v66, v84, v85
  v_cvt_pk_f16_f32 v67, v86, v87
  v_cvt_pk_f16_f32 v32, v72, v73
  v_cvt_pk_f16_f32 v33, v74, v75
  v_cvt_pk_f16_f32 v34, v76, v77
  v_cvt_pk_f16_f32 v35, v78, v79
  v_fmamk_f32 v88, v233, 0x42c00000, v235
  v_fmamk_f32 v89, v233, 0x42c20000, v235
  v_fmamk_f32 v90, v233, 0x42c40000, v235
  v_fmamk_f32 v91, v233, 0x42c60000, v235
  v_fmamk_f32 v92, v233, 0x42e00000, v235
  v_fmamk_f32 v93, v233, 0x42e20000, v235
  v_fmamk_f32 v94, v233, 0x42e40000, v235
  v_fmamk_f32 v95, v233, 0x42e60000, v235
  v_sin_f32 v96, v88
  v_sin_f32 v97, v89
  v_sin_f32 v98, v90
  v_sin_f32 v99, v91
  v_sin_f32 v100, v92
  v_sin_f32 v101, v93
  v_sin_f32 v102, v94
  v_sin_f32 v103, v95
  v_cos_f32 v88, v88
  v_cos_f32 v89, v89
  v_cos_f32 v90, v90
  v_cos_f32 v91, v91
  v_cos_f32 v92, v92
  v_cos_f32 v93, v93
  v_cos_f32 v94, v94
  v_cos_f32 v95, v95
  v_cvt_pk_f16_f32 v68, v96, v97
  v_cvt_pk_f16_f32 v69, v98, v99
  v_cvt_pk_f16_f32 v70, v100, v101
  v_cvt_pk_f16_f32 v71, v102, v103
  v_cvt_pk_f16_f32 v36, v88, v89
  v_cvt_pk_f16_f32 v37, v90, v91
  v_cvt_pk_f16_f32 v38, v92, v93
  v_cvt_pk_f16_f32 v39, v94, v95
  v_lshrrev_b32 v220, 2, v248
  v_and_b32 v221, 3, v248
  v_and_b32 v222, 1, v250
  v_lshlrev_b32 v222, 1, v222
  v_xor_b32 v221, v221, v222
  v_lshlrev_b32 v220, 6, v220
  v_lshl_add_u32 v7, v221, 4, v220
  s_lshl_b32 s23, s37, 18
  s_lshl_b32 s3, s41, 14
  s_add_u32 s23, s23, s3
  s_lshl_b32 s3, s36, 12
  s_add_u32 s23, s23, s3
  s_add_u32 s28, s3, 135168
  s_sub_u32 s3, 16, s37
  s_min_u32 s3, s3, s37
  s_bfe_u32 s30, s3, 0x10002
  s_lshl_b32 s30, s30, 14
  s_add_u32 s30, s30, 4194304
  s_and_b32 s3, s3, 3
  s_lshl_b32 s3, s3, 4
  s_add_u32 s29, s30, s3
  v_lshlrev_b32 v224, 7, v248
  v_add_u32 v225, 0x2000, v224
  v_and_b32 v229, 127, v6
  v_lshlrev_b32 v229, 7, v229
  v_lshrrev_b32 v228, 7, v6
  v_lshl_add_u32 v229, v228, 2, v229
  v_and_b32 v230, 127, v244
  v_lshlrev_b32 v230, 7, v230
  v_lshrrev_b32 v228, 7, v244
  v_lshl_add_u32 v230, v228, 2, v230
  v_and_b32 v231, 127, v245
  v_lshlrev_b32 v231, 7, v231
  v_lshrrev_b32 v228, 7, v245
  v_lshl_add_u32 v231, v228, 2, v231
  v_and_b32 v226, 32, v248
  v_lshlrev_b32 v226, 1, v226
  v_bfe_u32 v227, v248, 2, 2
  v_lshl_add_u32 v226, v227, 4, v226
  v_bfe_u32 v227, v248, 4, 1
  v_lshl_add_u32 v226, v227, 3, v226
  v_and_b32 v227, 3, v248
  v_lshl_add_u32 v226, v227, 1, v226
  v_add_u32 v226, 152640, v226
  v_lshlrev_b32 v227, 4, v250
  v_add_u32 v227, 152640, v227
  s_cmp_ge_u32 s37, 8
  s_cselect_b64 s[18:19], -1, 0
  s_mul_i32 s56, s36, 4224
  s_bitcmp1_b32 s39, 0
  s_cselect_b32 s84, 192, 0
  s_cselect_b32 s85, 0, 256
  s_cmp_eq_u32 s36, 3
  s_cbranch_scc1 sequential_preLN__spectral_fnet__dense_activation_squared_relu__prompt_kernel_pf3w5
  s_mov_b32 s32, s92
  s_and_b32 s33, s93, 0xffff
  s_mov_b32 s34, 3670016
  s_mov_b32 s35, 0x20000
  s_mul_i32 s3, s2, 3
  s_add_u32 s3, s3, s36
  s_mul_i32 s3, s3, 4864
  s_add_u32 s3, s3, 0
  v_lshlrev_b32 v220, 7, v248
  v_cmp_gt_u32 vcc, 38, v248
  v_mov_b32 v221, 0x40000000
  s_nop 0
  v_cndmask_b32 v220, v221, v220, vcc
  buffer_load_dword a255, v220, s[32:35], s3 offen
sequential_preLN__spectral_fnet__dense_activation_squared_relu__prompt_kernel_pf3w5:
  s_cmp_lg_u32 s36, 3
  s_cbranch_scc1 sequential_preLN__spectral_fnet__dense_activation_squared_relu__prompt_kernel_pskip6
  buffer_load_dwordx4 v[184:187], v224, s[8:11], s29 offen sc1
  buffer_load_dwordx4 v[188:191], v225, s[8:11], s29 offen sc1
  s_waitcnt vmcnt(0)
  s_mov_b32 s47, 262144
sequential_preLN__spectral_fnet__dense_activation_squared_relu__prompt_kernel_poll7:
  v_cmp_ne_u64 vcc, s[42:43], v[184:185]
  v_cmp_ne_u64 s[48:49], s[42:43], v[188:189]
  s_nop 1
  s_or_b64 s[44:45], vcc, s[48:49]
  s_cbranch_scc0 sequential_preLN__spectral_fnet__dense_activation_squared_relu__prompt_kernel_pok8
  s_sub_u32 s47, s47, 1
  s_cbranch_scc1 sequential_preLN__spectral_fnet__dense_activation_squared_relu__prompt_kernel_pok8
  s_sleep 1
  s_mov_b64 exec, vcc
  buffer_load_dwordx4 v[184:187], v224, s[8:11], s29 offen sc1
  s_mov_b64 exec, s[48:49]
  buffer_load_dwordx4 v[188:191], v225, s[8:11], s29 offen sc1
  s_mov_b64 exec, -1
  s_waitcnt vmcnt(0)
  s_branch sequential_preLN__spectral_fnet__dense_activation_squared_relu__prompt_kernel_poll7
sequential_preLN__spectral_fnet__dense_activation_squared_relu__prompt_kernel_pok8:
  v_cndmask_b32 v186, v186, v187, s[18:19]
  ds_write_b16 v226, v186 offset:0
  ds_write_b16_d16_hi v226, v186 offset:256
  v_cndmask_b32 v190, v190, v191, s[18:19]
  ds_write_b16 v226, v190 offset:128
  ds_write_b16_d16_hi v226, v190 offset:384
  s_waitcnt lgkmcnt(0)
sequential_preLN__spectral_fnet__dense_activation_squared_relu__prompt_kernel_pskip6:
  s_barrier
  s_mov_b32 m0, s28
  s_mul_i32 s44, s36, 3072
  buffer_load_dwordx4 v7, s[8:11], s23 offen offset:0 sc1 lds
  buffer_load_dwordx4 v7, s[8:11], s23 offen offset:1024 sc1 lds
  buffer_load_dwordx4 v7, s[8:11], s23 offen offset:2048 sc1 lds
  buffer_load_dwordx4 v7, s[8:11], s23 offen offset:3072 sc1 lds
  buffer_load_dword v200, v229, s[8:11], s30 offen offset:64 sc1
  buffer_load_dword v202, v229, s[8:11], s30 offen offset:72 sc1
  buffer_load_dword v201, v230, s[8:11], s30 offen offset:64 sc1
  buffer_load_dword v203, v231, s[8:11], s30 offen offset:64 sc1
  ds_read_b128 v[184:187], v227 offset:0
  ds_read_b128 v[188:191], v227 offset:64
  ds_read_b128 v[192:195], v227 offset:128
  s_waitcnt lgkmcnt(2)
  v_mfma_f32_16x16x32_f16 v[176:179], v[184:187], v[8:11], 0
  v_mfma_f32_16x16x32_f16 v[180:183], v[184:187], v[12:15], 0
  ds_read_b128 v[196:199], v227 offset:192
  s_waitcnt lgkmcnt(2)
  v_mfma_f32_16x16x32_f16 v[176:179], v[188:191], v[16:19], v[176:179]
  v_mfma_f32_16x16x32_f16 v[180:183], v[188:191], v[20:23], v[180:183]
  ds_read_b128 v[184:187], v227 offset:256
  s_waitcnt lgkmcnt(2)
  v_mfma_f32_16x16x32_f16 v[176:179], v[192:195], v[24:27], v[176:179]
  v_mfma_f32_16x16x32_f16 v[180:183], v[192:195], v[28:31], v[180:183]
  ds_read_b128 v[188:191], v227 offset:320
  s_waitcnt lgkmcnt(2)
  v_mfma_f32_16x16x32_f16 v[176:179], v[196:199], v[32:35], v[176:179]
  v_mfma_f32_16x16x32_f16 v[180:183], v[196:199], v[36:39], v[180:183]
  ds_read_b128 v[192:195], v227 offset:384
  s_waitcnt lgkmcnt(2)
  v_mfma_f32_16x16x32_f16 v[176:179], v[184:187], v[40:43], v[176:179]
  v_mfma_f32_16x16x32_f16 v[180:183], v[184:187], v[44:47], v[180:183]
  ds_read_b128 v[196:199], v227 offset:448
  s_waitcnt lgkmcnt(2)
  v_mfma_f32_16x16x32_f16 v[176:179], v[188:191], v[48:51], v[176:179]
  v_mfma_f32_16x16x32_f16 v[180:183], v[188:191], v[52:55], v[180:183]
  s_waitcnt lgkmcnt(1)
  v_mfma_f32_16x16x32_f16 v[176:179], v[192:195], v[56:59], v[176:179]
  v_mfma_f32_16x16x32_f16 v[180:183], v[192:195], v[60:63], v[180:183]
  s_waitcnt lgkmcnt(0)
  v_mfma_f32_16x16x32_f16 v[176:179], v[196:199], v[64:67], v[176:179]
  v_mfma_f32_16x16x32_f16 v[180:183], v[196:199], v[68:71], v[180:183]
  v_and_b32 v228, 15, v244
  v_lshlrev_b32 v228, 2, v228
  v_lshrrev_b32 v229, 9, v244
  v_add_u32 v228, v228, v229
  v_bfe_u32 v229, v244, 8, 1
  v_bfe_u32 v230, v244, 4, 4
  v_lshl_add_u32 v231, v250, 4, v230
  v_lshlrev_b32 v231, 4, v231
  v_lshl_add_u32 v231, v229, 10, v231
  v_lshl_add_u32 v3, v228, 16, v231
  v_lshl_add_u32 v230, v229, 4, v230
  v_lshlrev_b32 v230, 2, v230
  v_lshl_add_u32 v230, v250, 9, v230
  v_lshl_add_u32 v242, v228, 12, v230
  v_and_b32 v228, 15, v245
  v_lshlrev_b32 v228, 2, v228
  v_lshrrev_b32 v229, 9, v245
  v_add_u32 v228, v228, v229
  v_bfe_u32 v229, v245, 8, 1
  v_bfe_u32 v230, v245, 4, 4
  v_lshl_add_u32 v231, v250, 4, v230
  v_lshlrev_b32 v231, 4, v231
  v_lshl_add_u32 v231, v229, 10, v231
  v_lshl_add_u32 v4, v228, 16, v231
  v_lshl_add_u32 v230, v229, 4, v230
  v_lshlrev_b32 v230, 2, v230
  v_lshl_add_u32 v230, v250, 9, v230
  v_lshl_add_u32 v243, v228, 12, v230
  v_and_b32 v222, 31, v248
  v_lshlrev_b32 v222, 2, v222
  v_lshrrev_b32 v223, 5, v248
  v_lshl_add_u32 v5, v223, 11, v222
  s_lshl_b32 s20, s40, 16
  s_lshl_b32 s21, s41, 11
  s_add_u32 s21, s21, 6291456
  s_add_u32 s20, s20, s21
  s_add_u32 s21, s21, 32768
  s_lshl_b32 s22, s40, 12
  s_lshl_b32 s3, s41, 7
  s_add_u32 s22, s22, s3
  s_add_u32 s22, s22, 4456448
  v_lshrrev_b32 v228, 2, v248
  v_lshlrev_b32 v228, 6, v228
  v_and_b32 v229, 3, v248
  v_lshl_add_u32 v228, v229, 3, v228
  v_and_b32 v229, 16, v248
  v_lshlrev_b32 v229, 1, v229
  v_add_u32 v228, 135168, v228
  v_add_u32 v1, v228, v229
  v_sub_u32 v2, v228, v229
  v_add_u32 v2, 32, v2
  s_lshr_b32 s3, s36, 1
  s_lshl_b32 s3, s3, 5
  s_and_b32 s48, s36, 1
  s_lshl_b32 s48, s48, 2
  s_add_u32 s3, s3, s48
  v_lshl_add_u32 v232, v250, 3, s3
  v_lshlrev_b32 v233, 4, v249
  v_mul_u32_u24 v234, 7168, v232
  s_mov_b32 s48, 0
  v_add3_u32 v204, v234, v233, s48
  s_mov_b32 s48, 455680
  v_sub_u32 v208, s48, v234
  v_add_u32 v208, v208, v233
  s_mov_b32 s48, 6112
  v_add3_u32 v205, v234, v233, s48
  s_mov_b32 s48, 447456
  v_sub_u32 v209, s48, v234
  v_add_u32 v209, v209, v233
  s_mov_b32 s48, 12224
  v_add3_u32 v206, v234, v233, s48
  s_mov_b32 s48, 439232
  v_sub_u32 v210, s48, v234
  v_add_u32 v210, v210, v233
  s_mov_b32 s48, 18336
  v_add3_u32 v207, v234, v233, s48
  s_mov_b32 s48, 431008
  v_sub_u32 v211, s48, v234
  v_add_u32 v211, v211, v233
  v_add_u32 v212, 6884352, v208
  v_add_u32 v234, 3670016, v233
  v_cmp_eq_u32 vcc, 0, v232
  s_mul_i32 s3, s36, 192
  v_add_u32 v232, s3, v248
  v_cndmask_b32 v212, v212, v234, vcc
  v_mul_u32_u24 v233, 43691, v232
  v_lshrrev_b32 v233, 19, v233
  v_mul_u32_u24 v234, 12, v233
  v_sub_u32 v234, v232, v234
  v_lshrrev_b32 v235, 1, v233
  v_and_b32 v235, 2, v235
  v_xor_b32 v234, v234, v235
  v_lshlrev_b32 v234, 4, v234
  v_mul_u32_u24 v235, 7168, v233
  v_add_u32 v213, v235, v234
  v_sub_u32 v235, 455680, v235
  v_add_u32 v216, v235, v234
  v_add_u32 v219, 6884352, v216
  v_add_u32 v235, 3670016, v234
  v_cmp_eq_u32 vcc, 0, v233
  s_nop 1
  v_cndmask_b32 v219, v219, v235, vcc
  v_add_u32 v232, 64, v232
  v_mul_u32_u24 v233, 43691, v232
  v_lshrrev_b32 v233, 19, v233
  v_mul_u32_u24 v234, 12, v233
  v_sub_u32 v234, v232, v234
  v_lshrrev_b32 v235, 1, v233
  v_and_b32 v235, 2, v235
  v_xor_b32 v234, v234, v235
  v_lshlrev_b32 v234, 4, v234
  v_mul_u32_u24 v235, 7168, v233
  v_add_u32 v214, v235, v234
  v_sub_u32 v235, 454656, v235
  v_add_u32 v217, v235, v234
  v_subrev_u32 v214, 1024, v214
  v_add_u32 v232, 64, v232
  v_mul_u32_u24 v233, 43691, v232
  v_lshrrev_b32 v233, 19, v233
  v_mul_u32_u24 v234, 12, v233
  v_sub_u32 v234, v232, v234
  v_lshrrev_b32 v235, 1, v233
  v_and_b32 v235, 2, v235
  v_xor_b32 v234, v234, v235
  v_lshlrev_b32 v234, 4, v234
  v_mul_u32_u24 v235, 7168, v233
  v_add_u32 v215, v235, v234
  v_sub_u32 v235, 453632, v235
  v_add_u32 v218, v235, v234
  v_subrev_u32 v215, 2048, v215
  s_waitcnt vmcnt(8)
  v_accvgpr_read_b32 v136, a0
  v_accvgpr_read_b32 v137, a1
  v_accvgpr_read_b32 v138, a2
  v_accvgpr_read_b32 v139, a3
  v_accvgpr_read_b32 v140, a4
  v_accvgpr_read_b32 v141, a5
  v_accvgpr_read_b32 v142, a6
  v_accvgpr_read_b32 v143, a7
  v_accvgpr_read_b32 v144, a8
  v_accvgpr_read_b32 v145, a9
  v_accvgpr_read_b32 v146, a10
  v_accvgpr_read_b32 v147, a11
  v_accvgpr_read_b32 v148, a12
  v_accvgpr_read_b32 v149, a13
  v_accvgpr_read_b32 v150, a14
  v_accvgpr_read_b32 v152, a16
  v_accvgpr_read_b32 v153, a17
  v_accvgpr_read_b32 v154, a18
  v_accvgpr_read_b32 v155, a19
  v_accvgpr_read_b32 v156, a20
  v_accvgpr_read_b32 v157, a21
  v_accvgpr_read_b32 v158, a22
  v_cndmask_b32 v146, v146, v147, s[16:17]
  v_cndmask_b32 v154, v154, v155, s[16:17]
  v_lshlrev_b32 v104, 16, v146
  v_and_b32 v105, 0xffff0000, v145
  v_lshlrev_b32 v106, 16, v145
  v_and_b32 v107, 0xffff0000, v144
  v_lshlrev_b32 v120, 16, v136
  v_and_b32 v121, 0xffff0000, v136
  v_lshlrev_b32 v122, 16, v137
  v_and_b32 v123, 0xffff0000, v137
  v_lshlrev_b32 v108, 16, v150
  v_and_b32 v109, 0xffff0000, v149
  v_lshlrev_b32 v110, 16, v149
  v_and_b32 v111, 0xffff0000, v148
  v_lshlrev_b32 v124, 16, v138
  v_and_b32 v125, 0xffff0000, v138
  v_lshlrev_b32 v126, 16, v139
  v_and_b32 v127, 0xffff0000, v139
  v_lshlrev_b32 v112, 16, v154
  v_and_b32 v113, 0xffff0000, v153
  v_lshlrev_b32 v114, 16, v153
  v_and_b32 v115, 0xffff0000, v152
  v_lshlrev_b32 v128, 16, v140
  v_and_b32 v129, 0xffff0000, v140
  v_lshlrev_b32 v130, 16, v141
  v_and_b32 v131, 0xffff0000, v141
  v_lshlrev_b32 v116, 16, v158
  v_and_b32 v117, 0xffff0000, v157
  v_lshlrev_b32 v118, 16, v157
  v_and_b32 v119, 0xffff0000, v156
  v_lshlrev_b32 v132, 16, v142
  v_and_b32 v133, 0xffff0000, v142
  v_lshlrev_b32 v134, 16, v143
  v_and_b32 v135, 0xffff0000, v143
  s_waitcnt vmcnt(0)
  s_barrier
  ds_read_b64_tr_b16 v[72:73], v1 offset:0
  ds_read_b64_tr_b16 v[74:75], v1 offset:1024
  ds_read_b64_tr_b16 v[76:77], v2 offset:0
  ds_read_b64_tr_b16 v[78:79], v2 offset:1024
  ds_read_b64_tr_b16 v[80:81], v1 offset:2048
  ds_read_b64_tr_b16 v[82:83], v1 offset:3072
  ds_read_b64_tr_b16 v[84:85], v2 offset:2048
  ds_read_b64_tr_b16 v[86:87], v2 offset:3072
  ds_read_b64_tr_b16 v[88:89], v1 offset:4096
  ds_read_b64_tr_b16 v[90:91], v1 offset:5120
  ds_read_b64_tr_b16 v[92:93], v2 offset:4096
  ds_read_b64_tr_b16 v[94:95], v2 offset:5120
  v_pk_add_f32 v[200:201], v[200:201], v[176:177]
  v_pk_add_f32 v[202:203], v[202:203], v[180:181]
  v_pk_add_f32 v[104:105], v[104:105], v[200:201] op_sel:[0,1] op_sel_hi:[1,1] neg_lo:[0,1] neg_hi:[0,1]
  v_pk_add_f32 v[106:107], v[106:107], v[200:201] op_sel:[0,1] op_sel_hi:[1,1] neg_lo:[0,1] neg_hi:[0,1]
  v_pk_add_f32 v[108:109], v[108:109], v[200:201] op_sel:[0,1] op_sel_hi:[1,1] neg_lo:[0,1] neg_hi:[0,1]
  v_pk_add_f32 v[110:111], v[110:111], v[200:201] op_sel:[0,1] op_sel_hi:[1,1] neg_lo:[0,1] neg_hi:[0,1]
  v_pk_add_f32 v[120:121], v[120:121], v[200:201] op_sel:[0,0] op_sel_hi:[1,0] neg_lo:[0,1] neg_hi:[0,1]
  v_pk_add_f32 v[122:123], v[122:123], v[200:201] op_sel:[0,0] op_sel_hi:[1,0] neg_lo:[0,1] neg_hi:[0,1]
  v_pk_add_f32 v[124:125], v[124:125], v[200:201] op_sel:[0,0] op_sel_hi:[1,0] neg_lo:[0,1] neg_hi:[0,1]
  v_pk_add_f32 v[126:127], v[126:127], v[200:201] op_sel:[0,0] op_sel_hi:[1,0] neg_lo:[0,1] neg_hi:[0,1]
  v_pk_add_f32 v[112:113], v[112:113], v[202:203] op_sel:[0,1] op_sel_hi:[1,1] neg_lo:[0,1] neg_hi:[0,1]
  v_pk_add_f32 v[114:115], v[114:115], v[202:203] op_sel:[0,1] op_sel_hi:[1,1] neg_lo:[0,1] neg_hi:[0,1]
  v_pk_add_f32 v[116:117], v[116:117], v[202:203] op_sel:[0,1] op_sel_hi:[1,1] neg_lo:[0,1] neg_hi:[0,1]
  v_pk_add_f32 v[118:119], v[118:119], v[202:203] op_sel:[0,1] op_sel_hi:[1,1] neg_lo:[0,1] neg_hi:[0,1]
  v_pk_add_f32 v[128:129], v[128:129], v[202:203] op_sel:[0,0] op_sel_hi:[1,0] neg_lo:[0,1] neg_hi:[0,1]
  v_pk_add_f32 v[130:131], v[130:131], v[202:203] op_sel:[0,0] op_sel_hi:[1,0] neg_lo:[0,1] neg_hi:[0,1]
  v_pk_add_f32 v[132:133], v[132:133], v[202:203] op_sel:[0,0] op_sel_hi:[1,0] neg_lo:[0,1] neg_hi:[0,1]
  v_pk_add_f32 v[134:135], v[134:135], v[202:203] op_sel:[0,0] op_sel_hi:[1,0] neg_lo:[0,1] neg_hi:[0,1]
  s_waitcnt lgkmcnt(8)
  v_mfma_f32_16x16x32_f16 v[160:163], v[72:75], v[8:11], 0
  v_mfma_f32_16x16x32_f16 v[164:167], v[72:75], v[12:15], 0
  v_mfma_f32_16x16x32_f16 v[168:171], v[76:79], v[8:11], 0
  v_mfma_f32_16x16x32_f16 v[172:175], v[76:79], v[12:15], 0
  ds_read_b64_tr_b16 v[96:97], v1 offset:6144
  ds_read_b64_tr_b16 v[98:99], v1 offset:7168
  ds_read_b64_tr_b16 v[100:101], v2 offset:6144
  ds_read_b64_tr_b16 v[102:103], v2 offset:7168
  s_add_u32 s52, s84, 0
  s_add_u32 m0, s56, 0
  s_nop 0
  buffer_load_dwordx4 v204, s[12:15], s52 offen offset:0 lds
  s_waitcnt lgkmcnt(8)
  v_mfma_f32_16x16x32_f16 v[160:163], v[80:83], v[16:19], v[160:163]
  v_mfma_f32_16x16x32_f16 v[164:167], v[80:83], v[20:23], v[164:167]
  v_mfma_f32_16x16x32_f16 v[168:171], v[84:87], v[16:19], v[168:171]
  v_mfma_f32_16x16x32_f16 v[172:175], v[84:87], v[20:23], v[172:175]
  ds_read_b64_tr_b16 v[72:73], v1 offset:8192
  ds_read_b64_tr_b16 v[74:75], v1 offset:9216
  ds_read_b64_tr_b16 v[76:77], v2 offset:8192
  ds_read_b64_tr_b16 v[78:79], v2 offset:9216
  s_nop 0
  buffer_load_dwordx4 v205, s[12:15], s52 offen offset:1056 lds
  s_waitcnt lgkmcnt(8)
  v_mfma_f32_16x16x32_f16 v[160:163], v[88:91], v[24:27], v[160:163]
  v_mfma_f32_16x16x32_f16 v[164:167], v[88:91], v[28:31], v[164:167]
  v_mfma_f32_16x16x32_f16 v[168:171], v[92:95], v[24:27], v[168:171]
  v_mfma_f32_16x16x32_f16 v[172:175], v[92:95], v[28:31], v[172:175]
  ds_read_b64_tr_b16 v[80:81], v1 offset:10240
  ds_read_b64_tr_b16 v[82:83], v1 offset:11264
  ds_read_b64_tr_b16 v[84:85], v2 offset:10240
  ds_read_b64_tr_b16 v[86:87], v2 offset:11264
  s_nop 0
  buffer_load_dwordx4 v206, s[12:15], s52 offen offset:2112 lds
  s_waitcnt lgkmcnt(8)
  v_mfma_f32_16x16x32_f16 v[160:163], v[96:99], v[32:35], v[160:163]
  v_mfma_f32_16x16x32_f16 v[164:167], v[96:99], v[36:39], v[164:167]
  v_mfma_f32_16x16x32_f16 v[168:171], v[100:103], v[32:35], v[168:171]
  v_mfma_f32_16x16x32_f16 v[172:175], v[100:103], v[36:39], v[172:175]
  ds_read_b64_tr_b16 v[88:89], v1 offset:12288
  ds_read_b64_tr_b16 v[90:91], v1 offset:13312
  ds_read_b64_tr_b16 v[92:93], v2 offset:12288
  ds_read_b64_tr_b16 v[94:95], v2 offset:13312
  s_nop 0
  buffer_load_dwordx4 v207, s[12:15], s52 offen offset:3168 lds
  s_waitcnt lgkmcnt(8)
  v_mfma_f32_16x16x32_f16 v[160:163], v[72:75], v[40:43], v[160:163]
  v_mfma_f32_16x16x32_f16 v[164:167], v[72:75], v[44:47], v[164:167]
  v_mfma_f32_16x16x32_f16 v[168:171], v[76:79], v[40:43], v[168:171]
  v_mfma_f32_16x16x32_f16 v[172:175], v[76:79], v[44:47], v[172:175]
  ds_read_b64_tr_b16 v[96:97], v1 offset:14336
  ds_read_b64_tr_b16 v[98:99], v1 offset:15360
  ds_read_b64_tr_b16 v[100:101], v2 offset:14336
  ds_read_b64_tr_b16 v[102:103], v2 offset:15360
  s_add_u32 s52, s84, 458752
  s_add_u32 m0, s56, 16896
  s_nop 0
  buffer_load_dwordx4 v204, s[12:15], s52 offen offset:0 lds
  s_waitcnt lgkmcnt(8)
  v_mfma_f32_16x16x32_f16 v[160:163], v[80:83], v[48:51], v[160:163]
  v_mfma_f32_16x16x32_f16 v[164:167], v[80:83], v[52:55], v[164:167]
  v_mfma_f32_16x16x32_f16 v[168:171], v[84:87], v[48:51], v[168:171]
  v_mfma_f32_16x16x32_f16 v[172:175], v[84:87], v[52:55], v[172:175]
  s_nop 0
  buffer_load_dwordx4 v205, s[12:15], s52 offen offset:1056 lds
  s_waitcnt lgkmcnt(4)
  v_mfma_f32_16x16x32_f16 v[160:163], v[88:91], v[56:59], v[160:163]
  v_mfma_f32_16x16x32_f16 v[164:167], v[88:91], v[60:63], v[164:167]
  v_mfma_f32_16x16x32_f16 v[168:171], v[92:95], v[56:59], v[168:171]
  v_mfma_f32_16x16x32_f16 v[172:175], v[92:95], v[60:63], v[172:175]
  s_nop 0
  buffer_load_dwordx4 v206, s[12:15], s52 offen offset:2112 lds
  s_waitcnt lgkmcnt(0)
  v_mfma_f32_16x16x32_f16 v[160:163], v[96:99], v[64:67], v[160:163]
  v_mfma_f32_16x16x32_f16 v[164:167], v[96:99], v[68:71], v[164:167]
  v_mfma_f32_16x16x32_f16 v[168:171], v[100:103], v[64:67], v[168:171]
  v_mfma_f32_16x16x32_f16 v[172:175], v[100:103], v[68:71], v[172:175]
  s_nop 0
  buffer_load_dwordx4 v207, s[12:15], s52 offen offset:3168 lds
  v_mov_b32 v252, v200
  v_mov_b32 v253, v202
  s_nop 5
  v_pk_add_f32 v[104:105], v[104:105], v[160:161]
  v_pk_add_f32 v[106:107], v[106:107], v[162:163]
  v_cvt_pk_bf16_f32 v16, v104, v105
  v_cvt_pk_bf16_f32 v17, v106, v107
  v_pk_add_f32 v[108:109], v[108:109], v[168:169]
  v_pk_add_f32 v[110:111], v[110:111], v[170:171]
  v_cvt_pk_bf16_f32 v18, v108, v109
  v_cvt_pk_bf16_f32 v19, v110, v111
  buffer_store_dwordx4 v[16:19], v3, s[8:11], s21 offen sc1
  v_cndmask_b32 v160, v160, 0, s[16:17]
  v_pk_add_f32 v[120:121], v[120:121], v[160:161]
  v_pk_add_f32 v[122:123], v[122:123], v[162:163]
  v_cvt_pk_bf16_f32 v8, v120, v121
  v_cvt_pk_bf16_f32 v9, v122, v123
  v_pk_add_f32 v[124:125], v[124:125], v[168:169]
  v_pk_add_f32 v[126:127], v[126:127], v[170:171]
  v_cvt_pk_bf16_f32 v10, v124, v125
  v_cvt_pk_bf16_f32 v11, v126, v127
  buffer_store_dwordx4 v[8:11], v251, s[8:11], s20 offen offset:0 sc1
  v_pk_add_f32 v[112:113], v[112:113], v[164:165]
  v_pk_add_f32 v[114:115], v[114:115], v[166:167]
  v_cvt_pk_bf16_f32 v20, v112, v113
  v_cvt_pk_bf16_f32 v21, v114, v115
  v_pk_add_f32 v[116:117], v[116:117], v[172:173]
  v_pk_add_f32 v[118:119], v[118:119], v[174:175]
  v_cvt_pk_bf16_f32 v22, v116, v117
  v_cvt_pk_bf16_f32 v23, v118, v119
  buffer_store_dwordx4 v[20:23], v4, s[8:11], s21 offen sc1
  v_cndmask_b32 v164, v164, 0, s[16:17]
  v_pk_add_f32 v[128:129], v[128:129], v[164:165]
  v_pk_add_f32 v[130:131], v[130:131], v[166:167]
  v_cvt_pk_bf16_f32 v12, v128, v129
  v_cvt_pk_bf16_f32 v13, v130, v131
  v_pk_add_f32 v[132:133], v[132:133], v[172:173]
  v_pk_add_f32 v[134:135], v[134:135], v[174:175]
  v_cvt_pk_bf16_f32 v14, v132, v133
  v_cvt_pk_bf16_f32 v15, v134, v135
  buffer_store_dwordx4 v[12:15], v251, s[8:11], s20 offen offset:1024 sc1
  v_pk_mul_f32 v[60:61], v[104:105], v[104:105]
  v_pk_fma_f32 v[60:61], v[106:107], v[106:107], v[60:61]
  v_pk_fma_f32 v[60:61], v[108:109], v[108:109], v[60:61]
  v_pk_fma_f32 v[60:61], v[110:111], v[110:111], v[60:61]
  v_pk_mul_f32 v[56:57], v[120:121], v[120:121]
  v_pk_fma_f32 v[56:57], v[122:123], v[122:123], v[56:57]
  v_pk_fma_f32 v[56:57], v[124:125], v[124:125], v[56:57]
  v_pk_fma_f32 v[56:57], v[126:127], v[126:127], v[56:57]
  v_pk_mul_f32 v[62:63], v[112:113], v[112:113]
  v_pk_fma_f32 v[62:63], v[114:115], v[114:115], v[62:63]
  v_pk_fma_f32 v[62:63], v[116:117], v[116:117], v[62:63]
  v_pk_fma_f32 v[62:63], v[118:119], v[118:119], v[62:63]
  v_pk_mul_f32 v[58:59], v[128:129], v[128:129]
  v_pk_fma_f32 v[58:59], v[130:131], v[130:131], v[58:59]
  v_pk_fma_f32 v[58:59], v[132:133], v[132:133], v[58:59]
  v_pk_fma_f32 v[58:59], v[134:135], v[134:135], v[58:59]
  v_add_f32 v56, v56, v57
  v_add_f32 v58, v58, v59
  v_add_f32 v60, v60, v61
  v_add_f32 v62, v62, v63
  s_nop 0
  v_permlane32_swap_b32 v56, v60
  v_permlane32_swap_b32 v58, v62
  v_add_f32 v56, v56, v60
  v_add_f32 v58, v58, v62
  s_nop 1
  v_permlane16_swap_b32 v56, v58
  v_add_f32 v56, v56, v58
  buffer_store_dword v56, v5, s[8:11], s22 offen sc1
  v_bfe_u32 v230, v248, 2, 3
  v_mul_u32_u24 v230, 1056, v230
  v_lshrrev_b32 v231, 5, v248
  v_lshl_add_u32 v230, v231, 8, v230
  v_and_b32 v232, 3, v248
  v_lshl_add_u32 v220, v232, 3, v230
  v_lshrrev_b32 v230, 2, v248
  v_mul_u32_u24 v230, 192, v230
  v_lshl_add_u32 v230, v232, 3, v230
  v_and_b32 v231, 16, v248
  v_lshlrev_b32 v231, 1, v231
  v_add_u32 v223, v230, v231
  v_sub_u32 v224, v230, v231
  v_add_u32 v221, 50688, v220
  v_add_u32 v225, 50688, v223
  v_add_u32 v226, 50688, v224
  v_add_u32 v222, 101376, v220
  v_add_u32 v227, 101376, v223
  v_add_u32 v228, 101376, v224
  s_lshl_b32 s3, s40, 16
  s_add_u32 s3, s3, 6291456
  s_add_u32 s16, s100, s3
  s_addc_u32 s17, s101, 0
  s_and_b32 s17, s17, 0xffff
  s_mov_b32 s18, 65536
  s_mov_b32 s19, 0x20000
  s_lshl_b32 s55, s37, 4
  s_add_u32 s55, s55, s41
  s_lshl_b32 s55, s55, 6
  s_add_u32 s54, s55, 4243456
  s_add_u32 s55, s55, 4227072
  s_mul_i32 s3, s40, 229376
  s_mul_i32 s48, s41, 14336
  s_add_u32 s3, s3, s48
  s_add_u32 s3, s3, 10485760
  s_add_u32 s20, s100, s3
  s_addc_u32 s21, s101, 0
  s_and_b32 s21, s21, 0xffff
  s_mov_b32 s22, 14336
  s_mov_b32 s23, 0x20000
  s_mov_b32 s24, s90
  s_and_b32 s25, s91, 0xffff
  s_mov_b32 s26, 7168
  s_mov_b32 s27, 0x20000
  s_mov_b32 s46, 4456448
  s_lshl_b32 s58, s40, 12
  s_add_u32 s58, s58, 4456448
  v_lshrrev_b32 v231, 3, v248
  v_and_b32 v232, 7, v248
  v_and_b32 v233, 6, v231
  v_xor_b32 v232, v232, v233
  v_lshlrev_b32 v232, 4, v232
  v_lshl_add_u32 v231, v231, 11, v232
  s_lshl_b32 s48, s36, 14
  v_add_u32 v241, s48, v231
  s_mul_i32 s3, s39, 458752
  v_add_u32 v240, s3, v241
  s_waitcnt vmcnt(0)
  s_barrier
  s_cmp_lg_u32 s36, 3
  s_cbranch_scc1 sequential_preLN__spectral_fnet__dense_activation_squared_relu__prompt_kernel_sig9
  v_mov_b32 v230, s42
  v_mov_b32 v231, s43
  v_mov_b32 v232, 0
  v_mov_b32 v233, 0
  s_mov_b64 exec, 15
  buffer_store_dwordx4 v[230:233], v251, s[8:11], s55 offen sc1
  s_mov_b64 exec, -1
sequential_preLN__spectral_fnet__dense_activation_squared_relu__prompt_kernel_sig9:
  s_barrier
  s_add_u32 s52, s84, 917504
  s_add_u32 m0, s56, 33792
  s_nop 0
  buffer_load_dwordx4 v204, s[12:15], s52 offen offset:0 lds
  s_nop 0
  buffer_load_dwordx4 v205, s[12:15], s52 offen offset:1056 lds
  s_nop 0
  buffer_load_dwordx4 v206, s[12:15], s52 offen offset:2112 lds
  s_nop 0
  buffer_load_dwordx4 v207, s[12:15], s52 offen offset:3168 lds
  s_add_u32 s52, s84, 1376256
  s_add_u32 m0, s56, 50688
  s_nop 0
  buffer_load_dwordx4 v204, s[12:15], s52 offen offset:0 lds
  s_nop 0
  buffer_load_dwordx4 v205, s[12:15], s52 offen offset:1056 lds
  s_nop 0
  buffer_load_dwordx4 v206, s[12:15], s52 offen offset:2112 lds
  s_nop 0
  buffer_load_dwordx4 v207, s[12:15], s52 offen offset:3168 lds
  s_add_u32 s52, s84, 1835008
  s_add_u32 m0, s56, 67584
  s_nop 0
  buffer_load_dwordx4 v204, s[12:15], s52 offen offset:0 lds
  s_nop 0
  buffer_load_dwordx4 v205, s[12:15], s52 offen offset:1056 lds
  s_nop 0
  buffer_load_dwordx4 v206, s[12:15], s52 offen offset:2112 lds
  s_nop 0
  buffer_load_dwordx4 v207, s[12:15], s52 offen offset:3168 lds
  s_add_u32 s52, s84, 2293760
  s_add_u32 m0, s56, 84480
  s_nop 0
  buffer_load_dwordx4 v204, s[12:15], s52 offen offset:0 lds
  s_nop 0
  buffer_load_dwordx4 v205, s[12:15], s52 offen offset:1056 lds
  s_nop 0
  buffer_load_dwordx4 v206, s[12:15], s52 offen offset:2112 lds
  s_nop 0
  buffer_load_dwordx4 v207, s[12:15], s52 offen offset:3168 lds
  s_sub_u32 s3, 16, s37
  s_and_b32 s3, s3, 15
  s_lshl_b32 s3, s3, 10
  s_lshl_b32 s48, s37, 10
  v_mov_b32 v230, s3
  v_mov_b32 v231, s48
  v_and_b32 v232, 1, v250
  v_cmp_eq_u32 vcc, 0, v232
  s_mov_b32 s59, 4227072
  s_nop 0
  v_cndmask_b32 v230, v230, v231, vcc
  v_lshl_add_u32 v230, v249, 6, v230
  s_cmp_eq_u32 s36, 3
  s_cbranch_scc1 sequential_preLN__spectral_fnet__dense_activation_squared_relu__prompt_kernel_pf3w10
  s_mov_b32 s32, s92
  s_and_b32 s33, s93, 0xffff
  s_mov_b32 s34, 7340032
  s_mov_b32 s35, 0x20000
  s_mul_i32 s3, s2, 3
  s_add_u32 s3, s3, s36
  s_mul_i32 s3, s3, 4864
  s_add_u32 s3, s3, 3670016
  v_lshlrev_b32 v188, 7, v248
  v_cmp_gt_u32 vcc, 38, v248
  v_mov_b32 v189, 0x40000000
  s_nop 0
  v_cndmask_b32 v188, v189, v188, vcc
  buffer_load_dword a255, v188, s[32:35], s3 offen
sequential_preLN__spectral_fnet__dense_activation_squared_relu__prompt_kernel_pf3w10:
  s_cmp_lg_u32 s36, 3
  s_cbranch_scc1 sequential_preLN__spectral_fnet__dense_activation_squared_relu__prompt_kernel_pskip11
  buffer_load_dwordx2 v[184:185], v230, s[8:11], s59 offen sc1
  s_waitcnt vmcnt(0)
  s_mov_b32 s47, 262144
sequential_preLN__spectral_fnet__dense_activation_squared_relu__prompt_kernel_poll12:
  v_cmp_ne_u64 vcc, s[42:43], v[184:185]
  s_sub_u32 s47, s47, 1
  s_cbranch_scc1 sequential_preLN__spectral_fnet__dense_activation_squared_relu__prompt_kernel_pok13
  s_cmp_eq_u64 vcc, 0
  s_cbranch_scc1 sequential_preLN__spectral_fnet__dense_activation_squared_relu__prompt_kernel_pok13
  s_sleep 1
  s_mov_b64 exec, vcc
  buffer_load_dwordx2 v[184:185], v230, s[8:11], s59 offen sc1
  s_mov_b64 exec, -1
  s_waitcnt vmcnt(0)
  s_branch sequential_preLN__spectral_fnet__dense_activation_squared_relu__prompt_kernel_poll12
sequential_preLN__spectral_fnet__dense_activation_squared_relu__prompt_kernel_pok13:
sequential_preLN__spectral_fnet__dense_activation_squared_relu__prompt_kernel_pskip11:
  s_barrier
  s_mov_b32 s53, 0
  buffer_load_dwordx4 a[0:3], v251, s[16:19], s53 offen offset:0 sc1
  buffer_load_dwordx4 a[4:7], v251, s[16:19], s53 offen offset:1024 sc1
  buffer_load_dwordx4 a[8:11], v251, s[16:19], s53 offen offset:2048 sc1
  buffer_load_dwordx4 a[12:15], v251, s[16:19], s53 offen offset:3072 sc1
  s_mov_b32 s53, 4096
  buffer_load_dwordx4 a[16:19], v251, s[16:19], s53 offen offset:0 sc1
  buffer_load_dwordx4 a[20:23], v251, s[16:19], s53 offen offset:1024 sc1
  buffer_load_dwordx4 a[24:27], v251, s[16:19], s53 offen offset:2048 sc1
  buffer_load_dwordx4 a[28:31], v251, s[16:19], s53 offen offset:3072 sc1
  v_lshlrev_b32 v230, 2, v249
  v_lshl_add_u32 v230, v250, 9, v230
  buffer_load_dword v184, v230, s[8:11], s58 offen offset:0 sc1
  buffer_load_dword v188, v242, s[8:11], s46 offen offset:2048 sc1
  buffer_load_dword v185, v230, s[8:11], s58 offen offset:128 sc1
  buffer_load_dword v189, v242, s[8:11], s46 offen offset:2176 sc1
  buffer_load_dword v186, v230, s[8:11], s58 offen offset:256 sc1
  buffer_load_dword v190, v242, s[8:11], s46 offen offset:2304 sc1
  buffer_load_dword v187, v230, s[8:11], s58 offen offset:384 sc1
  buffer_load_dword v191, v242, s[8:11], s46 offen offset:2432 sc1
  buffer_load_dword v192, v230, s[8:11], s58 offen offset:64 sc1
  buffer_load_dword v196, v243, s[8:11], s46 offen offset:2048 sc1
  buffer_load_dword v193, v230, s[8:11], s58 offen offset:192 sc1
  buffer_load_dword v197, v243, s[8:11], s46 offen offset:2176 sc1
  buffer_load_dword v194, v230, s[8:11], s58 offen offset:320 sc1
  buffer_load_dword v198, v243, s[8:11], s46 offen offset:2304 sc1
  buffer_load_dword v195, v230, s[8:11], s58 offen offset:448 sc1
  buffer_load_dword v199, v243, s[8:11], s46 offen offset:2432 sc1
  ds_read_b64_tr_b16 v[112:113], v220 offset:0
  ds_read_b64_tr_b16 v[114:115], v220 offset:512
  ds_read_b64_tr_b16 v[116:117], v220 offset:32
  ds_read_b64_tr_b16 v[118:119], v220 offset:544
  ds_read_b64_tr_b16 v[120:121], v220 offset:64
  ds_read_b64_tr_b16 v[122:123], v220 offset:576
  ds_read_b64_tr_b16 v[124:125], v220 offset:96
  ds_read_b64_tr_b16 v[126:127], v220 offset:608
  ds_read_b64_tr_b16 v[128:129], v220 offset:128
  ds_read_b64_tr_b16 v[130:131], v220 offset:640
  ds_read_b64_tr_b16 v[132:133], v220 offset:160
  ds_read_b64_tr_b16 v[134:135], v220 offset:672
  ds_read_b64_tr_b16 v[136:137], v220 offset:192
  ds_read_b64_tr_b16 v[138:139], v220 offset:704
  s_waitcnt vmcnt(22) lgkmcnt(10)
  v_mfma_f32_16x16x32_bf16 v[0:3], v[112:115], a[0:3], 0
  ds_read_b64_tr_b16 v[140:141], v220 offset:224
  v_mfma_f32_16x16x32_bf16 v[4:7], v[112:115], a[4:7], 0
  ds_read_b64_tr_b16 v[142:143], v220 offset:736
  s_mov_b32 s53, 8192
  v_mfma_f32_16x16x32_bf16 v[8:11], v[116:119], a[0:3], 0
  ds_read_b64_tr_b16 v[112:113], v220 offset:8448
  v_mfma_f32_16x16x32_bf16 v[12:15], v[116:119], a[4:7], 0
  buffer_load_dwordx4 a[32:35], v251, s[16:19], s53 offen offset:0 sc1
  ds_read_b64_tr_b16 v[114:115], v220 offset:8960
  s_waitcnt lgkmcnt(10)
  v_mfma_f32_16x16x32_bf16 v[16:19], v[120:123], a[0:3], 0
  ds_read_b64_tr_b16 v[116:117], v220 offset:8480
  v_mfma_f32_16x16x32_bf16 v[20:23], v[120:123], a[4:7], 0
  ds_read_b64_tr_b16 v[118:119], v220 offset:8992
  v_mfma_f32_16x16x32_bf16 v[24:27], v[124:127], a[0:3], 0
  ds_read_b64_tr_b16 v[120:121], v220 offset:8512
  v_mfma_f32_16x16x32_bf16 v[28:31], v[124:127], a[4:7], 0
  buffer_load_dwordx4 a[36:39], v251, s[16:19], s53 offen offset:1024 sc1
  ds_read_b64_tr_b16 v[122:123], v220 offset:9024
  s_waitcnt lgkmcnt(10)
  v_mfma_f32_16x16x32_bf16 v[32:35], v[128:131], a[0:3], 0
  ds_read_b64_tr_b16 v[124:125], v220 offset:8544
  v_mfma_f32_16x16x32_bf16 v[36:39], v[128:131], a[4:7], 0
  ds_read_b64_tr_b16 v[126:127], v220 offset:9056
  v_mfma_f32_16x16x32_bf16 v[40:43], v[132:135], a[0:3], 0
  ds_read_b64_tr_b16 v[128:129], v220 offset:8576
  v_mfma_f32_16x16x32_bf16 v[44:47], v[132:135], a[4:7], 0
  buffer_load_dwordx4 a[40:43], v251, s[16:19], s53 offen offset:2048 sc1
  ds_read_b64_tr_b16 v[130:131], v220 offset:9088
  s_waitcnt lgkmcnt(10)
  v_mfma_f32_16x16x32_bf16 v[48:51], v[136:139], a[0:3], 0
  ds_read_b64_tr_b16 v[132:133], v220 offset:8608
  v_mfma_f32_16x16x32_bf16 v[52:55], v[136:139], a[4:7], 0
  ds_read_b64_tr_b16 v[134:135], v220 offset:9120
  v_mfma_f32_16x16x32_bf16 v[56:59], v[140:143], a[0:3], 0
  ds_read_b64_tr_b16 v[136:137], v220 offset:8640
  v_mfma_f32_16x16x32_bf16 v[60:63], v[140:143], a[4:7], 0
  buffer_load_dwordx4 a[44:47], v251, s[16:19], s53 offen offset:3072 sc1
  ds_read_b64_tr_b16 v[138:139], v220 offset:9152
  s_waitcnt vmcnt(24) lgkmcnt(10)
  v_mfma_f32_16x16x32_bf16 v[0:3], v[112:115], a[8:11], v[0:3]
  ds_read_b64_tr_b16 v[140:141], v220 offset:8672
  v_mfma_f32_16x16x32_bf16 v[4:7], v[112:115], a[12:15], v[4:7]
  ds_read_b64_tr_b16 v[142:143], v220 offset:9184
  s_mov_b32 s53, 12288
  v_mfma_f32_16x16x32_bf16 v[8:11], v[116:119], a[8:11], v[8:11]
  ds_read_b64_tr_b16 v[112:113], v220 offset:16896
  v_mfma_f32_16x16x32_bf16 v[12:15], v[116:119], a[12:15], v[12:15]
  buffer_load_dwordx4 a[48:51], v251, s[16:19], s53 offen offset:0 sc1
  ds_read_b64_tr_b16 v[114:115], v220 offset:17408
  s_waitcnt lgkmcnt(10)
  v_mfma_f32_16x16x32_bf16 v[16:19], v[120:123], a[8:11], v[16:19]
  ds_read_b64_tr_b16 v[116:117], v220 offset:16928
  v_mfma_f32_16x16x32_bf16 v[20:23], v[120:123], a[12:15], v[20:23]
  ds_read_b64_tr_b16 v[118:119], v220 offset:17440
  v_mfma_f32_16x16x32_bf16 v[24:27], v[124:127], a[8:11], v[24:27]
  ds_read_b64_tr_b16 v[120:121], v220 offset:16960
  v_mfma_f32_16x16x32_bf16 v[28:31], v[124:127], a[12:15], v[28:31]
  buffer_load_dwordx4 a[52:55], v251, s[16:19], s53 offen offset:1024 sc1
  ds_read_b64_tr_b16 v[122:123], v220 offset:17472
  s_waitcnt lgkmcnt(10)
  v_mfma_f32_16x16x32_bf16 v[32:35], v[128:131], a[8:11], v[32:35]
  ds_read_b64_tr_b16 v[124:125], v220 offset:16992
  v_mfma_f32_16x16x32_bf16 v[36:39], v[128:131], a[12:15], v[36:39]
  ds_read_b64_tr_b16 v[126:127], v220 offset:17504
  v_mfma_f32_16x16x32_bf16 v[40:43], v[132:135], a[8:11], v[40:43]
  ds_read_b64_tr_b16 v[128:129], v220 offset:17024
  v_mfma_f32_16x16x32_bf16 v[44:47], v[132:135], a[12:15], v[44:47]
  buffer_load_dwordx4 a[56:59], v251, s[16:19], s53 offen offset:2048 sc1
  ds_read_b64_tr_b16 v[130:131], v220 offset:17536
  s_waitcnt lgkmcnt(10)
  v_mfma_f32_16x16x32_bf16 v[48:51], v[136:139], a[8:11], v[48:51]
  ds_read_b64_tr_b16 v[132:133], v220 offset:17056
  v_mfma_f32_16x16x32_bf16 v[52:55], v[136:139], a[12:15], v[52:55]
  ds_read_b64_tr_b16 v[134:135], v220 offset:17568
  v_mfma_f32_16x16x32_bf16 v[56:59], v[140:143], a[8:11], v[56:59]
  ds_read_b64_tr_b16 v[136:137], v220 offset:17088
  v_mfma_f32_16x16x32_bf16 v[60:63], v[140:143], a[12:15], v[60:63]
  buffer_load_dwordx4 a[60:63], v251, s[16:19], s53 offen offset:3072 sc1
  ds_read_b64_tr_b16 v[138:139], v220 offset:17600
  s_waitcnt vmcnt(26) lgkmcnt(10)
  v_mfma_f32_16x16x32_bf16 v[0:3], v[112:115], a[16:19], v[0:3]
  ds_read_b64_tr_b16 v[140:141], v220 offset:17120
  v_mfma_f32_16x16x32_bf16 v[4:7], v[112:115], a[20:23], v[4:7]
  ds_read_b64_tr_b16 v[142:143], v220 offset:17632
  s_mov_b32 s53, 16384
  v_mfma_f32_16x16x32_bf16 v[8:11], v[116:119], a[16:19], v[8:11]
  ds_read_b64_tr_b16 v[112:113], v220 offset:25344
  v_mfma_f32_16x16x32_bf16 v[12:15], v[116:119], a[20:23], v[12:15]
  buffer_load_dwordx4 a[64:67], v251, s[16:19], s53 offen offset:0 sc1
  ds_read_b64_tr_b16 v[114:115], v220 offset:25856
  s_waitcnt lgkmcnt(10)
  v_mfma_f32_16x16x32_bf16 v[16:19], v[120:123], a[16:19], v[16:19]
  ds_read_b64_tr_b16 v[116:117], v220 offset:25376
  v_mfma_f32_16x16x32_bf16 v[20:23], v[120:123], a[20:23], v[20:23]
  ds_read_b64_tr_b16 v[118:119], v220 offset:25888
  v_mfma_f32_16x16x32_bf16 v[24:27], v[124:127], a[16:19], v[24:27]
  ds_read_b64_tr_b16 v[120:121], v220 offset:25408
  v_mfma_f32_16x16x32_bf16 v[28:31], v[124:127], a[20:23], v[28:31]
  buffer_load_dwordx4 a[68:71], v251, s[16:19], s53 offen offset:1024 sc1
  ds_read_b64_tr_b16 v[122:123], v220 offset:25920
  s_waitcnt lgkmcnt(10)
  v_mfma_f32_16x16x32_bf16 v[32:35], v[128:131], a[16:19], v[32:35]
  ds_read_b64_tr_b16 v[124:125], v220 offset:25440
  v_mfma_f32_16x16x32_bf16 v[36:39], v[128:131], a[20:23], v[36:39]
  ds_read_b64_tr_b16 v[126:127], v220 offset:25952
  v_mfma_f32_16x16x32_bf16 v[40:43], v[132:135], a[16:19], v[40:43]
  ds_read_b64_tr_b16 v[128:129], v220 offset:25472
  v_mfma_f32_16x16x32_bf16 v[44:47], v[132:135], a[20:23], v[44:47]
  buffer_load_dwordx4 a[72:75], v251, s[16:19], s53 offen offset:2048 sc1
  ds_read_b64_tr_b16 v[130:131], v220 offset:25984
  s_waitcnt lgkmcnt(10)
  v_mfma_f32_16x16x32_bf16 v[48:51], v[136:139], a[16:19], v[48:51]
  ds_read_b64_tr_b16 v[132:133], v220 offset:25504
  v_mfma_f32_16x16x32_bf16 v[52:55], v[136:139], a[20:23], v[52:55]
  ds_read_b64_tr_b16 v[134:135], v220 offset:26016
  v_mfma_f32_16x16x32_bf16 v[56:59], v[140:143], a[16:19], v[56:59]
  ds_read_b64_tr_b16 v[136:137], v220 offset:25536
  v_mfma_f32_16x16x32_bf16 v[60:63], v[140:143], a[20:23], v[60:63]
  buffer_load_dwordx4 a[76:79], v251, s[16:19], s53 offen offset:3072 sc1
  ds_read_b64_tr_b16 v[138:139], v220 offset:26048
  s_waitcnt vmcnt(28) lgkmcnt(10)
  v_mfma_f32_16x16x32_bf16 v[0:3], v[112:115], a[24:27], v[0:3]
  ds_read_b64_tr_b16 v[140:141], v220 offset:25568
  v_mfma_f32_16x16x32_bf16 v[4:7], v[112:115], a[28:31], v[4:7]
  ds_read_b64_tr_b16 v[142:143], v220 offset:26080
  v_mfma_f32_16x16x32_bf16 v[8:11], v[116:119], a[24:27], v[8:11]
  s_barrier
  ds_read_b64_tr_b16 v[112:113], v220 offset:33792
  v_mfma_f32_16x16x32_bf16 v[12:15], v[116:119], a[28:31], v[12:15]
  ds_read_b64_tr_b16 v[114:115], v220 offset:34304
  s_waitcnt lgkmcnt(10)
  v_mfma_f32_16x16x32_bf16 v[16:19], v[120:123], a[24:27], v[16:19]
  ds_read_b64_tr_b16 v[116:117], v220 offset:33824
  v_mfma_f32_16x16x32_bf16 v[20:23], v[120:123], a[28:31], v[20:23]
  ds_read_b64_tr_b16 v[118:119], v220 offset:34336
  s_mov_b32 s53, 20480
  v_mfma_f32_16x16x32_bf16 v[24:27], v[124:127], a[24:27], v[24:27]
  ds_read_b64_tr_b16 v[120:121], v220 offset:33856
  v_mfma_f32_16x16x32_bf16 v[28:31], v[124:127], a[28:31], v[28:31]
  buffer_load_dwordx4 a[80:83], v251, s[16:19], s53 offen offset:0 sc1
  ds_read_b64_tr_b16 v[122:123], v220 offset:34368
  s_waitcnt lgkmcnt(10)
  v_mfma_f32_16x16x32_bf16 v[32:35], v[128:131], a[24:27], v[32:35]
  ds_read_b64_tr_b16 v[124:125], v220 offset:33888
  v_mfma_f32_16x16x32_bf16 v[36:39], v[128:131], a[28:31], v[36:39]
  ds_read_b64_tr_b16 v[126:127], v220 offset:34400
  s_add_u32 s52, s84, 2752512
  s_add_u32 m0, s56, 101376
  v_mfma_f32_16x16x32_bf16 v[40:43], v[132:135], a[24:27], v[40:43]
  ds_read_b64_tr_b16 v[128:129], v220 offset:33920
  v_mfma_f32_16x16x32_bf16 v[44:47], v[132:135], a[28:31], v[44:47]
  buffer_load_dwordx4 v204, s[12:15], s52 offen offset:0 lds
  ds_read_b64_tr_b16 v[130:131], v220 offset:34432
  s_waitcnt lgkmcnt(10)
  v_mfma_f32_16x16x32_bf16 v[48:51], v[136:139], a[24:27], v[48:51]
  ds_read_b64_tr_b16 v[132:133], v220 offset:33952
  v_mfma_f32_16x16x32_bf16 v[52:55], v[136:139], a[28:31], v[52:55]
  ds_read_b64_tr_b16 v[134:135], v220 offset:34464
  v_mfma_f32_16x16x32_bf16 v[56:59], v[140:143], a[24:27], v[56:59]
  ds_read_b64_tr_b16 v[136:137], v220 offset:33984
  v_mfma_f32_16x16x32_bf16 v[60:63], v[140:143], a[28:31], v[60:63]
  buffer_load_dwordx4 v205, s[12:15], s52 offen offset:1056 lds
  ds_read_b64_tr_b16 v[138:139], v220 offset:34496
  s_waitcnt vmcnt(13) lgkmcnt(10)
  v_mfma_f32_16x16x32_bf16 v[0:3], v[112:115], a[32:35], v[0:3]
  ds_read_b64_tr_b16 v[140:141], v220 offset:34016
  v_mfma_f32_16x16x32_bf16 v[4:7], v[112:115], a[36:39], v[4:7]
  ds_read_b64_tr_b16 v[142:143], v220 offset:34528
  v_mfma_f32_16x16x32_bf16 v[8:11], v[116:119], a[32:35], v[8:11]
  ds_read_b64_tr_b16 v[112:113], v220 offset:42240
  v_mfma_f32_16x16x32_bf16 v[12:15], v[116:119], a[36:39], v[12:15]
  buffer_load_dwordx4 v206, s[12:15], s52 offen offset:2112 lds
  ds_read_b64_tr_b16 v[114:115], v220 offset:42752
  s_waitcnt lgkmcnt(10)
  v_mfma_f32_16x16x32_bf16 v[16:19], v[120:123], a[32:35], v[16:19]
  ds_read_b64_tr_b16 v[116:117], v220 offset:42272
  v_mfma_f32_16x16x32_bf16 v[20:23], v[120:123], a[36:39], v[20:23]
  ds_read_b64_tr_b16 v[118:119], v220 offset:42784
  v_mfma_f32_16x16x32_bf16 v[24:27], v[124:127], a[32:35], v[24:27]
  ds_read_b64_tr_b16 v[120:121], v220 offset:42304
  v_mfma_f32_16x16x32_bf16 v[28:31], v[124:127], a[36:39], v[28:31]
  buffer_load_dwordx4 v207, s[12:15], s52 offen offset:3168 lds
  ds_read_b64_tr_b16 v[122:123], v220 offset:42816
  s_waitcnt lgkmcnt(10)
  v_mfma_f32_16x16x32_bf16 v[32:35], v[128:131], a[32:35], v[32:35]
  ds_read_b64_tr_b16 v[124:125], v220 offset:42336
  v_mfma_f32_16x16x32_bf16 v[36:39], v[128:131], a[36:39], v[36:39]
  ds_read_b64_tr_b16 v[126:127], v220 offset:42848
  s_add_u32 s52, s84, 3211264
  s_add_u32 m0, s56, 118272
  v_mfma_f32_16x16x32_bf16 v[40:43], v[132:135], a[32:35], v[40:43]
  ds_read_b64_tr_b16 v[128:129], v220 offset:42368
  v_mfma_f32_16x16x32_bf16 v[44:47], v[132:135], a[36:39], v[44:47]
  buffer_load_dwordx4 v204, s[12:15], s52 offen offset:0 lds
  ds_read_b64_tr_b16 v[130:131], v220 offset:42880
  s_waitcnt lgkmcnt(10)
  v_mfma_f32_16x16x32_bf16 v[48:51], v[136:139], a[32:35], v[48:51]
  ds_read_b64_tr_b16 v[132:133], v220 offset:42400
  v_mfma_f32_16x16x32_bf16 v[52:55], v[136:139], a[36:39], v[52:55]
  ds_read_b64_tr_b16 v[134:135], v220 offset:42912
  v_mfma_f32_16x16x32_bf16 v[56:59], v[140:143], a[32:35], v[56:59]
  ds_read_b64_tr_b16 v[136:137], v220 offset:42432
  v_mfma_f32_16x16x32_bf16 v[60:63], v[140:143], a[36:39], v[60:63]
  buffer_load_dwordx4 v205, s[12:15], s52 offen offset:1056 lds
  ds_read_b64_tr_b16 v[138:139], v220 offset:42944
  s_waitcnt vmcnt(15) lgkmcnt(10)
  v_mfma_f32_16x16x32_bf16 v[0:3], v[112:115], a[40:43], v[0:3]
  ds_read_b64_tr_b16 v[140:141], v220 offset:42464
  v_mfma_f32_16x16x32_bf16 v[4:7], v[112:115], a[44:47], v[4:7]
  ds_read_b64_tr_b16 v[142:143], v220 offset:42976
  v_mfma_f32_16x16x32_bf16 v[8:11], v[116:119], a[40:43], v[8:11]
  ds_read_b64_tr_b16 v[112:113], v221 offset:0
  v_mfma_f32_16x16x32_bf16 v[12:15], v[116:119], a[44:47], v[12:15]
  buffer_load_dwordx4 v206, s[12:15], s52 offen offset:2112 lds
  ds_read_b64_tr_b16 v[114:115], v221 offset:512
  s_waitcnt lgkmcnt(10)
  v_mfma_f32_16x16x32_bf16 v[16:19], v[120:123], a[40:43], v[16:19]
  ds_read_b64_tr_b16 v[116:117], v221 offset:32
  v_mfma_f32_16x16x32_bf16 v[20:23], v[120:123], a[44:47], v[20:23]
  ds_read_b64_tr_b16 v[118:119], v221 offset:544
  v_mfma_f32_16x16x32_bf16 v[24:27], v[124:127], a[40:43], v[24:27]
  ds_read_b64_tr_b16 v[120:121], v221 offset:64
  v_mfma_f32_16x16x32_bf16 v[28:31], v[124:127], a[44:47], v[28:31]
  buffer_load_dwordx4 v207, s[12:15], s52 offen offset:3168 lds
  ds_read_b64_tr_b16 v[122:123], v221 offset:576
  s_waitcnt lgkmcnt(10)
  v_mfma_f32_16x16x32_bf16 v[32:35], v[128:131], a[40:43], v[32:35]
  ds_read_b64_tr_b16 v[124:125], v221 offset:96
  v_mfma_f32_16x16x32_bf16 v[36:39], v[128:131], a[44:47], v[36:39]
  ds_read_b64_tr_b16 v[126:127], v221 offset:608
  v_mfma_f32_16x16x32_bf16 v[40:43], v[132:135], a[40:43], v[40:43]
  ds_read_b64_tr_b16 v[128:129], v221 offset:128
  v_mfma_f32_16x16x32_bf16 v[44:47], v[132:135], a[44:47], v[44:47]
  buffer_load_dwordx4 a[84:87], v251, s[16:19], s53 offen offset:1024 sc1
  ds_read_b64_tr_b16 v[130:131], v221 offset:640
  s_waitcnt lgkmcnt(10)
  v_mfma_f32_16x16x32_bf16 v[48:51], v[136:139], a[40:43], v[48:51]
  ds_read_b64_tr_b16 v[132:133], v221 offset:160
  v_mfma_f32_16x16x32_bf16 v[52:55], v[136:139], a[44:47], v[52:55]
  ds_read_b64_tr_b16 v[134:135], v221 offset:672
  v_mfma_f32_16x16x32_bf16 v[56:59], v[140:143], a[40:43], v[56:59]
  ds_read_b64_tr_b16 v[136:137], v221 offset:192
  v_mfma_f32_16x16x32_bf16 v[60:63], v[140:143], a[44:47], v[60:63]
  buffer_load_dwordx4 a[88:91], v251, s[16:19], s53 offen offset:2048 sc1
  ds_read_b64_tr_b16 v[138:139], v221 offset:704
  s_waitcnt vmcnt(17) lgkmcnt(10)
  v_mfma_f32_16x16x32_bf16 v[0:3], v[112:115], a[48:51], v[0:3]
  ds_read_b64_tr_b16 v[140:141], v221 offset:224
  v_mfma_f32_16x16x32_bf16 v[4:7], v[112:115], a[52:55], v[4:7]
  ds_read_b64_tr_b16 v[142:143], v221 offset:736
  v_mfma_f32_16x16x32_bf16 v[8:11], v[116:119], a[48:51], v[8:11]
  ds_read_b64_tr_b16 v[112:113], v221 offset:8448
  v_mfma_f32_16x16x32_bf16 v[12:15], v[116:119], a[52:55], v[12:15]
  buffer_load_dwordx4 a[92:95], v251, s[16:19], s53 offen offset:3072 sc1
  ds_read_b64_tr_b16 v[114:115], v221 offset:8960
  s_waitcnt lgkmcnt(10)
  v_mfma_f32_16x16x32_bf16 v[16:19], v[120:123], a[48:51], v[16:19]
  ds_read_b64_tr_b16 v[116:117], v221 offset:8480
  v_mfma_f32_16x16x32_bf16 v[20:23], v[120:123], a[52:55], v[20:23]
  ds_read_b64_tr_b16 v[118:119], v221 offset:8992
  s_mov_b32 s53, 24576
  v_mfma_f32_16x16x32_bf16 v[24:27], v[124:127], a[48:51], v[24:27]
  ds_read_b64_tr_b16 v[120:121], v221 offset:8512
  v_mfma_f32_16x16x32_bf16 v[28:31], v[124:127], a[52:55], v[28:31]
  buffer_load_dwordx4 a[96:99], v251, s[16:19], s53 offen offset:0 sc1
  ds_read_b64_tr_b16 v[122:123], v221 offset:9024
  s_waitcnt lgkmcnt(10)
  v_mfma_f32_16x16x32_bf16 v[32:35], v[128:131], a[48:51], v[32:35]
  ds_read_b64_tr_b16 v[124:125], v221 offset:8544
  v_mfma_f32_16x16x32_bf16 v[36:39], v[128:131], a[52:55], v[36:39]
  ds_read_b64_tr_b16 v[126:127], v221 offset:9056
  v_mfma_f32_16x16x32_bf16 v[40:43], v[132:135], a[48:51], v[40:43]
  ds_read_b64_tr_b16 v[128:129], v221 offset:8576
  v_mfma_f32_16x16x32_bf16 v[44:47], v[132:135], a[52:55], v[44:47]
  buffer_load_dwordx4 a[100:103], v251, s[16:19], s53 offen offset:1024 sc1
  ds_read_b64_tr_b16 v[130:131], v221 offset:9088
  s_waitcnt lgkmcnt(10)
  v_mfma_f32_16x16x32_bf16 v[48:51], v[136:139], a[48:51], v[48:51]
  ds_read_b64_tr_b16 v[132:133], v221 offset:8608
  v_mfma_f32_16x16x32_bf16 v[52:55], v[136:139], a[52:55], v[52:55]
  ds_read_b64_tr_b16 v[134:135], v221 offset:9120
  v_mfma_f32_16x16x32_bf16 v[56:59], v[140:143], a[48:51], v[56:59]
  ds_read_b64_tr_b16 v[136:137], v221 offset:8640
  v_mfma_f32_16x16x32_bf16 v[60:63], v[140:143], a[52:55], v[60:63]
  buffer_load_dwordx4 a[104:107], v251, s[16:19], s53 offen offset:2048 sc1
  ds_read_b64_tr_b16 v[138:139], v221 offset:9152
  s_waitcnt vmcnt(19) lgkmcnt(10)
  v_mfma_f32_16x16x32_bf16 v[0:3], v[112:115], a[56:59], v[0:3]
  ds_read_b64_tr_b16 v[140:141], v221 offset:8672
  v_mfma_f32_16x16x32_bf16 v[4:7], v[112:115], a[60:63], v[4:7]
  ds_read_b64_tr_b16 v[142:143], v221 offset:9184
  v_mfma_f32_16x16x32_bf16 v[8:11], v[116:119], a[56:59], v[8:11]
  s_barrier
  ds_read_b64_tr_b16 v[112:113], v221 offset:16896
  v_mfma_f32_16x16x32_bf16 v[12:15], v[116:119], a[60:63], v[12:15]
  ds_read_b64_tr_b16 v[114:115], v221 offset:17408
  s_waitcnt lgkmcnt(10)
  v_mfma_f32_16x16x32_bf16 v[16:19], v[120:123], a[56:59], v[16:19]
  ds_read_b64_tr_b16 v[116:117], v221 offset:16928
  v_mfma_f32_16x16x32_bf16 v[20:23], v[120:123], a[60:63], v[20:23]
  ds_read_b64_tr_b16 v[118:119], v221 offset:17440
  v_mfma_f32_16x16x32_bf16 v[24:27], v[124:127], a[56:59], v[24:27]
  ds_read_b64_tr_b16 v[120:121], v221 offset:16960
  v_mfma_f32_16x16x32_bf16 v[28:31], v[124:127], a[60:63], v[28:31]
  buffer_load_dwordx4 a[108:111], v251, s[16:19], s53 offen offset:3072 sc1
  ds_read_b64_tr_b16 v[122:123], v221 offset:17472
  s_waitcnt lgkmcnt(10)
  v_mfma_f32_16x16x32_bf16 v[32:35], v[128:131], a[56:59], v[32:35]
  ds_read_b64_tr_b16 v[124:125], v221 offset:16992
  v_mfma_f32_16x16x32_bf16 v[36:39], v[128:131], a[60:63], v[36:39]
  ds_read_b64_tr_b16 v[126:127], v221 offset:17504
  s_add_u32 s52, s84, 0
  s_add_u32 m0, s56, 0
  v_mfma_f32_16x16x32_bf16 v[40:43], v[132:135], a[56:59], v[40:43]
  ds_read_b64_tr_b16 v[128:129], v221 offset:17024
  v_mfma_f32_16x16x32_bf16 v[44:47], v[132:135], a[60:63], v[44:47]
  buffer_load_dwordx4 v212, s[12:15], s52 offen offset:0 lds
  ds_read_b64_tr_b16 v[130:131], v221 offset:17536
  s_waitcnt lgkmcnt(10)
  v_mfma_f32_16x16x32_bf16 v[48:51], v[136:139], a[56:59], v[48:51]
  ds_read_b64_tr_b16 v[132:133], v221 offset:17056
  v_mfma_f32_16x16x32_bf16 v[52:55], v[136:139], a[60:63], v[52:55]
  ds_read_b64_tr_b16 v[134:135], v221 offset:17568
  s_add_u32 s52, s84, 6884352
  v_mfma_f32_16x16x32_bf16 v[56:59], v[140:143], a[56:59], v[56:59]
  ds_read_b64_tr_b16 v[136:137], v221 offset:17088
  v_mfma_f32_16x16x32_bf16 v[60:63], v[140:143], a[60:63], v[60:63]
  buffer_load_dwordx4 v209, s[12:15], s52 offen offset:1056 lds
  ds_read_b64_tr_b16 v[138:139], v221 offset:17600
  s_waitcnt vmcnt(20) lgkmcnt(10)
  v_mfma_f32_16x16x32_bf16 v[0:3], v[112:115], a[64:67], v[0:3]
  ds_read_b64_tr_b16 v[140:141], v221 offset:17120
  v_mfma_f32_16x16x32_bf16 v[4:7], v[112:115], a[68:71], v[4:7]
  ds_read_b64_tr_b16 v[142:143], v221 offset:17632
  v_mfma_f32_16x16x32_bf16 v[8:11], v[116:119], a[64:67], v[8:11]
  ds_read_b64_tr_b16 v[112:113], v221 offset:25344
  v_mfma_f32_16x16x32_bf16 v[12:15], v[116:119], a[68:71], v[12:15]
  buffer_load_dwordx4 v210, s[12:15], s52 offen offset:2112 lds
  ds_read_b64_tr_b16 v[114:115], v221 offset:25856
  s_waitcnt lgkmcnt(10)
  v_mfma_f32_16x16x32_bf16 v[16:19], v[120:123], a[64:67], v[16:19]
  ds_read_b64_tr_b16 v[116:117], v221 offset:25376
  v_mfma_f32_16x16x32_bf16 v[20:23], v[120:123], a[68:71], v[20:23]
  ds_read_b64_tr_b16 v[118:119], v221 offset:25888
  v_add_f32 v184, v184, v185
  v_mfma_f32_16x16x32_bf16 v[24:27], v[124:127], a[64:67], v[24:27]
  ds_read_b64_tr_b16 v[120:121], v221 offset:25408
  v_mfma_f32_16x16x32_bf16 v[28:31], v[124:127], a[68:71], v[28:31]
  buffer_load_dwordx4 v211, s[12:15], s52 offen offset:3168 lds
  ds_read_b64_tr_b16 v[122:123], v221 offset:25920
  s_waitcnt lgkmcnt(10)
  v_mfma_f32_16x16x32_bf16 v[32:35], v[128:131], a[64:67], v[32:35]
  ds_read_b64_tr_b16 v[124:125], v221 offset:25440
  v_mfma_f32_16x16x32_bf16 v[36:39], v[128:131], a[68:71], v[36:39]
  ds_read_b64_tr_b16 v[126:127], v221 offset:25952
  v_add_f32 v184, v184, v186
  s_add_u32 s52, s84, 6425600
  s_add_u32 m0, s56, 16896
  v_mfma_f32_16x16x32_bf16 v[40:43], v[132:135], a[64:67], v[40:43]
  ds_read_b64_tr_b16 v[128:129], v221 offset:25472
  v_mfma_f32_16x16x32_bf16 v[44:47], v[132:135], a[68:71], v[44:47]
  buffer_load_dwordx4 v208, s[12:15], s52 offen offset:0 lds
  ds_read_b64_tr_b16 v[130:131], v221 offset:25984
  s_waitcnt lgkmcnt(10)
  v_mfma_f32_16x16x32_bf16 v[48:51], v[136:139], a[64:67], v[48:51]
  ds_read_b64_tr_b16 v[132:133], v221 offset:25504
  v_mfma_f32_16x16x32_bf16 v[52:55], v[136:139], a[68:71], v[52:55]
  ds_read_b64_tr_b16 v[134:135], v221 offset:26016
  v_add_f32 v184, v184, v187
  v_mfma_f32_16x16x32_bf16 v[56:59], v[140:143], a[64:67], v[56:59]
  ds_read_b64_tr_b16 v[136:137], v221 offset:25536
  v_mfma_f32_16x16x32_bf16 v[60:63], v[140:143], a[68:71], v[60:63]
  buffer_load_dwordx4 v209, s[12:15], s52 offen offset:1056 lds
  ds_read_b64_tr_b16 v[138:139], v221 offset:26048
  s_waitcnt vmcnt(22) lgkmcnt(10)
  v_mfma_f32_16x16x32_bf16 v[0:3], v[112:115], a[72:75], v[0:3]
  ds_read_b64_tr_b16 v[140:141], v221 offset:25568
  v_mfma_f32_16x16x32_bf16 v[4:7], v[112:115], a[76:79], v[4:7]
  ds_read_b64_tr_b16 v[142:143], v221 offset:26080
  v_add_f32 v184, v184, v188
  v_mfma_f32_16x16x32_bf16 v[8:11], v[116:119], a[72:75], v[8:11]
  ds_read_b64_tr_b16 v[112:113], v221 offset:33792
  v_mfma_f32_16x16x32_bf16 v[12:15], v[116:119], a[76:79], v[12:15]
  buffer_load_dwordx4 v210, s[12:15], s52 offen offset:2112 lds
  ds_read_b64_tr_b16 v[114:115], v221 offset:34304
  s_waitcnt lgkmcnt(10)
  v_mfma_f32_16x16x32_bf16 v[16:19], v[120:123], a[72:75], v[16:19]
  ds_read_b64_tr_b16 v[116:117], v221 offset:33824
  v_mfma_f32_16x16x32_bf16 v[20:23], v[120:123], a[76:79], v[20:23]
  ds_read_b64_tr_b16 v[118:119], v221 offset:34336
  v_add_f32 v184, v184, v189
  v_mfma_f32_16x16x32_bf16 v[24:27], v[124:127], a[72:75], v[24:27]
  ds_read_b64_tr_b16 v[120:121], v221 offset:33856
  v_mfma_f32_16x16x32_bf16 v[28:31], v[124:127], a[76:79], v[28:31]
  buffer_load_dwordx4 v211, s[12:15], s52 offen offset:3168 lds
  ds_read_b64_tr_b16 v[122:123], v221 offset:34368
  s_waitcnt lgkmcnt(10)
  v_mfma_f32_16x16x32_bf16 v[32:35], v[128:131], a[72:75], v[32:35]
  ds_read_b64_tr_b16 v[124:125], v221 offset:33888
  v_mfma_f32_16x16x32_bf16 v[36:39], v[128:131], a[76:79], v[36:39]
  ds_read_b64_tr_b16 v[126:127], v221 offset:34400
  v_add_f32 v184, v184, v190
  s_mov_b32 s53, 28672
  v_mfma_f32_16x16x32_bf16 v[40:43], v[132:135], a[72:75], v[40:43]
  ds_read_b64_tr_b16 v[128:129], v221 offset:33920
  v_mfma_f32_16x16x32_bf16 v[44:47], v[132:135], a[76:79], v[44:47]
  buffer_load_dwordx4 a[112:115], v251, s[16:19], s53 offen offset:0 sc1
  ds_read_b64_tr_b16 v[130:131], v221 offset:34432
  s_waitcnt lgkmcnt(10)
  v_mfma_f32_16x16x32_bf16 v[48:51], v[136:139], a[72:75], v[48:51]
  ds_read_b64_tr_b16 v[132:133], v221 offset:33952
  v_mfma_f32_16x16x32_bf16 v[52:55], v[136:139], a[76:79], v[52:55]
  ds_read_b64_tr_b16 v[134:135], v221 offset:34464
  v_add_f32 v184, v184, v191
  v_mfma_f32_16x16x32_bf16 v[56:59], v[140:143], a[72:75], v[56:59]
  ds_read_b64_tr_b16 v[136:137], v221 offset:33984
  v_mfma_f32_16x16x32_bf16 v[60:63], v[140:143], a[76:79], v[60:63]
  buffer_load_dwordx4 a[116:119], v251, s[16:19], s53 offen offset:1024 sc1
  ds_read_b64_tr_b16 v[138:139], v221 offset:34496
  s_waitcnt vmcnt(16) lgkmcnt(10)
  v_mfma_f32_16x16x32_bf16 v[0:3], v[112:115], a[80:83], v[0:3]
  ds_read_b64_tr_b16 v[140:141], v221 offset:34016
  v_mfma_f32_16x16x32_bf16 v[4:7], v[112:115], a[84:87], v[4:7]
  ds_read_b64_tr_b16 v[142:143], v221 offset:34528
  v_add_f32 v192, v192, v193
  v_mfma_f32_16x16x32_bf16 v[8:11], v[116:119], a[80:83], v[8:11]
  ds_read_b64_tr_b16 v[112:113], v221 offset:42240
  v_mfma_f32_16x16x32_bf16 v[12:15], v[116:119], a[84:87], v[12:15]
  buffer_load_dwordx4 a[120:123], v251, s[16:19], s53 offen offset:2048 sc1
  ds_read_b64_tr_b16 v[114:115], v221 offset:42752
  s_waitcnt lgkmcnt(10)
  v_mfma_f32_16x16x32_bf16 v[16:19], v[120:123], a[80:83], v[16:19]
  ds_read_b64_tr_b16 v[116:117], v221 offset:42272
  v_mfma_f32_16x16x32_bf16 v[20:23], v[120:123], a[84:87], v[20:23]
  ds_read_b64_tr_b16 v[118:119], v221 offset:42784
  v_add_f32 v192, v192, v194
  v_mfma_f32_16x16x32_bf16 v[24:27], v[124:127], a[80:83], v[24:27]
  ds_read_b64_tr_b16 v[120:121], v221 offset:42304
  v_mfma_f32_16x16x32_bf16 v[28:31], v[124:127], a[84:87], v[28:31]
  buffer_load_dwordx4 a[124:127], v251, s[16:19], s53 offen offset:3072 sc1
  ds_read_b64_tr_b16 v[122:123], v221 offset:42816
  s_waitcnt lgkmcnt(10)
  v_mfma_f32_16x16x32_bf16 v[32:35], v[128:131], a[80:83], v[32:35]
  ds_read_b64_tr_b16 v[124:125], v221 offset:42336
  v_mfma_f32_16x16x32_bf16 v[36:39], v[128:131], a[84:87], v[36:39]
  ds_read_b64_tr_b16 v[126:127], v221 offset:42848
  v_add_f32 v192, v192, v195
  s_mov_b32 s53, 32768
  v_mfma_f32_16x16x32_bf16 v[40:43], v[132:135], a[80:83], v[40:43]
  ds_read_b64_tr_b16 v[128:129], v221 offset:42368
  v_mfma_f32_16x16x32_bf16 v[44:47], v[132:135], a[84:87], v[44:47]
  buffer_load_dwordx4 a[128:131], v251, s[16:19], s53 offen offset:0 sc1
  ds_read_b64_tr_b16 v[130:131], v221 offset:42880
  s_waitcnt lgkmcnt(10)
  v_mfma_f32_16x16x32_bf16 v[48:51], v[136:139], a[80:83], v[48:51]
  ds_read_b64_tr_b16 v[132:133], v221 offset:42400
  v_mfma_f32_16x16x32_bf16 v[52:55], v[136:139], a[84:87], v[52:55]
  ds_read_b64_tr_b16 v[134:135], v221 offset:42912
  v_add_f32 v192, v192, v196
  v_mfma_f32_16x16x32_bf16 v[56:59], v[140:143], a[80:83], v[56:59]
  ds_read_b64_tr_b16 v[136:137], v221 offset:42432
  v_mfma_f32_16x16x32_bf16 v[60:63], v[140:143], a[84:87], v[60:63]
  buffer_load_dwordx4 a[132:135], v251, s[16:19], s53 offen offset:1024 sc1
  ds_read_b64_tr_b16 v[138:139], v221 offset:42944
  s_waitcnt vmcnt(18) lgkmcnt(10)
  v_mfma_f32_16x16x32_bf16 v[0:3], v[112:115], a[88:91], v[0:3]
  ds_read_b64_tr_b16 v[140:141], v221 offset:42464
  v_mfma_f32_16x16x32_bf16 v[4:7], v[112:115], a[92:95], v[4:7]
  ds_read_b64_tr_b16 v[142:143], v221 offset:42976
  v_add_f32 v192, v192, v197
  v_mfma_f32_16x16x32_bf16 v[8:11], v[116:119], a[88:91], v[8:11]
  s_barrier
  ds_read_b64_tr_b16 v[112:113], v222 offset:0
  v_mfma_f32_16x16x32_bf16 v[12:15], v[116:119], a[92:95], v[12:15]
  ds_read_b64_tr_b16 v[114:115], v222 offset:512
  s_waitcnt lgkmcnt(10)
  v_mfma_f32_16x16x32_bf16 v[16:19], v[120:123], a[88:91], v[16:19]
  ds_read_b64_tr_b16 v[116:117], v222 offset:32
  v_mfma_f32_16x16x32_bf16 v[20:23], v[120:123], a[92:95], v[20:23]
  ds_read_b64_tr_b16 v[118:119], v222 offset:544
  v_add_f32 v192, v192, v198
  v_mfma_f32_16x16x32_bf16 v[24:27], v[124:127], a[88:91], v[24:27]
  ds_read_b64_tr_b16 v[120:121], v222 offset:64
  v_mfma_f32_16x16x32_bf16 v[28:31], v[124:127], a[92:95], v[28:31]
  buffer_load_dwordx4 a[136:139], v251, s[16:19], s53 offen offset:2048 sc1
  ds_read_b64_tr_b16 v[122:123], v222 offset:576
  s_waitcnt lgkmcnt(10)
  v_mfma_f32_16x16x32_bf16 v[32:35], v[128:131], a[88:91], v[32:35]
  ds_read_b64_tr_b16 v[124:125], v222 offset:96
  v_mfma_f32_16x16x32_bf16 v[36:39], v[128:131], a[92:95], v[36:39]
  ds_read_b64_tr_b16 v[126:127], v222 offset:608
  v_add_f32 v192, v192, v199
  v_mfma_f32_16x16x32_bf16 v[40:43], v[132:135], a[88:91], v[40:43]
  ds_read_b64_tr_b16 v[128:129], v222 offset:128
  v_mfma_f32_16x16x32_bf16 v[44:47], v[132:135], a[92:95], v[44:47]
  buffer_load_dwordx4 a[140:143], v251, s[16:19], s53 offen offset:3072 sc1
  ds_read_b64_tr_b16 v[130:131], v222 offset:640
  s_waitcnt lgkmcnt(10)
  v_mfma_f32_16x16x32_bf16 v[48:51], v[136:139], a[88:91], v[48:51]
  ds_read_b64_tr_b16 v[132:133], v222 offset:160
  v_mfma_f32_16x16x32_bf16 v[52:55], v[136:139], a[92:95], v[52:55]
  ds_read_b64_tr_b16 v[134:135], v222 offset:672
  v_permlane32_swap_b32 v184, v192
  s_add_u32 s52, s84, 5966848
  s_add_u32 m0, s56, 33792
  v_mfma_f32_16x16x32_bf16 v[56:59], v[140:143], a[88:91], v[56:59]
  ds_read_b64_tr_b16 v[136:137], v222 offset:192
  v_mfma_f32_16x16x32_bf16 v[60:63], v[140:143], a[92:95], v[60:63]
  buffer_load_dwordx4 v208, s[12:15], s52 offen offset:0 lds
  ds_read_b64_tr_b16 v[138:139], v222 offset:704
  s_waitcnt vmcnt(19) lgkmcnt(10)
  v_mfma_f32_16x16x32_bf16 v[0:3], v[112:115], a[96:99], v[0:3]
  ds_read_b64_tr_b16 v[140:141], v222 offset:224
  v_mfma_f32_16x16x32_bf16 v[4:7], v[112:115], a[100:103], v[4:7]
  ds_read_b64_tr_b16 v[142:143], v222 offset:736
  v_add_f32 v184, v184, v192
  v_mfma_f32_16x16x32_bf16 v[8:11], v[116:119], a[96:99], v[8:11]
  ds_read_b64_tr_b16 v[112:113], v222 offset:8448
  v_mfma_f32_16x16x32_bf16 v[12:15], v[116:119], a[100:103], v[12:15]
  buffer_load_dwordx4 v209, s[12:15], s52 offen offset:1056 lds
  ds_read_b64_tr_b16 v[114:115], v222 offset:8960
  s_waitcnt lgkmcnt(10)
  v_mfma_f32_16x16x32_bf16 v[16:19], v[120:123], a[96:99], v[16:19]
  ds_read_b64_tr_b16 v[116:117], v222 offset:8480
  v_mfma_f32_16x16x32_bf16 v[20:23], v[120:123], a[100:103], v[20:23]
  ds_read_b64_tr_b16 v[118:119], v222 offset:8992
  v_mov_b32 v192, v184
  v_mfma_f32_16x16x32_bf16 v[24:27], v[124:127], a[96:99], v[24:27]
  ds_read_b64_tr_b16 v[120:121], v222 offset:8512
  v_mfma_f32_16x16x32_bf16 v[28:31], v[124:127], a[100:103], v[28:31]
  buffer_load_dwordx4 v210, s[12:15], s52 offen offset:2112 lds
  ds_read_b64_tr_b16 v[122:123], v222 offset:9024
  s_waitcnt lgkmcnt(10)
  v_mfma_f32_16x16x32_bf16 v[32:35], v[128:131], a[96:99], v[32:35]
  ds_read_b64_tr_b16 v[124:125], v222 offset:8544
  v_mfma_f32_16x16x32_bf16 v[36:39], v[128:131], a[100:103], v[36:39]
  ds_read_b64_tr_b16 v[126:127], v222 offset:9056
  v_permlane16_swap_b32 v184, v192
  v_mfma_f32_16x16x32_bf16 v[40:43], v[132:135], a[96:99], v[40:43]
  ds_read_b64_tr_b16 v[128:129], v222 offset:8576
  v_mfma_f32_16x16x32_bf16 v[44:47], v[132:135], a[100:103], v[44:47]
  buffer_load_dwordx4 v211, s[12:15], s52 offen offset:3168 lds
  ds_read_b64_tr_b16 v[130:131], v222 offset:9088
  s_waitcnt lgkmcnt(10)
  v_mfma_f32_16x16x32_bf16 v[48:51], v[136:139], a[96:99], v[48:51]
  ds_read_b64_tr_b16 v[132:133], v222 offset:8608
  v_mfma_f32_16x16x32_bf16 v[52:55], v[136:139], a[100:103], v[52:55]
  ds_read_b64_tr_b16 v[134:135], v222 offset:9120
  v_add_f32 v184, v184, v192
  s_add_u32 s52, s84, 5508096
  s_add_u32 m0, s56, 50688
  v_mfma_f32_16x16x32_bf16 v[56:59], v[140:143], a[96:99], v[56:59]
  ds_read_b64_tr_b16 v[136:137], v222 offset:8640
  v_mfma_f32_16x16x32_bf16 v[60:63], v[140:143], a[100:103], v[60:63]
  buffer_load_dwordx4 v208, s[12:15], s52 offen offset:0 lds
  ds_read_b64_tr_b16 v[138:139], v222 offset:9152
  s_waitcnt vmcnt(21) lgkmcnt(10)
  v_mfma_f32_16x16x32_bf16 v[0:3], v[112:115], a[104:107], v[0:3]
  ds_read_b64_tr_b16 v[140:141], v222 offset:8672
  v_mfma_f32_16x16x32_bf16 v[4:7], v[112:115], a[108:111], v[4:7]
  ds_read_b64_tr_b16 v[142:143], v222 offset:9184
  v_mov_b32 v192, 0x3727c5ac
  v_mfma_f32_16x16x32_bf16 v[8:11], v[116:119], a[104:107], v[8:11]
  ds_read_b64_tr_b16 v[112:113], v222 offset:16896
  v_mfma_f32_16x16x32_bf16 v[12:15], v[116:119], a[108:111], v[12:15]
  buffer_load_dwordx4 v209, s[12:15], s52 offen offset:1056 lds
  ds_read_b64_tr_b16 v[114:115], v222 offset:17408
  s_waitcnt lgkmcnt(10)
  v_mfma_f32_16x16x32_bf16 v[16:19], v[120:123], a[104:107], v[16:19]
  ds_read_b64_tr_b16 v[116:117], v222 offset:16928
  v_mfma_f32_16x16x32_bf16 v[20:23], v[120:123], a[108:111], v[20:23]
  ds_read_b64_tr_b16 v[118:119], v222 offset:17440
  v_fmac_f32 v192, 0x3a800000, v184
  v_mfma_f32_16x16x32_bf16 v[24:27], v[124:127], a[104:107], v[24:27]
  ds_read_b64_tr_b16 v[120:121], v222 offset:16960
  v_mfma_f32_16x16x32_bf16 v[28:31], v[124:127], a[108:111], v[28:31]
  buffer_load_dwordx4 v210, s[12:15], s52 offen offset:2112 lds
  ds_read_b64_tr_b16 v[122:123], v222 offset:17472
  s_waitcnt lgkmcnt(10)
  v_mfma_f32_16x16x32_bf16 v[32:35], v[128:131], a[104:107], v[32:35]
  ds_read_b64_tr_b16 v[124:125], v222 offset:16992
  v_mfma_f32_16x16x32_bf16 v[36:39], v[128:131], a[108:111], v[36:39]
  ds_read_b64_tr_b16 v[126:127], v222 offset:17504
  v_mov_b32 v193, v192
  v_mfma_f32_16x16x32_bf16 v[40:43], v[132:135], a[104:107], v[40:43]
  ds_read_b64_tr_b16 v[128:129], v222 offset:17024
  v_mfma_f32_16x16x32_bf16 v[44:47], v[132:135], a[108:111], v[44:47]
  buffer_load_dwordx4 v211, s[12:15], s52 offen offset:3168 lds
  ds_read_b64_tr_b16 v[130:131], v222 offset:17536
  s_waitcnt lgkmcnt(10)
  v_mfma_f32_16x16x32_bf16 v[48:51], v[136:139], a[104:107], v[48:51]
  ds_read_b64_tr_b16 v[132:133], v222 offset:17056
  v_mfma_f32_16x16x32_bf16 v[52:55], v[136:139], a[108:111], v[52:55]
  ds_read_b64_tr_b16 v[134:135], v222 offset:17568
  v_mov_b32 v201, 0
  s_mov_b32 s53, 36864
  v_mfma_f32_16x16x32_bf16 v[56:59], v[140:143], a[104:107], v[56:59]
  ds_read_b64_tr_b16 v[136:137], v222 offset:17088
  v_mfma_f32_16x16x32_bf16 v[60:63], v[140:143], a[108:111], v[60:63]
  buffer_load_dwordx4 a[144:147], v251, s[16:19], s53 offen offset:0 sc1
  ds_read_b64_tr_b16 v[138:139], v222 offset:17600
  s_waitcnt vmcnt(15) lgkmcnt(10)
  v_mfma_f32_16x16x32_bf16 v[0:3], v[112:115], a[112:115], v[0:3]
  ds_read_b64_tr_b16 v[140:141], v222 offset:17120
  v_mfma_f32_16x16x32_bf16 v[4:7], v[112:115], a[116:119], v[4:7]
  ds_read_b64_tr_b16 v[142:143], v222 offset:17632
  v_permlane32_swap_b32 v192, v193
  v_mfma_f32_16x16x32_bf16 v[8:11], v[116:119], a[112:115], v[8:11]
  ds_read_b64_tr_b16 v[112:113], v222 offset:25344
  v_mfma_f32_16x16x32_bf16 v[12:15], v[116:119], a[116:119], v[12:15]
  buffer_load_dwordx4 a[148:151], v251, s[16:19], s53 offen offset:1024 sc1
  ds_read_b64_tr_b16 v[114:115], v222 offset:25856
  s_waitcnt lgkmcnt(10)
  v_mfma_f32_16x16x32_bf16 v[16:19], v[120:123], a[112:115], v[16:19]
  ds_read_b64_tr_b16 v[116:117], v222 offset:25376
  v_mfma_f32_16x16x32_bf16 v[20:23], v[120:123], a[116:119], v[20:23]
  ds_read_b64_tr_b16 v[118:119], v222 offset:25888
  v_mov_b32 v203, 0
  v_mfma_f32_16x16x32_bf16 v[24:27], v[124:127], a[112:115], v[24:27]
  ds_read_b64_tr_b16 v[120:121], v222 offset:25408
  v_mfma_f32_16x16x32_bf16 v[28:31], v[124:127], a[116:119], v[28:31]
  buffer_load_dwordx4 a[152:155], v251, s[16:19], s53 offen offset:2048 sc1
  ds_read_b64_tr_b16 v[122:123], v222 offset:25920
  s_waitcnt lgkmcnt(10)
  v_mfma_f32_16x16x32_bf16 v[32:35], v[128:131], a[112:115], v[32:35]
  ds_read_b64_tr_b16 v[124:125], v222 offset:25440
  v_mfma_f32_16x16x32_bf16 v[36:39], v[128:131], a[116:119], v[36:39]
  ds_read_b64_tr_b16 v[126:127], v222 offset:25952
  v_sqrt_f32 v184, v192
  v_mfma_f32_16x16x32_bf16 v[40:43], v[132:135], a[112:115], v[40:43]
  ds_read_b64_tr_b16 v[128:129], v222 offset:25472
  v_mfma_f32_16x16x32_bf16 v[44:47], v[132:135], a[116:119], v[44:47]
  buffer_load_dwordx4 a[156:159], v251, s[16:19], s53 offen offset:3072 sc1
  ds_read_b64_tr_b16 v[130:131], v222 offset:25984
  s_waitcnt lgkmcnt(10)
  v_mfma_f32_16x16x32_bf16 v[48:51], v[136:139], a[112:115], v[48:51]
  ds_read_b64_tr_b16 v[132:133], v222 offset:25504
  v_mfma_f32_16x16x32_bf16 v[52:55], v[136:139], a[116:119], v[52:55]
  ds_read_b64_tr_b16 v[134:135], v222 offset:26016
  v_rcp_f32 v254, v192
  s_mov_b32 s53, 40960
  v_mfma_f32_16x16x32_bf16 v[56:59], v[140:143], a[112:115], v[56:59]
  ds_read_b64_tr_b16 v[136:137], v222 offset:25536
  v_mfma_f32_16x16x32_bf16 v[60:63], v[140:143], a[116:119], v[60:63]
  buffer_load_dwordx4 a[160:163], v251, s[16:19], s53 offen offset:0 sc1
  ds_read_b64_tr_b16 v[138:139], v222 offset:26048
  s_waitcnt vmcnt(17) lgkmcnt(10)
  v_mfma_f32_16x16x32_bf16 v[0:3], v[112:115], a[120:123], v[0:3]
  ds_read_b64_tr_b16 v[140:141], v222 offset:25568
  v_mfma_f32_16x16x32_bf16 v[4:7], v[112:115], a[124:127], v[4:7]
  ds_read_b64_tr_b16 v[142:143], v222 offset:26080
  v_cvt_pk_bf16_f32 v185, v184, v184
  v_mfma_f32_16x16x32_bf16 v[8:11], v[116:119], a[120:123], v[8:11]
  s_barrier
  ds_read_b64_tr_b16 v[112:113], v220 offset:0
  v_mfma_f32_16x16x32_bf16 v[12:15], v[116:119], a[124:127], v[12:15]
  ds_read_b64_tr_b16 v[114:115], v220 offset:512
  s_waitcnt lgkmcnt(10)
  v_mfma_f32_16x16x32_bf16 v[16:19], v[120:123], a[120:123], v[16:19]
  ds_read_b64_tr_b16 v[116:117], v220 offset:32
  v_mfma_f32_16x16x32_bf16 v[20:23], v[120:123], a[124:127], v[20:23]
  ds_read_b64_tr_b16 v[118:119], v220 offset:544
  v_and_b32 v185, 0xffff0000, v185
  v_mfma_f32_16x16x32_bf16 v[24:27], v[124:127], a[120:123], v[24:27]
  ds_read_b64_tr_b16 v[120:121], v220 offset:64
  v_mfma_f32_16x16x32_bf16 v[28:31], v[124:127], a[124:127], v[28:31]
  buffer_load_dwordx4 a[164:167], v251, s[16:19], s53 offen offset:1024 sc1
  ds_read_b64_tr_b16 v[122:123], v220 offset:576
  s_waitcnt lgkmcnt(10)
  v_mfma_f32_16x16x32_bf16 v[32:35], v[128:131], a[120:123], v[32:35]
  ds_read_b64_tr_b16 v[124:125], v220 offset:96
  v_mfma_f32_16x16x32_bf16 v[36:39], v[128:131], a[124:127], v[36:39]
  ds_read_b64_tr_b16 v[126:127], v220 offset:608
  v_sub_f32 v185, v184, v185
  v_mfma_f32_16x16x32_bf16 v[40:43], v[132:135], a[120:123], v[40:43]
  ds_read_b64_tr_b16 v[128:129], v220 offset:128
  v_mfma_f32_16x16x32_bf16 v[44:47], v[132:135], a[124:127], v[44:47]
  buffer_load_dwordx4 a[168:171], v251, s[16:19], s53 offen offset:2048 sc1
  ds_read_b64_tr_b16 v[130:131], v220 offset:640
  s_waitcnt lgkmcnt(10)
  v_mfma_f32_16x16x32_bf16 v[48:51], v[136:139], a[120:123], v[48:51]
  ds_read_b64_tr_b16 v[132:133], v220 offset:160
  v_mfma_f32_16x16x32_bf16 v[52:55], v[136:139], a[124:127], v[52:55]
  ds_read_b64_tr_b16 v[134:135], v220 offset:672
  v_cvt_pk_bf16_f32 v200, v184, v185
  v_mfma_f32_16x16x32_bf16 v[56:59], v[140:143], a[120:123], v[56:59]
  ds_read_b64_tr_b16 v[136:137], v220 offset:192
  v_mfma_f32_16x16x32_bf16 v[60:63], v[140:143], a[124:127], v[60:63]
  buffer_load_dwordx4 a[172:175], v251, s[16:19], s53 offen offset:3072 sc1
  ds_read_b64_tr_b16 v[138:139], v220 offset:704
  s_waitcnt vmcnt(18) lgkmcnt(10)
  v_mfma_f32_16x16x32_bf16 v[0:3], v[112:115], a[128:131], v[0:3]
  ds_read_b64_tr_b16 v[140:141], v220 offset:224
  v_mfma_f32_16x16x32_bf16 v[4:7], v[112:115], a[132:135], v[4:7]
  ds_read_b64_tr_b16 v[142:143], v220 offset:736
  v_cvt_pk_bf16_f32 v185, v192, v192
  s_add_u32 s52, s84, 5049344
  s_add_u32 m0, s56, 67584
  v_mfma_f32_16x16x32_bf16 v[8:11], v[116:119], a[128:131], v[8:11]
  ds_read_b64_tr_b16 v[112:113], v220 offset:8448
  v_mfma_f32_16x16x32_bf16 v[12:15], v[116:119], a[132:135], v[12:15]
  buffer_load_dwordx4 v208, s[12:15], s52 offen offset:0 lds
  ds_read_b64_tr_b16 v[114:115], v220 offset:8960
  s_waitcnt lgkmcnt(10)
  v_mfma_f32_16x16x32_bf16 v[16:19], v[120:123], a[128:131], v[16:19]
  ds_read_b64_tr_b16 v[116:117], v220 offset:8480
  v_mfma_f32_16x16x32_bf16 v[20:23], v[120:123], a[132:135], v[20:23]
  ds_read_b64_tr_b16 v[118:119], v220 offset:8992
  v_and_b32 v185, 0xffff0000, v185
  v_mfma_f32_16x16x32_bf16 v[24:27], v[124:127], a[128:131], v[24:27]
  ds_read_b64_tr_b16 v[120:121], v220 offset:8512
  v_mfma_f32_16x16x32_bf16 v[28:31], v[124:127], a[132:135], v[28:31]
  buffer_load_dwordx4 v209, s[12:15], s52 offen offset:1056 lds
  ds_read_b64_tr_b16 v[122:123], v220 offset:9024
  s_waitcnt lgkmcnt(10)
  v_mfma_f32_16x16x32_bf16 v[32:35], v[128:131], a[128:131], v[32:35]
  ds_read_b64_tr_b16 v[124:125], v220 offset:8544
  v_mfma_f32_16x16x32_bf16 v[36:39], v[128:131], a[132:135], v[36:39]
  ds_read_b64_tr_b16 v[126:127], v220 offset:9056
  v_sub_f32 v185, v192, v185
  v_mfma_f32_16x16x32_bf16 v[40:43], v[132:135], a[128:131], v[40:43]
  ds_read_b64_tr_b16 v[128:129], v220 offset:8576
  v_mfma_f32_16x16x32_bf16 v[44:47], v[132:135], a[132:135], v[44:47]
  buffer_load_dwordx4 v210, s[12:15], s52 offen offset:2112 lds
  ds_read_b64_tr_b16 v[130:131], v220 offset:9088
  s_waitcnt lgkmcnt(10)
  v_mfma_f32_16x16x32_bf16 v[48:51], v[136:139], a[128:131], v[48:51]
  ds_read_b64_tr_b16 v[132:133], v220 offset:8608
  v_mfma_f32_16x16x32_bf16 v[52:55], v[136:139], a[132:135], v[52:55]
  ds_read_b64_tr_b16 v[134:135], v220 offset:9120
  v_cvt_pk_bf16_f32 v234, v192, v185
  v_mfma_f32_16x16x32_bf16 v[56:59], v[140:143], a[128:131], v[56:59]
  ds_read_b64_tr_b16 v[136:137], v220 offset:8640
  v_mfma_f32_16x16x32_bf16 v[60:63], v[140:143], a[132:135], v[60:63]
  buffer_load_dwordx4 v211, s[12:15], s52 offen offset:3168 lds
  ds_read_b64_tr_b16 v[138:139], v220 offset:9152
  s_waitcnt vmcnt(20) lgkmcnt(10)
  v_mfma_f32_16x16x32_bf16 v[0:3], v[112:115], a[136:139], v[0:3]
  ds_read_b64_tr_b16 v[140:141], v220 offset:8672
  v_mfma_f32_16x16x32_bf16 v[4:7], v[112:115], a[140:143], v[4:7]
  ds_read_b64_tr_b16 v[142:143], v220 offset:9184
  v_mul_f32 v186, v192, v252
  s_add_u32 s52, s84, 4590592
  s_add_u32 m0, s56, 84480
  v_mfma_f32_16x16x32_bf16 v[8:11], v[116:119], a[136:139], v[8:11]
  ds_read_b64_tr_b16 v[112:113], v220 offset:16896
  v_mfma_f32_16x16x32_bf16 v[12:15], v[116:119], a[140:143], v[12:15]
  buffer_load_dwordx4 v208, s[12:15], s52 offen offset:0 lds
  ds_read_b64_tr_b16 v[114:115], v220 offset:17408
  s_waitcnt lgkmcnt(10)
  v_mfma_f32_16x16x32_bf16 v[16:19], v[120:123], a[136:139], v[16:19]
  ds_read_b64_tr_b16 v[116:117], v220 offset:16928
  v_mfma_f32_16x16x32_bf16 v[20:23], v[120:123], a[140:143], v[20:23]
  ds_read_b64_tr_b16 v[118:119], v220 offset:17440
  v_cvt_pk_bf16_f32 v185, v186, v186
  v_mfma_f32_16x16x32_bf16 v[24:27], v[124:127], a[136:139], v[24:27]
  ds_read_b64_tr_b16 v[120:121], v220 offset:16960
  v_mfma_f32_16x16x32_bf16 v[28:31], v[124:127], a[140:143], v[28:31]
  buffer_load_dwordx4 v209, s[12:15], s52 offen offset:1056 lds
  ds_read_b64_tr_b16 v[122:123], v220 offset:17472
  s_waitcnt lgkmcnt(10)
  v_mfma_f32_16x16x32_bf16 v[32:35], v[128:131], a[136:139], v[32:35]
  ds_read_b64_tr_b16 v[124:125], v220 offset:16992
  v_mfma_f32_16x16x32_bf16 v[36:39], v[128:131], a[140:143], v[36:39]
  ds_read_b64_tr_b16 v[126:127], v220 offset:17504
  v_and_b32 v185, 0xffff0000, v185
  v_mfma_f32_16x16x32_bf16 v[40:43], v[132:135], a[136:139], v[40:43]
  ds_read_b64_tr_b16 v[128:129], v220 offset:17024
  v_mfma_f32_16x16x32_bf16 v[44:47], v[132:135], a[140:143], v[44:47]
  buffer_load_dwordx4 v210, s[12:15], s52 offen offset:2112 lds
  ds_read_b64_tr_b16 v[130:131], v220 offset:17536
  s_waitcnt lgkmcnt(10)
  v_mfma_f32_16x16x32_bf16 v[48:51], v[136:139], a[136:139], v[48:51]
  ds_read_b64_tr_b16 v[132:133], v220 offset:17056
  v_mfma_f32_16x16x32_bf16 v[52:55], v[136:139], a[140:143], v[52:55]
  ds_read_b64_tr_b16 v[134:135], v220 offset:17568
  v_sub_f32 v185, v186, v185
  v_mfma_f32_16x16x32_bf16 v[56:59], v[140:143], a[136:139], v[56:59]
  ds_read_b64_tr_b16 v[136:137], v220 offset:17088
  v_mfma_f32_16x16x32_bf16 v[60:63], v[140:143], a[140:143], v[60:63]
  buffer_load_dwordx4 v211, s[12:15], s52 offen offset:3168 lds
  ds_read_b64_tr_b16 v[138:139], v220 offset:17600
  s_waitcnt vmcnt(14) lgkmcnt(10)
  v_mfma_f32_16x16x32_bf16 v[0:3], v[112:115], a[144:147], v[0:3]
  ds_read_b64_tr_b16 v[140:141], v220 offset:17120
  v_mfma_f32_16x16x32_bf16 v[4:7], v[112:115], a[148:151], v[4:7]
  ds_read_b64_tr_b16 v[142:143], v220 offset:17632
  v_cvt_pk_bf16_f32 v235, v186, v185
  s_mov_b32 s53, 45056
  v_mfma_f32_16x16x32_bf16 v[8:11], v[116:119], a[144:147], v[8:11]
  ds_read_b64_tr_b16 v[112:113], v220 offset:25344
  v_mfma_f32_16x16x32_bf16 v[12:15], v[116:119], a[148:151], v[12:15]
  buffer_load_dwordx4 a[176:179], v251, s[16:19], s53 offen offset:0 sc1
  ds_read_b64_tr_b16 v[114:115], v220 offset:25856
  s_waitcnt lgkmcnt(10)
  v_mfma_f32_16x16x32_bf16 v[16:19], v[120:123], a[144:147], v[16:19]
  ds_read_b64_tr_b16 v[116:117], v220 offset:25376
  v_mfma_f32_16x16x32_bf16 v[20:23], v[120:123], a[148:151], v[20:23]
  ds_read_b64_tr_b16 v[118:119], v220 offset:25888
  v_sqrt_f32 v184, v193
  v_mfma_f32_16x16x32_bf16 v[24:27], v[124:127], a[144:147], v[24:27]
  ds_read_b64_tr_b16 v[120:121], v220 offset:25408
  v_mfma_f32_16x16x32_bf16 v[28:31], v[124:127], a[148:151], v[28:31]
  buffer_load_dwordx4 a[180:183], v251, s[16:19], s53 offen offset:1024 sc1
  ds_read_b64_tr_b16 v[122:123], v220 offset:25920
  s_waitcnt lgkmcnt(10)
  v_mfma_f32_16x16x32_bf16 v[32:35], v[128:131], a[144:147], v[32:35]
  ds_read_b64_tr_b16 v[124:125], v220 offset:25440
  v_mfma_f32_16x16x32_bf16 v[36:39], v[128:131], a[148:151], v[36:39]
  ds_read_b64_tr_b16 v[126:127], v220 offset:25952
  v_rcp_f32 v255, v193
  v_mfma_f32_16x16x32_bf16 v[40:43], v[132:135], a[144:147], v[40:43]
  ds_read_b64_tr_b16 v[128:129], v220 offset:25472
  v_mfma_f32_16x16x32_bf16 v[44:47], v[132:135], a[148:151], v[44:47]
  buffer_load_dwordx4 a[184:187], v251, s[16:19], s53 offen offset:2048 sc1
  ds_read_b64_tr_b16 v[130:131], v220 offset:25984
  s_waitcnt lgkmcnt(10)
  v_mfma_f32_16x16x32_bf16 v[48:51], v[136:139], a[144:147], v[48:51]
  ds_read_b64_tr_b16 v[132:133], v220 offset:25504
  v_mfma_f32_16x16x32_bf16 v[52:55], v[136:139], a[148:151], v[52:55]
  ds_read_b64_tr_b16 v[134:135], v220 offset:26016
  v_cvt_pk_bf16_f32 v185, v184, v184
  v_mfma_f32_16x16x32_bf16 v[56:59], v[140:143], a[144:147], v[56:59]
  ds_read_b64_tr_b16 v[136:137], v220 offset:25536
  v_mfma_f32_16x16x32_bf16 v[60:63], v[140:143], a[148:151], v[60:63]
  buffer_load_dwordx4 a[188:191], v251, s[16:19], s53 offen offset:3072 sc1
  ds_read_b64_tr_b16 v[138:139], v220 offset:26048
  s_waitcnt vmcnt(16) lgkmcnt(10)
  v_mfma_f32_16x16x32_bf16 v[0:3], v[112:115], a[152:155], v[0:3]
  ds_read_b64_tr_b16 v[140:141], v220 offset:25568
  v_mfma_f32_16x16x32_bf16 v[4:7], v[112:115], a[156:159], v[4:7]
  ds_read_b64_tr_b16 v[142:143], v220 offset:26080
  v_and_b32 v185, 0xffff0000, v185
  v_mfma_f32_16x16x32_bf16 v[8:11], v[116:119], a[152:155], v[8:11]
  s_barrier
  ds_read_b64_tr_b16 v[112:113], v220 offset:33792
  v_mfma_f32_16x16x32_bf16 v[12:15], v[116:119], a[156:159], v[12:15]
  ds_read_b64_tr_b16 v[114:115], v220 offset:34304
  s_waitcnt lgkmcnt(10)
  v_mfma_f32_16x16x32_bf16 v[16:19], v[120:123], a[152:155], v[16:19]
  ds_read_b64_tr_b16 v[116:117], v220 offset:33824
  v_mfma_f32_16x16x32_bf16 v[20:23], v[120:123], a[156:159], v[20:23]
  ds_read_b64_tr_b16 v[118:119], v220 offset:34336
  v_sub_f32 v185, v184, v185
  s_mov_b32 s53, 49152
  v_mfma_f32_16x16x32_bf16 v[24:27], v[124:127], a[152:155], v[24:27]
  ds_read_b64_tr_b16 v[120:121], v220 offset:33856
  v_mfma_f32_16x16x32_bf16 v[28:31], v[124:127], a[156:159], v[28:31]
  buffer_load_dwordx4 a[192:195], v251, s[16:19], s53 offen offset:0 sc1
  ds_read_b64_tr_b16 v[122:123], v220 offset:34368
  s_waitcnt lgkmcnt(10)
  v_mfma_f32_16x16x32_bf16 v[32:35], v[128:131], a[152:155], v[32:35]
  ds_read_b64_tr_b16 v[124:125], v220 offset:33888
  v_mfma_f32_16x16x32_bf16 v[36:39], v[128:131], a[156:159], v[36:39]
  ds_read_b64_tr_b16 v[126:127], v220 offset:34400
  v_cvt_pk_bf16_f32 v202, v184, v185
  v_mfma_f32_16x16x32_bf16 v[40:43], v[132:135], a[152:155], v[40:43]
  ds_read_b64_tr_b16 v[128:129], v220 offset:33920
  v_mfma_f32_16x16x32_bf16 v[44:47], v[132:135], a[156:159], v[44:47]
  buffer_load_dwordx4 a[196:199], v251, s[16:19], s53 offen offset:1024 sc1
  ds_read_b64_tr_b16 v[130:131], v220 offset:34432
  s_waitcnt lgkmcnt(10)
  v_mfma_f32_16x16x32_bf16 v[48:51], v[136:139], a[152:155], v[48:51]
  ds_read_b64_tr_b16 v[132:133], v220 offset:33952
  v_mfma_f32_16x16x32_bf16 v[52:55], v[136:139], a[156:159], v[52:55]
  ds_read_b64_tr_b16 v[134:135], v220 offset:34464
  v_cvt_pk_bf16_f32 v185, v193, v193
  v_mfma_f32_16x16x32_bf16 v[56:59], v[140:143], a[152:155], v[56:59]
  ds_read_b64_tr_b16 v[136:137], v220 offset:33984
  v_mfma_f32_16x16x32_bf16 v[60:63], v[140:143], a[156:159], v[60:63]
  buffer_load_dwordx4 a[200:203], v251, s[16:19], s53 offen offset:2048 sc1
  ds_read_b64_tr_b16 v[138:139], v220 offset:34496
  s_waitcnt vmcnt(17) lgkmcnt(10)
  v_mfma_f32_16x16x32_bf16 v[0:3], v[112:115], a[160:163], v[0:3]
  ds_read_b64_tr_b16 v[140:141], v220 offset:34016
  v_mfma_f32_16x16x32_bf16 v[4:7], v[112:115], a[164:167], v[4:7]
  ds_read_b64_tr_b16 v[142:143], v220 offset:34528
  v_and_b32 v185, 0xffff0000, v185
  v_mfma_f32_16x16x32_bf16 v[8:11], v[116:119], a[160:163], v[8:11]
  ds_read_b64_tr_b16 v[112:113], v220 offset:42240
  v_mfma_f32_16x16x32_bf16 v[12:15], v[116:119], a[164:167], v[12:15]
  buffer_load_dwordx4 a[204:207], v251, s[16:19], s53 offen offset:3072 sc1
  ds_read_b64_tr_b16 v[114:115], v220 offset:42752
  s_waitcnt lgkmcnt(10)
  v_mfma_f32_16x16x32_bf16 v[16:19], v[120:123], a[160:163], v[16:19]
  ds_read_b64_tr_b16 v[116:117], v220 offset:42272
  v_mfma_f32_16x16x32_bf16 v[20:23], v[120:123], a[164:167], v[20:23]
  ds_read_b64_tr_b16 v[118:119], v220 offset:42784
  v_sub_f32 v185, v193, v185
  s_add_u32 s52, s84, 4131840
  s_add_u32 m0, s56, 101376
  v_mfma_f32_16x16x32_bf16 v[24:27], v[124:127], a[160:163], v[24:27]
  ds_read_b64_tr_b16 v[120:121], v220 offset:42304
  v_mfma_f32_16x16x32_bf16 v[28:31], v[124:127], a[164:167], v[28:31]
  buffer_load_dwordx4 v208, s[12:15], s52 offen offset:0 lds
  ds_read_b64_tr_b16 v[122:123], v220 offset:42816
  s_waitcnt lgkmcnt(10)
  v_mfma_f32_16x16x32_bf16 v[32:35], v[128:131], a[160:163], v[32:35]
  ds_read_b64_tr_b16 v[124:125], v220 offset:42336
  v_mfma_f32_16x16x32_bf16 v[36:39], v[128:131], a[164:167], v[36:39]
  ds_read_b64_tr_b16 v[126:127], v220 offset:42848
  v_cvt_pk_bf16_f32 v236, v193, v185
  v_mfma_f32_16x16x32_bf16 v[40:43], v[132:135], a[160:163], v[40:43]
  ds_read_b64_tr_b16 v[128:129], v220 offset:42368
  v_mfma_f32_16x16x32_bf16 v[44:47], v[132:135], a[164:167], v[44:47]
  buffer_load_dwordx4 v209, s[12:15], s52 offen offset:1056 lds
  ds_read_b64_tr_b16 v[130:131], v220 offset:42880
  s_waitcnt lgkmcnt(10)
  v_mfma_f32_16x16x32_bf16 v[48:51], v[136:139], a[160:163], v[48:51]
  ds_read_b64_tr_b16 v[132:133], v220 offset:42400
  v_mfma_f32_16x16x32_bf16 v[52:55], v[136:139], a[164:167], v[52:55]
  ds_read_b64_tr_b16 v[134:135], v220 offset:42912
  v_mul_f32 v186, v193, v253
  v_mfma_f32_16x16x32_bf16 v[56:59], v[140:143], a[160:163], v[56:59]
  ds_read_b64_tr_b16 v[136:137], v220 offset:42432
  v_mfma_f32_16x16x32_bf16 v[60:63], v[140:143], a[164:167], v[60:63]
  buffer_load_dwordx4 v210, s[12:15], s52 offen offset:2112 lds
  ds_read_b64_tr_b16 v[138:139], v220 offset:42944
  s_waitcnt vmcnt(19) lgkmcnt(10)
  v_mfma_f32_16x16x32_bf16 v[0:3], v[112:115], a[168:171], v[0:3]
  ds_read_b64_tr_b16 v[140:141], v220 offset:42464
  v_mfma_f32_16x16x32_bf16 v[4:7], v[112:115], a[172:175], v[4:7]
  ds_read_b64_tr_b16 v[142:143], v220 offset:42976
  v_cvt_pk_bf16_f32 v185, v186, v186
  v_mfma_f32_16x16x32_bf16 v[8:11], v[116:119], a[168:171], v[8:11]
  ds_read_b64_tr_b16 v[112:113], v221 offset:0
  v_mfma_f32_16x16x32_bf16 v[12:15], v[116:119], a[172:175], v[12:15]
  buffer_load_dwordx4 v211, s[12:15], s52 offen offset:3168 lds
  ds_read_b64_tr_b16 v[114:115], v221 offset:512
  s_waitcnt lgkmcnt(10)
  v_mfma_f32_16x16x32_bf16 v[16:19], v[120:123], a[168:171], v[16:19]
  ds_read_b64_tr_b16 v[116:117], v221 offset:32
  v_mfma_f32_16x16x32_bf16 v[20:23], v[120:123], a[172:175], v[20:23]
  ds_read_b64_tr_b16 v[118:119], v221 offset:544
  v_and_b32 v185, 0xffff0000, v185
  s_add_u32 s52, s84, 3673088
  s_add_u32 m0, s56, 118272
  v_mfma_f32_16x16x32_bf16 v[24:27], v[124:127], a[168:171], v[24:27]
  ds_read_b64_tr_b16 v[120:121], v221 offset:64
  v_mfma_f32_16x16x32_bf16 v[28:31], v[124:127], a[172:175], v[28:31]
  buffer_load_dwordx4 v208, s[12:15], s52 offen offset:0 lds
  ds_read_b64_tr_b16 v[122:123], v221 offset:576
  s_waitcnt lgkmcnt(10)
  v_mfma_f32_16x16x32_bf16 v[32:35], v[128:131], a[168:171], v[32:35]
  ds_read_b64_tr_b16 v[124:125], v221 offset:96
  v_mfma_f32_16x16x32_bf16 v[36:39], v[128:131], a[172:175], v[36:39]
  ds_read_b64_tr_b16 v[126:127], v221 offset:608
  v_sub_f32 v185, v186, v185
  v_mfma_f32_16x16x32_bf16 v[40:43], v[132:135], a[168:171], v[40:43]
  ds_read_b64_tr_b16 v[128:129], v221 offset:128
  v_mfma_f32_16x16x32_bf16 v[44:47], v[132:135], a[172:175], v[44:47]
  buffer_load_dwordx4 v209, s[12:15], s52 offen offset:1056 lds
  ds_read_b64_tr_b16 v[130:131], v221 offset:640
  s_waitcnt lgkmcnt(10)
  v_mfma_f32_16x16x32_bf16 v[48:51], v[136:139], a[168:171], v[48:51]
  ds_read_b64_tr_b16 v[132:133], v221 offset:160
  v_mfma_f32_16x16x32_bf16 v[52:55], v[136:139], a[172:175], v[52:55]
  ds_read_b64_tr_b16 v[134:135], v221 offset:672
  v_cvt_pk_bf16_f32 v237, v186, v185
  v_mfma_f32_16x16x32_bf16 v[56:59], v[140:143], a[168:171], v[56:59]
  ds_read_b64_tr_b16 v[136:137], v221 offset:192
  v_mfma_f32_16x16x32_bf16 v[60:63], v[140:143], a[172:175], v[60:63]
  buffer_load_dwordx4 v210, s[12:15], s52 offen offset:2112 lds
  ds_read_b64_tr_b16 v[138:139], v221 offset:704
  s_waitcnt vmcnt(13) lgkmcnt(10)
  v_mfma_f32_16x16x32_bf16 v[0:3], v[112:115], a[176:179], v[0:3]
  ds_read_b64_tr_b16 v[140:141], v221 offset:224
  v_mfma_f32_16x16x32_bf16 v[4:7], v[112:115], a[180:183], v[4:7]
  ds_read_b64_tr_b16 v[142:143], v221 offset:736
  v_lshlrev_b32 v238, 1, v249
  v_mfma_f32_16x16x32_bf16 v[8:11], v[116:119], a[176:179], v[8:11]
  ds_read_b64_tr_b16 v[112:113], v221 offset:8448
  v_mfma_f32_16x16x32_bf16 v[12:15], v[116:119], a[180:183], v[12:15]
  buffer_load_dwordx4 v211, s[12:15], s52 offen offset:3168 lds
  ds_read_b64_tr_b16 v[114:115], v221 offset:8960
  s_waitcnt lgkmcnt(10)
  v_mfma_f32_16x16x32_bf16 v[16:19], v[120:123], a[176:179], v[16:19]
  ds_read_b64_tr_b16 v[116:117], v221 offset:8480
  v_mfma_f32_16x16x32_bf16 v[20:23], v[120:123], a[180:183], v[20:23]
  ds_read_b64_tr_b16 v[118:119], v221 offset:8992
  v_lshl_add_u32 v238, v250, 28, v238
  s_mov_b32 s53, 53248
  v_mfma_f32_16x16x32_bf16 v[24:27], v[124:127], a[176:179], v[24:27]
  ds_read_b64_tr_b16 v[120:121], v221 offset:8512
  v_mfma_f32_16x16x32_bf16 v[28:31], v[124:127], a[180:183], v[28:31]
  buffer_load_dwordx4 a[208:211], v251, s[16:19], s53 offen offset:0 sc1
  ds_read_b64_tr_b16 v[122:123], v221 offset:9024
  s_waitcnt lgkmcnt(10)
  v_mfma_f32_16x16x32_bf16 v[32:35], v[128:131], a[176:179], v[32:35]
  ds_read_b64_tr_b16 v[124:125], v221 offset:8544
  v_mfma_f32_16x16x32_bf16 v[36:39], v[128:131], a[180:183], v[36:39]
  ds_read_b64_tr_b16 v[126:127], v221 offset:9056
  v_mov_b32 v177, 0
  v_mfma_f32_16x16x32_bf16 v[40:43], v[132:135], a[176:179], v[40:43]
  ds_read_b64_tr_b16 v[128:129], v221 offset:8576
  v_mfma_f32_16x16x32_bf16 v[44:47], v[132:135], a[180:183], v[44:47]
  buffer_load_dwordx4 a[212:215], v251, s[16:19], s53 offen offset:1024 sc1
  ds_read_b64_tr_b16 v[130:131], v221 offset:9088
  s_waitcnt lgkmcnt(10)
  v_mfma_f32_16x16x32_bf16 v[48:51], v[136:139], a[176:179], v[48:51]
  ds_read_b64_tr_b16 v[132:133], v221 offset:8608
  v_mfma_f32_16x16x32_bf16 v[52:55], v[136:139], a[180:183], v[52:55]
  ds_read_b64_tr_b16 v[134:135], v221 offset:9120
  v_mov_b32 v179, 0
  v_mfma_f32_16x16x32_bf16 v[56:59], v[140:143], a[176:179], v[56:59]
  ds_read_b64_tr_b16 v[136:137], v221 offset:8640
  v_mfma_f32_16x16x32_bf16 v[60:63], v[140:143], a[180:183], v[60:63]
  buffer_load_dwordx4 a[216:219], v251, s[16:19], s53 offen offset:2048 sc1
  ds_read_b64_tr_b16 v[138:139], v221 offset:9152
  s_waitcnt vmcnt(15) lgkmcnt(10)
  v_mfma_f32_16x16x32_bf16 v[0:3], v[112:115], a[184:187], v[0:3]
  ds_read_b64_tr_b16 v[140:141], v221 offset:8672
  v_mfma_f32_16x16x32_bf16 v[4:7], v[112:115], a[188:191], v[4:7]
  ds_read_b64_tr_b16 v[142:143], v221 offset:9184
  v_mov_b32 v181, 0
  v_mfma_f32_16x16x32_bf16 v[8:11], v[116:119], a[184:187], v[8:11]
  s_barrier
  ds_read_b64_tr_b16 v[112:113], v221 offset:16896
  v_mfma_f32_16x16x32_bf16 v[12:15], v[116:119], a[188:191], v[12:15]
  ds_read_b64_tr_b16 v[114:115], v221 offset:17408
  s_waitcnt lgkmcnt(10)
  v_mfma_f32_16x16x32_bf16 v[16:19], v[120:123], a[184:187], v[16:19]
  ds_read_b64_tr_b16 v[116:117], v221 offset:16928
  v_mfma_f32_16x16x32_bf16 v[20:23], v[120:123], a[188:191], v[20:23]
  ds_read_b64_tr_b16 v[118:119], v221 offset:17440
  v_mov_b32 v183, 0
  v_mfma_f32_16x16x32_bf16 v[24:27], v[124:127], a[184:187], v[24:27]
  ds_read_b64_tr_b16 v[120:121], v221 offset:16960
  v_mfma_f32_16x16x32_bf16 v[28:31], v[124:127], a[188:191], v[28:31]
  buffer_load_dwordx4 a[220:223], v251, s[16:19], s53 offen offset:3072 sc1
  ds_read_b64_tr_b16 v[122:123], v221 offset:17472
  s_waitcnt lgkmcnt(10)
  v_mfma_f32_16x16x32_bf16 v[32:35], v[128:131], a[184:187], v[32:35]
  ds_read_b64_tr_b16 v[124:125], v221 offset:16992
  v_mfma_f32_16x16x32_bf16 v[36:39], v[128:131], a[188:191], v[36:39]
  ds_read_b64_tr_b16 v[126:127], v221 offset:17504
  v_mov_b32 v185, 0
  s_mov_b32 s53, 57344
  v_mfma_f32_16x16x32_bf16 v[40:43], v[132:135], a[184:187], v[40:43]
  ds_read_b64_tr_b16 v[128:129], v221 offset:17024
  v_mfma_f32_16x16x32_bf16 v[44:47], v[132:135], a[188:191], v[44:47]
  buffer_load_dwordx4 a[224:227], v251, s[16:19], s53 offen offset:0 sc1
  ds_read_b64_tr_b16 v[130:131], v221 offset:17536
  s_waitcnt lgkmcnt(10)
  v_mfma_f32_16x16x32_bf16 v[48:51], v[136:139], a[184:187], v[48:51]
  ds_read_b64_tr_b16 v[132:133], v221 offset:17056
  v_mfma_f32_16x16x32_bf16 v[52:55], v[136:139], a[188:191], v[52:55]
  ds_read_b64_tr_b16 v[134:135], v221 offset:17568
  v_mov_b32 v187, 0
  v_mfma_f32_16x16x32_bf16 v[56:59], v[140:143], a[184:187], v[56:59]
  ds_read_b64_tr_b16 v[136:137], v221 offset:17088
  v_mfma_f32_16x16x32_bf16 v[60:63], v[140:143], a[188:191], v[60:63]
  buffer_load_dwordx4 a[228:231], v251, s[16:19], s53 offen offset:1024 sc1
  ds_read_b64_tr_b16 v[138:139], v221 offset:17600
  s_waitcnt vmcnt(16) lgkmcnt(10)
  v_mfma_f32_16x16x32_bf16 v[0:3], v[112:115], a[192:195], v[0:3]
  ds_read_b64_tr_b16 v[140:141], v221 offset:17120
  v_mfma_f32_16x16x32_bf16 v[4:7], v[112:115], a[196:199], v[4:7]
  ds_read_b64_tr_b16 v[142:143], v221 offset:17632
  v_mov_b32 v189, 0
  v_mfma_f32_16x16x32_bf16 v[8:11], v[116:119], a[192:195], v[8:11]
  ds_read_b64_tr_b16 v[112:113], v221 offset:25344
  v_mfma_f32_16x16x32_bf16 v[12:15], v[116:119], a[196:199], v[12:15]
  buffer_load_dwordx4 a[232:235], v251, s[16:19], s53 offen offset:2048 sc1
  ds_read_b64_tr_b16 v[114:115], v221 offset:25856
  s_waitcnt lgkmcnt(10)
  v_mfma_f32_16x16x32_bf16 v[16:19], v[120:123], a[192:195], v[16:19]
  ds_read_b64_tr_b16 v[116:117], v221 offset:25376
  v_mfma_f32_16x16x32_bf16 v[20:23], v[120:123], a[196:199], v[20:23]
  ds_read_b64_tr_b16 v[118:119], v221 offset:25888
  v_mov_b32 v191, 0
  v_mfma_f32_16x16x32_bf16 v[24:27], v[124:127], a[192:195], v[24:27]
  ds_read_b64_tr_b16 v[120:121], v221 offset:25408
  v_mfma_f32_16x16x32_bf16 v[28:31], v[124:127], a[196:199], v[28:31]
  buffer_load_dwordx4 a[236:239], v251, s[16:19], s53 offen offset:3072 sc1
  ds_read_b64_tr_b16 v[122:123], v221 offset:25920
  s_waitcnt lgkmcnt(10)
  v_mfma_f32_16x16x32_bf16 v[32:35], v[128:131], a[192:195], v[32:35]
  ds_read_b64_tr_b16 v[124:125], v221 offset:25440
  v_mfma_f32_16x16x32_bf16 v[36:39], v[128:131], a[196:199], v[36:39]
  ds_read_b64_tr_b16 v[126:127], v221 offset:25952
  s_add_u32 s52, s85, 0
  s_add_u32 m0, s44, 16896
  v_mfma_f32_16x16x32_bf16 v[40:43], v[132:135], a[192:195], v[40:43]
  ds_read_b64_tr_b16 v[128:129], v221 offset:25472
  v_mfma_f32_16x16x32_bf16 v[44:47], v[132:135], a[196:199], v[44:47]
  buffer_load_dwordx4 v213, s[12:15], s52 offen offset:0 lds
  ds_read_b64_tr_b16 v[130:131], v221 offset:25984
  s_waitcnt lgkmcnt(10)
  v_mfma_f32_16x16x32_bf16 v[48:51], v[136:139], a[192:195], v[48:51]
  ds_read_b64_tr_b16 v[132:133], v221 offset:25504
  v_mfma_f32_16x16x32_bf16 v[52:55], v[136:139], a[196:199], v[52:55]
  ds_read_b64_tr_b16 v[134:135], v221 offset:26016
  v_mfma_f32_16x16x32_bf16 v[56:59], v[140:143], a[192:195], v[56:59]
  ds_read_b64_tr_b16 v[136:137], v221 offset:25536
  v_mfma_f32_16x16x32_bf16 v[60:63], v[140:143], a[196:199], v[60:63]
  buffer_load_dwordx4 v214, s[12:15], s52 offen offset:1024 lds
  ds_read_b64_tr_b16 v[138:139], v221 offset:26048
  s_waitcnt vmcnt(18) lgkmcnt(10)
  v_mfma_f32_16x16x32_bf16 v[0:3], v[112:115], a[200:203], v[0:3]
  ds_read_b64_tr_b16 v[140:141], v221 offset:25568
  v_mfma_f32_16x16x32_bf16 v[4:7], v[112:115], a[204:207], v[4:7]
  ds_read_b64_tr_b16 v[142:143], v221 offset:26080
  v_mfma_f32_16x16x32_bf16 v[8:11], v[116:119], a[200:203], v[8:11]
  ds_read_b64_tr_b16 v[112:113], v221 offset:33792
  v_mfma_f32_16x16x32_bf16 v[12:15], v[116:119], a[204:207], v[12:15]
  buffer_load_dwordx4 v215, s[12:15], s52 offen offset:2048 lds
  ds_read_b64_tr_b16 v[114:115], v221 offset:34304
  s_waitcnt lgkmcnt(10)
  v_mfma_f32_16x16x32_bf16 v[16:19], v[120:123], a[200:203], v[16:19]
  ds_read_b64_tr_b16 v[116:117], v221 offset:33824
  v_mfma_f32_16x16x32_bf16 v[20:23], v[120:123], a[204:207], v[20:23]
  ds_read_b64_tr_b16 v[118:119], v221 offset:34336
  s_mov_b32 s53, 61440
  v_mfma_f32_16x16x32_bf16 v[24:27], v[124:127], a[200:203], v[24:27]
  ds_read_b64_tr_b16 v[120:121], v221 offset:33856
  v_mfma_f32_16x16x32_bf16 v[28:31], v[124:127], a[204:207], v[28:31]
  buffer_load_dwordx4 a[240:243], v251, s[16:19], s53 offen offset:0 sc1
  ds_read_b64_tr_b16 v[122:123], v221 offset:34368
  s_waitcnt lgkmcnt(10)
  v_mfma_f32_16x16x32_bf16 v[32:35], v[128:131], a[200:203], v[32:35]
  ds_read_b64_tr_b16 v[124:125], v221 offset:33888
  v_mfma_f32_16x16x32_bf16 v[36:39], v[128:131], a[204:207], v[36:39]
  ds_read_b64_tr_b16 v[126:127], v221 offset:34400
  v_mfma_f32_16x16x32_bf16 v[40:43], v[132:135], a[200:203], v[40:43]
  ds_read_b64_tr_b16 v[128:129], v221 offset:33920
  v_mfma_f32_16x16x32_bf16 v[44:47], v[132:135], a[204:207], v[44:47]
  buffer_load_dwordx4 a[244:247], v251, s[16:19], s53 offen offset:1024 sc1
  ds_read_b64_tr_b16 v[130:131], v221 offset:34432
  s_waitcnt lgkmcnt(10)
  v_mfma_f32_16x16x32_bf16 v[48:51], v[136:139], a[200:203], v[48:51]
  ds_read_b64_tr_b16 v[132:133], v221 offset:33952
  v_mfma_f32_16x16x32_bf16 v[52:55], v[136:139], a[204:207], v[52:55]
  ds_read_b64_tr_b16 v[134:135], v221 offset:34464
  s_add_u32 s52, s85, 458752
  s_add_u32 m0, s44, 33792
  v_mfma_f32_16x16x32_bf16 v[56:59], v[140:143], a[200:203], v[56:59]
  ds_read_b64_tr_b16 v[136:137], v221 offset:33984
  v_mfma_f32_16x16x32_bf16 v[60:63], v[140:143], a[204:207], v[60:63]
  buffer_load_dwordx4 v213, s[12:15], s52 offen offset:0 lds
  ds_read_b64_tr_b16 v[138:139], v221 offset:34496
  s_waitcnt vmcnt(12) lgkmcnt(10)
  v_mfma_f32_16x16x32_bf16 v[0:3], v[112:115], a[208:211], v[0:3]
  ds_read_b64_tr_b16 v[140:141], v221 offset:34016
  v_mfma_f32_16x16x32_bf16 v[4:7], v[112:115], a[212:215], v[4:7]
  ds_read_b64_tr_b16 v[142:143], v221 offset:34528
  v_mfma_f32_16x16x32_bf16 v[8:11], v[116:119], a[208:211], v[8:11]
  ds_read_b64_tr_b16 v[112:113], v221 offset:42240
  v_mfma_f32_16x16x32_bf16 v[12:15], v[116:119], a[212:215], v[12:15]
  buffer_load_dwordx4 v214, s[12:15], s52 offen offset:1024 lds
  ds_read_b64_tr_b16 v[114:115], v221 offset:42752
  s_waitcnt lgkmcnt(10)
  v_mfma_f32_16x16x32_bf16 v[16:19], v[120:123], a[208:211], v[16:19]
  ds_read_b64_tr_b16 v[116:117], v221 offset:42272
  v_mfma_f32_16x16x32_bf16 v[20:23], v[120:123], a[212:215], v[20:23]
  ds_read_b64_tr_b16 v[118:119], v221 offset:42784
  v_mfma_f32_16x16x32_bf16 v[24:27], v[124:127], a[208:211], v[24:27]
  ds_read_b64_tr_b16 v[120:121], v221 offset:42304
  v_mfma_f32_16x16x32_bf16 v[28:31], v[124:127], a[212:215], v[28:31]
  buffer_load_dwordx4 v215, s[12:15], s52 offen offset:2048 lds
  ds_read_b64_tr_b16 v[122:123], v221 offset:42816
  s_waitcnt lgkmcnt(10)
  v_mfma_f32_16x16x32_bf16 v[32:35], v[128:131], a[208:211], v[32:35]
  ds_read_b64_tr_b16 v[124:125], v221 offset:42336
  v_mfma_f32_16x16x32_bf16 v[36:39], v[128:131], a[212:215], v[36:39]
  ds_read_b64_tr_b16 v[126:127], v221 offset:42848
  v_mfma_f32_16x16x32_bf16 v[40:43], v[132:135], a[208:211], v[40:43]
  ds_read_b64_tr_b16 v[128:129], v221 offset:42368
  v_mfma_f32_16x16x32_bf16 v[44:47], v[132:135], a[212:215], v[44:47]
  buffer_load_dwordx4 a[248:251], v251, s[16:19], s53 offen offset:2048 sc1
  ds_read_b64_tr_b16 v[130:131], v221 offset:42880
  s_waitcnt lgkmcnt(10)
  v_mfma_f32_16x16x32_bf16 v[48:51], v[136:139], a[208:211], v[48:51]
  ds_read_b64_tr_b16 v[132:133], v221 offset:42400
  v_mfma_f32_16x16x32_bf16 v[52:55], v[136:139], a[212:215], v[52:55]
  ds_read_b64_tr_b16 v[134:135], v221 offset:42912
  v_mfma_f32_16x16x32_bf16 v[56:59], v[140:143], a[208:211], v[56:59]
  ds_read_b64_tr_b16 v[136:137], v221 offset:42432
  v_mfma_f32_16x16x32_bf16 v[60:63], v[140:143], a[212:215], v[60:63]
  buffer_load_dwordx4 a[252:255], v251, s[16:19], s53 offen offset:3072 sc1
  ds_read_b64_tr_b16 v[138:139], v221 offset:42944
  s_waitcnt vmcnt(14) lgkmcnt(10)
  v_mfma_f32_16x16x32_bf16 v[0:3], v[112:115], a[216:219], v[0:3]
  ds_read_b64_tr_b16 v[140:141], v221 offset:42464
  v_mfma_f32_16x16x32_bf16 v[4:7], v[112:115], a[220:223], v[4:7]
  ds_read_b64_tr_b16 v[142:143], v221 offset:42976
  v_mfma_f32_16x16x32_bf16 v[8:11], v[116:119], a[216:219], v[8:11]
  s_barrier
  ds_read_b64_tr_b16 v[112:113], v222 offset:0
  v_mfma_f32_16x16x32_bf16 v[12:15], v[116:119], a[220:223], v[12:15]
  ds_read_b64_tr_b16 v[114:115], v222 offset:512
  s_waitcnt lgkmcnt(10)
  v_mfma_f32_16x16x32_bf16 v[16:19], v[120:123], a[216:219], v[16:19]
  ds_read_b64_tr_b16 v[116:117], v222 offset:32
  v_mfma_f32_16x16x32_bf16 v[20:23], v[120:123], a[220:223], v[20:23]
  ds_read_b64_tr_b16 v[118:119], v222 offset:544
  s_add_u32 s52, s85, 917504
  s_add_u32 m0, s44, 50688
  v_mfma_f32_16x16x32_bf16 v[24:27], v[124:127], a[216:219], v[24:27]
  ds_read_b64_tr_b16 v[120:121], v222 offset:64
  v_mfma_f32_16x16x32_bf16 v[28:31], v[124:127], a[220:223], v[28:31]
  buffer_load_dwordx4 v213, s[12:15], s52 offen offset:0 lds
  ds_read_b64_tr_b16 v[122:123], v222 offset:576
  s_waitcnt lgkmcnt(10)
  v_mfma_f32_16x16x32_bf16 v[32:35], v[128:131], a[216:219], v[32:35]
  ds_read_b64_tr_b16 v[124:125], v222 offset:96
  v_mfma_f32_16x16x32_bf16 v[36:39], v[128:131], a[220:223], v[36:39]
  ds_read_b64_tr_b16 v[126:127], v222 offset:608
  v_mfma_f32_16x16x32_bf16 v[40:43], v[132:135], a[216:219], v[40:43]
  ds_read_b64_tr_b16 v[128:129], v222 offset:128
  v_mfma_f32_16x16x32_bf16 v[44:47], v[132:135], a[220:223], v[44:47]
  buffer_load_dwordx4 v214, s[12:15], s52 offen offset:1024 lds
  ds_read_b64_tr_b16 v[130:131], v222 offset:640
  s_waitcnt lgkmcnt(10)
  v_mfma_f32_16x16x32_bf16 v[48:51], v[136:139], a[216:219], v[48:51]
  ds_read_b64_tr_b16 v[132:133], v222 offset:160
  v_mfma_f32_16x16x32_bf16 v[52:55], v[136:139], a[220:223], v[52:55]
  ds_read_b64_tr_b16 v[134:135], v222 offset:672
  v_mfma_f32_16x16x32_bf16 v[56:59], v[140:143], a[216:219], v[56:59]
  ds_read_b64_tr_b16 v[136:137], v222 offset:192
  v_mfma_f32_16x16x32_bf16 v[60:63], v[140:143], a[220:223], v[60:63]
  buffer_load_dwordx4 v215, s[12:15], s52 offen offset:2048 lds
  ds_read_b64_tr_b16 v[138:139], v222 offset:704
  s_waitcnt vmcnt(15) lgkmcnt(10)
  v_mfma_f32_16x16x32_bf16 v[0:3], v[112:115], a[224:227], v[0:3]
  ds_read_b64_tr_b16 v[140:141], v222 offset:224
  v_mfma_f32_16x16x32_bf16 v[4:7], v[112:115], a[228:231], v[4:7]
  ds_read_b64_tr_b16 v[142:143], v222 offset:736
  s_add_u32 s59, s57, s84
  v_mfma_f32_16x16x32_bf16 v[8:11], v[116:119], a[224:227], v[8:11]
  ds_read_b64_tr_b16 v[112:113], v222 offset:8448
  v_mfma_f32_16x16x32_bf16 v[12:15], v[116:119], a[228:231], v[12:15]
  ds_read_b64_tr_b16 v[114:115], v222 offset:8960
  buffer_load_ushort v176, v238, s[24:27], s59 offen offset:0
  s_waitcnt lgkmcnt(10)
  v_mfma_f32_16x16x32_bf16 v[16:19], v[120:123], a[224:227], v[16:19]
  ds_read_b64_tr_b16 v[116:117], v222 offset:8480
  v_mfma_f32_16x16x32_bf16 v[20:23], v[120:123], a[228:231], v[20:23]
  ds_read_b64_tr_b16 v[118:119], v222 offset:8992
  v_mfma_f32_16x16x32_bf16 v[24:27], v[124:127], a[224:227], v[24:27]
  ds_read_b64_tr_b16 v[120:121], v222 offset:8512
  v_mfma_f32_16x16x32_bf16 v[28:31], v[124:127], a[228:231], v[28:31]
  ds_read_b64_tr_b16 v[122:123], v222 offset:9024
  buffer_load_ushort v178, v238, s[24:27], s59 offen offset:32
  s_waitcnt lgkmcnt(10)
  v_mfma_f32_16x16x32_bf16 v[32:35], v[128:131], a[224:227], v[32:35]
  ds_read_b64_tr_b16 v[124:125], v222 offset:8544
  v_mfma_f32_16x16x32_bf16 v[36:39], v[128:131], a[228:231], v[36:39]
  ds_read_b64_tr_b16 v[126:127], v222 offset:9056
  v_mfma_f32_16x16x32_bf16 v[40:43], v[132:135], a[224:227], v[40:43]
  ds_read_b64_tr_b16 v[128:129], v222 offset:8576
  v_mfma_f32_16x16x32_bf16 v[44:47], v[132:135], a[228:231], v[44:47]
  ds_read_b64_tr_b16 v[130:131], v222 offset:9088
  buffer_load_ushort v180, v238, s[24:27], s59 offen offset:64
  s_waitcnt lgkmcnt(10)
  v_mfma_f32_16x16x32_bf16 v[48:51], v[136:139], a[224:227], v[48:51]
  ds_read_b64_tr_b16 v[132:133], v222 offset:8608
  v_mfma_f32_16x16x32_bf16 v[52:55], v[136:139], a[228:231], v[52:55]
  ds_read_b64_tr_b16 v[134:135], v222 offset:9120
  v_mfma_f32_16x16x32_bf16 v[56:59], v[140:143], a[224:227], v[56:59]
  ds_read_b64_tr_b16 v[136:137], v222 offset:8640
  v_mfma_f32_16x16x32_bf16 v[60:63], v[140:143], a[228:231], v[60:63]
  ds_read_b64_tr_b16 v[138:139], v222 offset:9152
  buffer_load_ushort v182, v238, s[24:27], s59 offen offset:96
  s_waitcnt vmcnt(17) lgkmcnt(10)
  v_mfma_f32_16x16x32_bf16 v[0:3], v[112:115], a[232:235], v[0:3]
  ds_read_b64_tr_b16 v[140:141], v222 offset:8672
  v_mfma_f32_16x16x32_bf16 v[4:7], v[112:115], a[236:239], v[4:7]
  ds_read_b64_tr_b16 v[142:143], v222 offset:9184
  v_mfma_f32_16x16x32_bf16 v[8:11], v[116:119], a[232:235], v[8:11]
  ds_read_b64_tr_b16 v[112:113], v222 offset:16896
  v_mfma_f32_16x16x32_bf16 v[12:15], v[116:119], a[236:239], v[12:15]
  ds_read_b64_tr_b16 v[114:115], v222 offset:17408
  buffer_load_ushort v184, v238, s[24:27], s59 offen offset:128
  s_waitcnt lgkmcnt(10)
  v_mfma_f32_16x16x32_bf16 v[16:19], v[120:123], a[232:235], v[16:19]
  ds_read_b64_tr_b16 v[116:117], v222 offset:16928
  v_mfma_f32_16x16x32_bf16 v[20:23], v[120:123], a[236:239], v[20:23]
  ds_read_b64_tr_b16 v[118:119], v222 offset:17440
  v_mfma_f32_16x16x32_bf16 v[24:27], v[124:127], a[232:235], v[24:27]
  ds_read_b64_tr_b16 v[120:121], v222 offset:16960
  v_mfma_f32_16x16x32_bf16 v[28:31], v[124:127], a[236:239], v[28:31]
  ds_read_b64_tr_b16 v[122:123], v222 offset:17472
  buffer_load_ushort v186, v238, s[24:27], s59 offen offset:160
  s_waitcnt lgkmcnt(10)
  v_mfma_f32_16x16x32_bf16 v[32:35], v[128:131], a[232:235], v[32:35]
  ds_read_b64_tr_b16 v[124:125], v222 offset:16992
  v_mfma_f32_16x16x32_bf16 v[36:39], v[128:131], a[236:239], v[36:39]
  ds_read_b64_tr_b16 v[126:127], v222 offset:17504
  v_mfma_f32_16x16x32_bf16 v[40:43], v[132:135], a[232:235], v[40:43]
  ds_read_b64_tr_b16 v[128:129], v222 offset:17024
  v_mfma_f32_16x16x32_bf16 v[44:47], v[132:135], a[236:239], v[44:47]
  ds_read_b64_tr_b16 v[130:131], v222 offset:17536
  buffer_load_ushort v188, v238, s[24:27], s59 offen offset:192
  s_waitcnt lgkmcnt(10)
  v_mfma_f32_16x16x32_bf16 v[48:51], v[136:139], a[232:235], v[48:51]
  ds_read_b64_tr_b16 v[132:133], v222 offset:17056
  v_mfma_f32_16x16x32_bf16 v[52:55], v[136:139], a[236:239], v[52:55]
  ds_read_b64_tr_b16 v[134:135], v222 offset:17568
  v_mfma_f32_16x16x32_bf16 v[56:59], v[140:143], a[232:235], v[56:59]
  ds_read_b64_tr_b16 v[136:137], v222 offset:17088
  v_mfma_f32_16x16x32_bf16 v[60:63], v[140:143], a[236:239], v[60:63]
  ds_read_b64_tr_b16 v[138:139], v222 offset:17600
  buffer_load_ushort v190, v238, s[24:27], s59 offen offset:224
  s_waitcnt vmcnt(16) lgkmcnt(10)
  v_mfma_f32_16x16x32_bf16 v[0:3], v[112:115], a[240:243], v[0:3]
  ds_read_b64_tr_b16 v[140:141], v222 offset:17120
  v_mfma_f32_16x16x32_bf16 v[4:7], v[112:115], a[244:247], v[4:7]
  ds_read_b64_tr_b16 v[142:143], v222 offset:17632
  s_add_u32 s52, s85, 1376256
  s_add_u32 m0, s44, 67584
  v_mfma_f32_16x16x32_bf16 v[8:11], v[116:119], a[240:243], v[8:11]
  ds_read_b64_tr_b16 v[112:113], v222 offset:25344
  v_mfma_f32_16x16x32_bf16 v[12:15], v[116:119], a[244:247], v[12:15]
  buffer_load_dwordx4 v213, s[12:15], s52 offen offset:0 lds
  ds_read_b64_tr_b16 v[114:115], v222 offset:25856
  s_waitcnt lgkmcnt(10)
  v_mfma_f32_16x16x32_bf16 v[16:19], v[120:123], a[240:243], v[16:19]
  ds_read_b64_tr_b16 v[116:117], v222 offset:25376
  v_mfma_f32_16x16x32_bf16 v[20:23], v[120:123], a[244:247], v[20:23]
  ds_read_b64_tr_b16 v[118:119], v222 offset:25888
  v_mfma_f32_16x16x32_bf16 v[24:27], v[124:127], a[240:243], v[24:27]
  ds_read_b64_tr_b16 v[120:121], v222 offset:25408
  v_mfma_f32_16x16x32_bf16 v[28:31], v[124:127], a[244:247], v[28:31]
  buffer_load_dwordx4 v214, s[12:15], s52 offen offset:1024 lds
  ds_read_b64_tr_b16 v[122:123], v222 offset:25920
  s_waitcnt lgkmcnt(10)
  v_mfma_f32_16x16x32_bf16 v[32:35], v[128:131], a[240:243], v[32:35]
  ds_read_b64_tr_b16 v[124:125], v222 offset:25440
  v_mfma_f32_16x16x32_bf16 v[36:39], v[128:131], a[244:247], v[36:39]
  ds_read_b64_tr_b16 v[126:127], v222 offset:25952
  v_mfma_f32_16x16x32_bf16 v[40:43], v[132:135], a[240:243], v[40:43]
  ds_read_b64_tr_b16 v[128:129], v222 offset:25472
  v_mfma_f32_16x16x32_bf16 v[44:47], v[132:135], a[244:247], v[44:47]
  buffer_load_dwordx4 v215, s[12:15], s52 offen offset:2048 lds
  ds_read_b64_tr_b16 v[130:131], v222 offset:25984
  s_waitcnt lgkmcnt(10)
  v_mfma_f32_16x16x32_bf16 v[48:51], v[136:139], a[240:243], v[48:51]
  ds_read_b64_tr_b16 v[132:133], v222 offset:25504
  v_mfma_f32_16x16x32_bf16 v[52:55], v[136:139], a[244:247], v[52:55]
  ds_read_b64_tr_b16 v[134:135], v222 offset:26016
  s_add_u32 s52, s85, 1835008
  s_add_u32 m0, s44, 0
  v_mfma_f32_16x16x32_bf16 v[56:59], v[140:143], a[240:243], v[56:59]
  ds_read_b64_tr_b16 v[136:137], v222 offset:25536
  v_mfma_f32_16x16x32_bf16 v[60:63], v[140:143], a[244:247], v[60:63]
  buffer_load_dwordx4 v213, s[12:15], s52 offen offset:0 lds
  ds_read_b64_tr_b16 v[138:139], v222 offset:26048
  s_waitcnt vmcnt(15) lgkmcnt(10)
  v_mfma_f32_16x16x32_bf16 v[0:3], v[112:115], a[248:251], v[0:3]
  ds_read_b64_tr_b16 v[140:141], v222 offset:25568
  v_mfma_f32_16x16x32_bf16 v[4:7], v[112:115], a[252:255], v[4:7]
  ds_read_b64_tr_b16 v[142:143], v222 offset:26080
  v_mfma_f32_16x16x32_bf16 v[8:11], v[116:119], a[248:251], v[8:11]
  s_barrier
  ds_read_b64_tr_b16 v[112:113], v223 offset:16896
  v_mfma_f32_16x16x32_bf16 v[12:15], v[116:119], a[252:255], v[12:15]
  ds_read_b64_tr_b16 v[114:115], v223 offset:19968
  s_waitcnt lgkmcnt(10)
  v_mfma_f32_16x16x32_bf16 v[16:19], v[120:123], a[248:251], v[16:19]
  ds_read_b64_tr_b16 v[116:117], v224 offset:16928
  v_mfma_f32_16x16x32_bf16 v[20:23], v[120:123], a[252:255], v[20:23]
  ds_read_b64_tr_b16 v[118:119], v224 offset:20000
  v_mfma_f32_16x16x32_bf16 v[24:27], v[124:127], a[248:251], v[24:27]
  ds_read_b64_tr_b16 v[120:121], v223 offset:16960
  v_mfma_f32_16x16x32_bf16 v[28:31], v[124:127], a[252:255], v[28:31]
  buffer_load_dwordx4 v214, s[12:15], s52 offen offset:1024 lds
  ds_read_b64_tr_b16 v[122:123], v223 offset:20032
  s_waitcnt lgkmcnt(10)
  v_mfma_f32_16x16x32_bf16 v[32:35], v[128:131], a[248:251], v[32:35]
  ds_read_b64_tr_b16 v[124:125], v224 offset:16992
  v_mfma_f32_16x16x32_bf16 v[36:39], v[128:131], a[252:255], v[36:39]
  ds_read_b64_tr_b16 v[126:127], v224 offset:20064
  v_mfma_f32_16x16x32_bf16 v[40:43], v[132:135], a[248:251], v[40:43]
  ds_read_b64_tr_b16 v[128:129], v223 offset:17024
  v_mfma_f32_16x16x32_bf16 v[44:47], v[132:135], a[252:255], v[44:47]
  buffer_load_dwordx4 v215, s[12:15], s52 offen offset:2048 lds
  ds_read_b64_tr_b16 v[130:131], v223 offset:20096
  s_waitcnt lgkmcnt(10)
  v_mfma_f32_16x16x32_bf16 v[48:51], v[136:139], a[248:251], v[48:51]
  ds_read_b64_tr_b16 v[132:133], v224 offset:17056
  v_mfma_f32_16x16x32_bf16 v[52:55], v[136:139], a[252:255], v[52:55]
  ds_read_b64_tr_b16 v[134:135], v224 offset:20128
  v_mfma_f32_16x16x32_bf16 v[56:59], v[140:143], a[248:251], v[56:59]
  ds_read_b64_tr_b16 v[136:137], v223 offset:23040
  v_mfma_f32_16x16x32_bf16 v[60:63], v[140:143], a[252:255], v[60:63]
  ds_read_b64_tr_b16 v[138:139], v223 offset:26112
  s_waitcnt vmcnt(6)
  v_lshl_or_b32 v176, v176, 16, v176
  v_lshl_or_b32 v178, v178, 16, v178
  v_lshl_or_b32 v180, v180, 16, v180
  v_lshl_or_b32 v182, v182, 16, v182
  v_lshl_or_b32 v184, v184, 16, v184
  v_lshl_or_b32 v186, v186, 16, v186
  v_lshl_or_b32 v188, v188, 16, v188
  v_lshl_or_b32 v190, v190, 16, v190
  v_mfma_f32_16x16x16_bf16 v[0:3], v[176:177], v[200:201], v[0:3]
  v_mfma_f32_16x16x16_bf16 v[4:7], v[176:177], v[202:203], v[4:7]
  v_mfma_f32_16x16x16_bf16 v[8:11], v[178:179], v[200:201], v[8:11]
  v_mfma_f32_16x16x16_bf16 v[12:15], v[178:179], v[202:203], v[12:15]
  v_mfma_f32_16x16x16_bf16 v[16:19], v[180:181], v[200:201], v[16:19]
  v_mfma_f32_16x16x16_bf16 v[20:23], v[180:181], v[202:203], v[20:23]
  v_mfma_f32_16x16x16_bf16 v[24:27], v[182:183], v[200:201], v[24:27]
  v_mfma_f32_16x16x16_bf16 v[28:31], v[182:183], v[202:203], v[28:31]
  s_nop 1
  v_mfma_f32_16x16x16_bf16 v[32:35], v[184:185], v[200:201], v[32:35]
  v_mfma_f32_16x16x16_bf16 v[36:39], v[184:185], v[202:203], v[36:39]
  v_mfma_f32_16x16x16_bf16 v[40:43], v[186:187], v[200:201], v[40:43]
  v_mfma_f32_16x16x16_bf16 v[44:47], v[186:187], v[202:203], v[44:47]
  v_max_f32 v64, 0, v0
  v_max_f32 v65, 0, v1
  v_max_f32 v66, 0, v2
  v_max_f32 v67, 0, v3
  v_max_f32 v68, 0, v8
  v_max_f32 v69, 0, v9
  v_max_f32 v70, 0, v10
  v_max_f32 v71, 0, v11
  v_pk_mul_f32 v[0:1], v[0:1], v[64:65]
  v_pk_mul_f32 v[2:3], v[2:3], v[66:67]
  v_pk_mul_f32 v[8:9], v[8:9], v[68:69]
  v_pk_mul_f32 v[10:11], v[10:11], v[70:71]
  v_cvt_pk_bf16_f32 v144, v0, v1
  v_cvt_pk_bf16_f32 v145, v2, v3
  v_cvt_pk_bf16_f32 v146, v8, v9
  v_cvt_pk_bf16_f32 v147, v10, v11
  s_mov_b32 s53, 0
  buffer_store_dwordx4 v[144:147], v251, s[20:23], s53 offen offset:0 sc1
  v_max_f32 v72, 0, v4
  v_max_f32 v73, 0, v5
  v_max_f32 v74, 0, v6
  v_max_f32 v75, 0, v7
  v_max_f32 v76, 0, v12
  v_max_f32 v77, 0, v13
  v_max_f32 v78, 0, v14
  v_max_f32 v79, 0, v15
  v_pk_mul_f32 v[4:5], v[4:5], v[72:73]
  v_pk_mul_f32 v[6:7], v[6:7], v[74:75]
  v_pk_mul_f32 v[12:13], v[12:13], v[76:77]
  v_pk_mul_f32 v[14:15], v[14:15], v[78:79]
  v_cvt_pk_bf16_f32 v148, v4, v5
  v_cvt_pk_bf16_f32 v149, v6, v7
  v_cvt_pk_bf16_f32 v150, v12, v13
  v_cvt_pk_bf16_f32 v151, v14, v15
  buffer_store_dwordx4 v[148:151], v251, s[20:23], s53 offen offset:1024 sc1
  v_mfma_f32_16x16x16_bf16 v[48:51], v[188:189], v[200:201], v[48:51]
  v_mfma_f32_16x16x16_bf16 v[52:55], v[188:189], v[202:203], v[52:55]
  v_mfma_f32_16x16x16_bf16 v[56:59], v[190:191], v[200:201], v[56:59]
  v_mfma_f32_16x16x16_bf16 v[60:63], v[190:191], v[202:203], v[60:63]
  v_max_f32 v64, 0, v16
  v_max_f32 v65, 0, v17
  v_max_f32 v66, 0, v18
  v_max_f32 v67, 0, v19
  v_max_f32 v68, 0, v24
  v_max_f32 v69, 0, v25
  v_max_f32 v70, 0, v26
  v_max_f32 v71, 0, v27
  v_pk_mul_f32 v[16:17], v[16:17], v[64:65]
  v_pk_mul_f32 v[18:19], v[18:19], v[66:67]
  v_pk_mul_f32 v[24:25], v[24:25], v[68:69]
  v_pk_mul_f32 v[26:27], v[26:27], v[70:71]
  v_cvt_pk_bf16_f32 v152, v16, v17
  v_cvt_pk_bf16_f32 v153, v18, v19
  v_cvt_pk_bf16_f32 v154, v24, v25
  v_cvt_pk_bf16_f32 v155, v26, v27
  v_max_f32 v72, 0, v20
  v_max_f32 v73, 0, v21
  v_max_f32 v74, 0, v22
  v_max_f32 v75, 0, v23
  v_max_f32 v76, 0, v28
  v_max_f32 v77, 0, v29
  v_max_f32 v78, 0, v30
  v_max_f32 v79, 0, v31
  v_pk_mul_f32 v[20:21], v[20:21], v[72:73]
  v_pk_mul_f32 v[22:23], v[22:23], v[74:75]
  v_pk_mul_f32 v[28:29], v[28:29], v[76:77]
  v_pk_mul_f32 v[30:31], v[30:31], v[78:79]
  v_cvt_pk_bf16_f32 v156, v20, v21
  v_cvt_pk_bf16_f32 v157, v22, v23
  v_cvt_pk_bf16_f32 v158, v28, v29
  v_cvt_pk_bf16_f32 v159, v30, v31
  v_max_f32 v64, 0, v32
  v_max_f32 v65, 0, v33
  v_max_f32 v66, 0, v34
  v_max_f32 v67, 0, v35
  v_max_f32 v68, 0, v40
  v_max_f32 v69, 0, v41
  v_max_f32 v70, 0, v42
  v_max_f32 v71, 0, v43
  v_pk_mul_f32 v[32:33], v[32:33], v[64:65]
  v_pk_mul_f32 v[34:35], v[34:35], v[66:67]
  v_pk_mul_f32 v[40:41], v[40:41], v[68:69]
  v_pk_mul_f32 v[42:43], v[42:43], v[70:71]
  v_cvt_pk_bf16_f32 v160, v32, v33
  v_cvt_pk_bf16_f32 v161, v34, v35
  v_cvt_pk_bf16_f32 v162, v40, v41
  v_cvt_pk_bf16_f32 v163, v42, v43
  v_max_f32 v72, 0, v36
  v_max_f32 v73, 0, v37
  v_max_f32 v74, 0, v38
  v_max_f32 v75, 0, v39
  v_max_f32 v76, 0, v44
  v_max_f32 v77, 0, v45
  v_max_f32 v78, 0, v46
  v_max_f32 v79, 0, v47
  v_pk_mul_f32 v[36:37], v[36:37], v[72:73]
  v_pk_mul_f32 v[38:39], v[38:39], v[74:75]
  v_pk_mul_f32 v[44:45], v[44:45], v[76:77]
  v_pk_mul_f32 v[46:47], v[46:47], v[78:79]
  v_cvt_pk_bf16_f32 v164, v36, v37
  v_cvt_pk_bf16_f32 v165, v38, v39
  v_cvt_pk_bf16_f32 v166, v44, v45
  v_cvt_pk_bf16_f32 v167, v46, v47
  v_max_f32 v64, 0, v48
  v_max_f32 v65, 0, v49
  v_max_f32 v66, 0, v50
  v_max_f32 v67, 0, v51
  v_max_f32 v68, 0, v56
  v_max_f32 v69, 0, v57
  v_max_f32 v70, 0, v58
  v_max_f32 v71, 0, v59
  v_pk_mul_f32 v[48:49], v[48:49], v[64:65]
  v_pk_mul_f32 v[50:51], v[50:51], v[66:67]
  v_pk_mul_f32 v[56:57], v[56:57], v[68:69]
  v_pk_mul_f32 v[58:59], v[58:59], v[70:71]
  v_cvt_pk_bf16_f32 v168, v48, v49
  v_cvt_pk_bf16_f32 v169, v50, v51
  v_cvt_pk_bf16_f32 v170, v56, v57
  v_cvt_pk_bf16_f32 v171, v58, v59
  v_max_f32 v72, 0, v52
  v_max_f32 v73, 0, v53
  v_max_f32 v74, 0, v54
  v_max_f32 v75, 0, v55
  v_max_f32 v76, 0, v60
  v_max_f32 v77, 0, v61
  v_max_f32 v78, 0, v62
  v_max_f32 v79, 0, v63
  v_pk_mul_f32 v[52:53], v[52:53], v[72:73]
  v_pk_mul_f32 v[54:55], v[54:55], v[74:75]
  v_pk_mul_f32 v[60:61], v[60:61], v[76:77]
  v_pk_mul_f32 v[62:63], v[62:63], v[78:79]
  v_cvt_pk_bf16_f32 v172, v52, v53
  v_cvt_pk_bf16_f32 v173, v54, v55
  v_cvt_pk_bf16_f32 v174, v60, v61
  v_cvt_pk_bf16_f32 v175, v62, v63
  s_waitcnt lgkmcnt(10)
  v_mfma_f32_16x16x32_bf16 v[64:67], v[112:115], a[0:3], 0
  ds_read_b64_tr_b16 v[140:141], v224 offset:23072
  v_mfma_f32_16x16x32_bf16 v[68:71], v[112:115], a[4:7], 0
  ds_read_b64_tr_b16 v[142:143], v224 offset:26144
  v_mfma_f32_16x16x32_bf16 v[72:75], v[116:119], a[0:3], 0
  ds_read_b64_tr_b16 v[112:113], v223 offset:23104
  v_mfma_f32_16x16x32_bf16 v[76:79], v[116:119], a[4:7], 0
  ds_read_b64_tr_b16 v[114:115], v223 offset:26176
  s_waitcnt lgkmcnt(10)
  v_mfma_f32_16x16x32_bf16 v[80:83], v[120:123], a[0:3], 0
  ds_read_b64_tr_b16 v[116:117], v224 offset:23136
  v_mfma_f32_16x16x32_bf16 v[84:87], v[120:123], a[4:7], 0
  ds_read_b64_tr_b16 v[118:119], v224 offset:26208
  v_mfma_f32_16x16x32_bf16 v[88:91], v[124:127], a[0:3], 0
  ds_read_b64_tr_b16 v[120:121], v223 offset:23168
  v_mfma_f32_16x16x32_bf16 v[92:95], v[124:127], a[4:7], 0
  ds_read_b64_tr_b16 v[122:123], v223 offset:26240
  buffer_store_dwordx4 v[152:155], v251, s[20:23], s53 offen offset:2048 sc1
  s_waitcnt lgkmcnt(10)
  v_mfma_f32_16x16x32_bf16 v[96:99], v[128:131], a[0:3], 0
  ds_read_b64_tr_b16 v[124:125], v224 offset:23200
  v_mfma_f32_16x16x32_bf16 v[100:103], v[128:131], a[4:7], 0
  ds_read_b64_tr_b16 v[126:127], v224 offset:26272
  v_mfma_f32_16x16x32_bf16 v[104:107], v[132:135], a[0:3], 0
  s_barrier
  s_mul_i32 s3, s38, 3670016
  s_lshl_b32 s48, s39, 8
  s_add_u32 s3, s3, s48
  s_lshl_b32 s48, s38, 7
  s_add_u32 s47, s3, s48
  s_sub_u32 s58, s3, s48
  s_add_u32 s58, s58, 128
  s_add_u32 s16, s92, s58
  s_addc_u32 s17, s93, 0
  s_and_b32 s17, s17, 0xffff
  s_sub_u32 s18, 7340032, s58
  s_mov_b32 s19, 0x20000
  s_add_u32 s28, s92, s47
  s_addc_u32 s29, s93, 0
  s_and_b32 s29, s29, 0xffff
  s_sub_u32 s30, 7340032, s47
  s_mov_b32 s31, 0x20000
  s_lshl_b32 s49, s36, 10
  s_bitcmp1_b32 s39, 0
  s_cselect_b32 s90, 196608, 0
  s_cselect_b32 s91, 4294705152, 0
  ds_read_b64_tr_b16 v[128:129], v223 offset:33792
  v_mfma_f32_16x16x32_bf16 v[108:111], v[132:135], a[4:7], 0
  ds_read_b64_tr_b16 v[130:131], v223 offset:36864
  s_waitcnt lgkmcnt(10)
  v_mfma_f32_16x16x32_bf16 v[64:67], v[136:139], a[8:11], v[64:67]
  ds_read_b64_tr_b16 v[132:133], v224 offset:33824
  v_mfma_f32_16x16x32_bf16 v[68:71], v[136:139], a[12:15], v[68:71]
  ds_read_b64_tr_b16 v[134:135], v224 offset:36896
  v_mfma_f32_16x16x32_bf16 v[72:75], v[140:143], a[8:11], v[72:75]
  ds_read_b64_tr_b16 v[136:137], v223 offset:33856
  v_mfma_f32_16x16x32_bf16 v[76:79], v[140:143], a[12:15], v[76:79]
  ds_read_b64_tr_b16 v[138:139], v223 offset:36928
  s_waitcnt lgkmcnt(10)
  v_mfma_f32_16x16x32_bf16 v[80:83], v[112:115], a[8:11], v[80:83]
  ds_read_b64_tr_b16 v[140:141], v224 offset:33888
  v_mfma_f32_16x16x32_bf16 v[84:87], v[112:115], a[12:15], v[84:87]
  ds_read_b64_tr_b16 v[142:143], v224 offset:36960
  v_mfma_f32_16x16x32_bf16 v[88:91], v[116:119], a[8:11], v[88:91]
  ds_read_b64_tr_b16 v[112:113], v223 offset:33920
  v_mfma_f32_16x16x32_bf16 v[92:95], v[116:119], a[12:15], v[92:95]
  ds_read_b64_tr_b16 v[114:115], v223 offset:36992
  buffer_store_dwordx4 v[156:159], v251, s[20:23], s53 offen offset:3072 sc1
  s_waitcnt lgkmcnt(10)
  v_mfma_f32_16x16x32_bf16 v[96:99], v[120:123], a[8:11], v[96:99]
  ds_read_b64_tr_b16 v[116:117], v224 offset:33952
  v_mfma_f32_16x16x32_bf16 v[100:103], v[120:123], a[12:15], v[100:103]
  ds_read_b64_tr_b16 v[118:119], v224 offset:37024
  v_mfma_f32_16x16x32_bf16 v[104:107], v[124:127], a[8:11], v[104:107]
  ds_read_b64_tr_b16 v[120:121], v223 offset:39936
  v_mfma_f32_16x16x32_bf16 v[108:111], v[124:127], a[12:15], v[108:111]
  ds_read_b64_tr_b16 v[122:123], v223 offset:43008
  s_waitcnt lgkmcnt(10)
  v_mfma_f32_16x16x32_bf16 v[64:67], v[128:131], a[16:19], v[64:67]
  ds_read_b64_tr_b16 v[124:125], v224 offset:39968
  v_mfma_f32_16x16x32_bf16 v[68:71], v[128:131], a[20:23], v[68:71]
  ds_read_b64_tr_b16 v[126:127], v224 offset:43040
  v_mfma_f32_16x16x32_bf16 v[72:75], v[132:135], a[16:19], v[72:75]
  ds_read_b64_tr_b16 v[128:129], v223 offset:40000
  v_mfma_f32_16x16x32_bf16 v[76:79], v[132:135], a[20:23], v[76:79]
  ds_read_b64_tr_b16 v[130:131], v223 offset:43072
  s_waitcnt lgkmcnt(10)
  v_mfma_f32_16x16x32_bf16 v[80:83], v[136:139], a[16:19], v[80:83]
  ds_read_b64_tr_b16 v[132:133], v224 offset:40032
  v_mfma_f32_16x16x32_bf16 v[84:87], v[136:139], a[20:23], v[84:87]
  ds_read_b64_tr_b16 v[134:135], v224 offset:43104
  v_mfma_f32_16x16x32_bf16 v[88:91], v[140:143], a[16:19], v[88:91]
  ds_read_b64_tr_b16 v[136:137], v223 offset:40064
  v_mfma_f32_16x16x32_bf16 v[92:95], v[140:143], a[20:23], v[92:95]
  ds_read_b64_tr_b16 v[138:139], v223 offset:43136
  s_mov_b32 s53, 4096
  buffer_store_dwordx4 v[160:163], v251, s[20:23], s53 offen offset:0 sc1
  s_waitcnt lgkmcnt(10)
  v_mfma_f32_16x16x32_bf16 v[96:99], v[112:115], a[16:19], v[96:99]
  ds_read_b64_tr_b16 v[140:141], v224 offset:40096
  v_mfma_f32_16x16x32_bf16 v[100:103], v[112:115], a[20:23], v[100:103]
  ds_read_b64_tr_b16 v[142:143], v224 offset:43168
  v_mfma_f32_16x16x32_bf16 v[104:107], v[116:119], a[16:19], v[104:107]
  s_barrier
  ds_read_b64_tr_b16 v[112:113], v225 offset:0
  v_mfma_f32_16x16x32_bf16 v[108:111], v[116:119], a[20:23], v[108:111]
  ds_read_b64_tr_b16 v[114:115], v225 offset:3072
  s_waitcnt lgkmcnt(10)
  v_mfma_f32_16x16x32_bf16 v[64:67], v[120:123], a[24:27], v[64:67]
  ds_read_b64_tr_b16 v[116:117], v226 offset:32
  v_mfma_f32_16x16x32_bf16 v[68:71], v[120:123], a[28:31], v[68:71]
  ds_read_b64_tr_b16 v[118:119], v226 offset:3104
  s_add_u32 s52, s85, 2293760
  s_add_u32 m0, s44, 16896
  v_mfma_f32_16x16x32_bf16 v[72:75], v[124:127], a[24:27], v[72:75]
  ds_read_b64_tr_b16 v[120:121], v225 offset:64
  v_mfma_f32_16x16x32_bf16 v[76:79], v[124:127], a[28:31], v[76:79]
  buffer_load_dwordx4 v213, s[12:15], s52 offen offset:0 lds
  ds_read_b64_tr_b16 v[122:123], v225 offset:3136
  s_waitcnt lgkmcnt(10)
  v_mfma_f32_16x16x32_bf16 v[80:83], v[128:131], a[24:27], v[80:83]
  ds_read_b64_tr_b16 v[124:125], v226 offset:96
  v_mfma_f32_16x16x32_bf16 v[84:87], v[128:131], a[28:31], v[84:87]
  ds_read_b64_tr_b16 v[126:127], v226 offset:3168
  s_nop 0
  buffer_load_dwordx4 v214, s[12:15], s52 offen offset:1024 lds
  v_mfma_f32_16x16x32_bf16 v[88:91], v[132:135], a[24:27], v[88:91]
  ds_read_b64_tr_b16 v[128:129], v225 offset:128
  v_mfma_f32_16x16x32_bf16 v[92:95], v[132:135], a[28:31], v[92:95]
  ds_read_b64_tr_b16 v[130:131], v225 offset:3200
  buffer_store_dwordx4 v[164:167], v251, s[20:23], s53 offen offset:1024 sc1
  s_waitcnt lgkmcnt(10)
  v_mfma_f32_16x16x32_bf16 v[96:99], v[136:139], a[24:27], v[96:99]
  ds_read_b64_tr_b16 v[132:133], v226 offset:160
  v_mfma_f32_16x16x32_bf16 v[100:103], v[136:139], a[28:31], v[100:103]
  ds_read_b64_tr_b16 v[134:135], v226 offset:3232
  s_nop 0
  buffer_load_dwordx4 v215, s[12:15], s52 offen offset:2048 lds
  v_mfma_f32_16x16x32_bf16 v[104:107], v[140:143], a[24:27], v[104:107]
  ds_read_b64_tr_b16 v[136:137], v225 offset:6144
  v_mfma_f32_16x16x32_bf16 v[108:111], v[140:143], a[28:31], v[108:111]
  ds_read_b64_tr_b16 v[138:139], v225 offset:9216
  s_waitcnt lgkmcnt(10)
  v_mfma_f32_16x16x32_bf16 v[64:67], v[112:115], a[32:35], v[64:67]
  ds_read_b64_tr_b16 v[140:141], v226 offset:6176
  v_mfma_f32_16x16x32_bf16 v[68:71], v[112:115], a[36:39], v[68:71]
  ds_read_b64_tr_b16 v[142:143], v226 offset:9248
  v_mfma_f32_16x16x32_bf16 v[72:75], v[116:119], a[32:35], v[72:75]
  ds_read_b64_tr_b16 v[112:113], v225 offset:6208
  v_mfma_f32_16x16x32_bf16 v[76:79], v[116:119], a[36:39], v[76:79]
  ds_read_b64_tr_b16 v[114:115], v225 offset:9280
  s_waitcnt lgkmcnt(10)
  v_mfma_f32_16x16x32_bf16 v[80:83], v[120:123], a[32:35], v[80:83]
  ds_read_b64_tr_b16 v[116:117], v226 offset:6240
  v_mfma_f32_16x16x32_bf16 v[84:87], v[120:123], a[36:39], v[84:87]
  ds_read_b64_tr_b16 v[118:119], v226 offset:9312
  v_mfma_f32_16x16x32_bf16 v[88:91], v[124:127], a[32:35], v[88:91]
  ds_read_b64_tr_b16 v[120:121], v225 offset:6272
  v_mfma_f32_16x16x32_bf16 v[92:95], v[124:127], a[36:39], v[92:95]
  ds_read_b64_tr_b16 v[122:123], v225 offset:9344
  buffer_store_dwordx4 v[168:171], v251, s[20:23], s53 offen offset:2048 sc1
  s_waitcnt lgkmcnt(10)
  v_mfma_f32_16x16x32_bf16 v[96:99], v[128:131], a[32:35], v[96:99]
  ds_read_b64_tr_b16 v[124:125], v226 offset:6304
  v_mfma_f32_16x16x32_bf16 v[100:103], v[128:131], a[36:39], v[100:103]
  ds_read_b64_tr_b16 v[126:127], v226 offset:9376
  v_mfma_f32_16x16x32_bf16 v[104:107], v[132:135], a[32:35], v[104:107]
  s_waitcnt vmcnt(13)
  s_barrier
  ds_read_b64_tr_b16 v[128:129], v225 offset:16896
  v_mfma_f32_16x16x32_bf16 v[108:111], v[132:135], a[36:39], v[108:111]
  ds_read_b64_tr_b16 v[130:131], v225 offset:19968
  s_waitcnt lgkmcnt(10)
  v_mfma_f32_16x16x32_bf16 v[64:67], v[136:139], a[40:43], v[64:67]
  ds_read_b64_tr_b16 v[132:133], v226 offset:16928
  v_mfma_f32_16x16x32_bf16 v[68:71], v[136:139], a[44:47], v[68:71]
  ds_read_b64_tr_b16 v[134:135], v226 offset:20000
  v_mfma_f32_16x16x32_bf16 v[72:75], v[140:143], a[40:43], v[72:75]
  ds_read_b64_tr_b16 v[136:137], v225 offset:16960
  v_mfma_f32_16x16x32_bf16 v[76:79], v[140:143], a[44:47], v[76:79]
  ds_read_b64_tr_b16 v[138:139], v225 offset:20032
  s_waitcnt lgkmcnt(10)
  v_mfma_f32_16x16x32_bf16 v[80:83], v[112:115], a[40:43], v[80:83]
  ds_read_b64_tr_b16 v[140:141], v226 offset:16992
  v_mfma_f32_16x16x32_bf16 v[84:87], v[112:115], a[44:47], v[84:87]
  ds_read_b64_tr_b16 v[142:143], v226 offset:20064
  s_add_u32 s52, s85, 2752512
  s_add_u32 m0, s44, 33792
  s_nop 0
  buffer_load_dwordx4 v213, s[12:15], s52 offen offset:0 lds
  v_mfma_f32_16x16x32_bf16 v[88:91], v[116:119], a[40:43], v[88:91]
  ds_read_b64_tr_b16 v[112:113], v225 offset:17024
  v_mfma_f32_16x16x32_bf16 v[92:95], v[116:119], a[44:47], v[92:95]
  ds_read_b64_tr_b16 v[114:115], v225 offset:20096
  buffer_store_dwordx4 v[172:175], v251, s[20:23], s53 offen offset:3072 sc1
  s_waitcnt lgkmcnt(10)
  v_mfma_f32_16x16x32_bf16 v[96:99], v[120:123], a[40:43], v[96:99]
  ds_read_b64_tr_b16 v[116:117], v226 offset:17056
  v_mfma_f32_16x16x32_bf16 v[100:103], v[120:123], a[44:47], v[100:103]
  ds_read_b64_tr_b16 v[118:119], v226 offset:20128
  s_nop 0
  buffer_load_dwordx4 v214, s[12:15], s52 offen offset:1024 lds
  v_mfma_f32_16x16x32_bf16 v[104:107], v[124:127], a[40:43], v[104:107]
  ds_read_b64_tr_b16 v[120:121], v225 offset:23040
  v_mfma_f32_16x16x32_bf16 v[108:111], v[124:127], a[44:47], v[108:111]
  buffer_load_dwordx4 v215, s[12:15], s52 offen offset:2048 lds
  ds_read_b64_tr_b16 v[122:123], v225 offset:26112
  s_waitcnt lgkmcnt(10)
  v_mfma_f32_16x16x32_bf16 v[64:67], v[128:131], a[48:51], v[64:67]
  ds_read_b64_tr_b16 v[124:125], v226 offset:23072
  v_mfma_f32_16x16x32_bf16 v[68:71], v[128:131], a[52:55], v[68:71]
  ds_read_b64_tr_b16 v[126:127], v226 offset:26144
  s_add_u32 s50, s90, 0
  s_add_u32 m0, s49, 86016
  v_mfma_f32_16x16x32_bf16 v[72:75], v[132:135], a[48:51], v[72:75]
  ds_read_b64_tr_b16 v[128:129], v225 offset:23104
  v_mfma_f32_16x16x32_bf16 v[76:79], v[132:135], a[52:55], v[76:79]
  buffer_load_dwordx4 v240, s[16:19], s50 offen lds
  ds_read_b64_tr_b16 v[130:131], v225 offset:26176
  s_waitcnt lgkmcnt(10)
  v_mfma_f32_16x16x32_bf16 v[80:83], v[136:139], a[48:51], v[80:83]
  ds_read_b64_tr_b16 v[132:133], v226 offset:23136
  v_mfma_f32_16x16x32_bf16 v[84:87], v[136:139], a[52:55], v[84:87]
  ds_read_b64_tr_b16 v[134:135], v226 offset:26208
  s_add_u32 m0, s49, 90112
  v_mfma_f32_16x16x32_bf16 v[88:91], v[140:143], a[48:51], v[88:91]
  ds_read_b64_tr_b16 v[136:137], v225 offset:23168
  v_mfma_f32_16x16x32_bf16 v[92:95], v[140:143], a[52:55], v[92:95]
  buffer_load_dwordx4 v240, s[28:31], s50 offen lds
  ds_read_b64_tr_b16 v[138:139], v225 offset:26240
  s_waitcnt lgkmcnt(10)
  v_mfma_f32_16x16x32_bf16 v[96:99], v[112:115], a[48:51], v[96:99]
  ds_read_b64_tr_b16 v[140:141], v226 offset:23200
  v_mfma_f32_16x16x32_bf16 v[100:103], v[112:115], a[52:55], v[100:103]
  ds_read_b64_tr_b16 v[142:143], v226 offset:26272
  v_mfma_f32_16x16x32_bf16 v[104:107], v[116:119], a[48:51], v[104:107]
  s_waitcnt vmcnt(16)
  s_barrier
  ds_read_b64_tr_b16 v[112:113], v223 offset:0
  v_mfma_f32_16x16x32_bf16 v[108:111], v[116:119], a[52:55], v[108:111]
  ds_read_b64_tr_b16 v[114:115], v223 offset:3072
  s_waitcnt lgkmcnt(10)
  v_mfma_f32_16x16x32_bf16 v[64:67], v[120:123], a[56:59], v[64:67]
  ds_read_b64_tr_b16 v[116:117], v224 offset:32
  v_mfma_f32_16x16x32_bf16 v[68:71], v[120:123], a[60:63], v[68:71]
  ds_read_b64_tr_b16 v[118:119], v224 offset:3104
  s_add_u32 s52, s85, 3211264
  s_add_u32 m0, s44, 50688
  v_mfma_f32_16x16x32_bf16 v[72:75], v[124:127], a[56:59], v[72:75]
  ds_read_b64_tr_b16 v[120:121], v223 offset:64
  v_mfma_f32_16x16x32_bf16 v[76:79], v[124:127], a[60:63], v[76:79]
  buffer_load_dwordx4 v213, s[12:15], s52 offen offset:0 lds
  ds_read_b64_tr_b16 v[122:123], v223 offset:3136
  s_waitcnt lgkmcnt(10)
  v_mfma_f32_16x16x32_bf16 v[80:83], v[128:131], a[56:59], v[80:83]
  ds_read_b64_tr_b16 v[124:125], v224 offset:96
  v_mfma_f32_16x16x32_bf16 v[84:87], v[128:131], a[60:63], v[84:87]
  ds_read_b64_tr_b16 v[126:127], v224 offset:3168
  s_nop 0
  buffer_load_dwordx4 v214, s[12:15], s52 offen offset:1024 lds
  v_mfma_f32_16x16x32_bf16 v[88:91], v[132:135], a[56:59], v[88:91]
  ds_read_b64_tr_b16 v[128:129], v223 offset:128
  v_mfma_f32_16x16x32_bf16 v[92:95], v[132:135], a[60:63], v[92:95]
  buffer_load_dwordx4 v215, s[12:15], s52 offen offset:2048 lds
  ds_read_b64_tr_b16 v[130:131], v223 offset:3200
  s_waitcnt lgkmcnt(10)
  v_mfma_f32_16x16x32_bf16 v[96:99], v[136:139], a[56:59], v[96:99]
  ds_read_b64_tr_b16 v[132:133], v224 offset:160
  v_mfma_f32_16x16x32_bf16 v[100:103], v[136:139], a[60:63], v[100:103]
  ds_read_b64_tr_b16 v[134:135], v224 offset:3232
  s_add_u32 s50, s90, 65536
  s_add_u32 m0, s49, 94208
  v_mfma_f32_16x16x32_bf16 v[104:107], v[140:143], a[56:59], v[104:107]
  ds_read_b64_tr_b16 v[136:137], v223 offset:6144
  v_mfma_f32_16x16x32_bf16 v[108:111], v[140:143], a[60:63], v[108:111]
  buffer_load_dwordx4 v240, s[16:19], s50 offen lds
  ds_read_b64_tr_b16 v[138:139], v223 offset:9216
  s_waitcnt lgkmcnt(10)
  v_mfma_f32_16x16x32_bf16 v[64:67], v[112:115], a[64:67], v[64:67]
  ds_read_b64_tr_b16 v[140:141], v224 offset:6176
  v_mfma_f32_16x16x32_bf16 v[68:71], v[112:115], a[68:71], v[68:71]
  ds_read_b64_tr_b16 v[142:143], v224 offset:9248
  s_add_u32 m0, s49, 98304
  v_mfma_f32_16x16x32_bf16 v[72:75], v[116:119], a[64:67], v[72:75]
  ds_read_b64_tr_b16 v[112:113], v223 offset:6208
  v_mfma_f32_16x16x32_bf16 v[76:79], v[116:119], a[68:71], v[76:79]
  buffer_load_dwordx4 v240, s[28:31], s50 offen lds
  ds_read_b64_tr_b16 v[114:115], v223 offset:9280
  s_waitcnt lgkmcnt(10)
  v_mfma_f32_16x16x32_bf16 v[80:83], v[120:123], a[64:67], v[80:83]
  ds_read_b64_tr_b16 v[116:117], v224 offset:6240
  v_mfma_f32_16x16x32_bf16 v[84:87], v[120:123], a[68:71], v[84:87]
  ds_read_b64_tr_b16 v[118:119], v224 offset:9312
  s_add_u32 s50, s90, 131072
  s_add_u32 m0, s49, 102400
  v_mfma_f32_16x16x32_bf16 v[88:91], v[124:127], a[64:67], v[88:91]
  ds_read_b64_tr_b16 v[120:121], v223 offset:6272
  v_mfma_f32_16x16x32_bf16 v[92:95], v[124:127], a[68:71], v[92:95]
  buffer_load_dwordx4 v240, s[16:19], s50 offen lds
  ds_read_b64_tr_b16 v[122:123], v223 offset:9344
  s_waitcnt lgkmcnt(10)
  v_mfma_f32_16x16x32_bf16 v[96:99], v[128:131], a[64:67], v[96:99]
  ds_read_b64_tr_b16 v[124:125], v224 offset:6304
  v_mfma_f32_16x16x32_bf16 v[100:103], v[128:131], a[68:71], v[100:103]
  ds_read_b64_tr_b16 v[126:127], v224 offset:9376
  v_mfma_f32_16x16x32_bf16 v[104:107], v[132:135], a[64:67], v[104:107]
  s_waitcnt vmcnt(13)
  s_barrier
  ds_read_b64_tr_b16 v[128:129], v223 offset:16896
  v_mfma_f32_16x16x32_bf16 v[108:111], v[132:135], a[68:71], v[108:111]
  ds_read_b64_tr_b16 v[130:131], v223 offset:19968
  s_waitcnt lgkmcnt(10)
  v_mfma_f32_16x16x32_bf16 v[64:67], v[136:139], a[72:75], v[64:67]
  ds_read_b64_tr_b16 v[132:133], v224 offset:16928
  v_mfma_f32_16x16x32_bf16 v[68:71], v[136:139], a[76:79], v[68:71]
  ds_read_b64_tr_b16 v[134:135], v224 offset:20000
  v_mfma_f32_16x16x32_bf16 v[72:75], v[140:143], a[72:75], v[72:75]
  ds_read_b64_tr_b16 v[136:137], v223 offset:16960
  v_mfma_f32_16x16x32_bf16 v[76:79], v[140:143], a[76:79], v[76:79]
  ds_read_b64_tr_b16 v[138:139], v223 offset:20032
  s_waitcnt lgkmcnt(10)
  v_mfma_f32_16x16x32_bf16 v[80:83], v[112:115], a[72:75], v[80:83]
  ds_read_b64_tr_b16 v[140:141], v224 offset:16992
  v_mfma_f32_16x16x32_bf16 v[84:87], v[112:115], a[76:79], v[84:87]
  ds_read_b64_tr_b16 v[142:143], v224 offset:20064
  s_add_u32 s52, s85, 0
  s_add_u32 m0, s44, 67584
  s_nop 0
  buffer_load_dwordx4 v219, s[12:15], s52 offen offset:0 lds
  s_add_u32 s52, s85, 6884352
  v_mfma_f32_16x16x32_bf16 v[88:91], v[116:119], a[72:75], v[88:91]
  ds_read_b64_tr_b16 v[112:113], v223 offset:17024
  v_mfma_f32_16x16x32_bf16 v[92:95], v[116:119], a[76:79], v[92:95]
  buffer_load_dwordx4 v217, s[12:15], s52 offen offset:1024 lds
  ds_read_b64_tr_b16 v[114:115], v223 offset:20096
  s_waitcnt lgkmcnt(10)
  v_mfma_f32_16x16x32_bf16 v[96:99], v[120:123], a[72:75], v[96:99]
  ds_read_b64_tr_b16 v[116:117], v224 offset:17056
  v_mfma_f32_16x16x32_bf16 v[100:103], v[120:123], a[76:79], v[100:103]
  ds_read_b64_tr_b16 v[118:119], v224 offset:20128
  s_nop 0
  buffer_load_dwordx4 v218, s[12:15], s52 offen offset:2048 lds
  s_add_u32 m0, s49, 106496
  v_mfma_f32_16x16x32_bf16 v[104:107], v[124:127], a[72:75], v[104:107]
  ds_read_b64_tr_b16 v[120:121], v223 offset:23040
  v_mfma_f32_16x16x32_bf16 v[108:111], v[124:127], a[76:79], v[108:111]
  buffer_load_dwordx4 v240, s[28:31], s50 offen lds
  ds_read_b64_tr_b16 v[122:123], v223 offset:26112
  s_waitcnt lgkmcnt(10)
  v_mfma_f32_16x16x32_bf16 v[64:67], v[128:131], a[80:83], v[64:67]
  ds_read_b64_tr_b16 v[124:125], v224 offset:23072
  v_mfma_f32_16x16x32_bf16 v[68:71], v[128:131], a[84:87], v[68:71]
  ds_read_b64_tr_b16 v[126:127], v224 offset:26144
  v_mfma_f32_16x16x32_bf16 v[72:75], v[132:135], a[80:83], v[72:75]
  ds_read_b64_tr_b16 v[128:129], v223 offset:23104
  v_mfma_f32_16x16x32_bf16 v[76:79], v[132:135], a[84:87], v[76:79]
  ds_read_b64_tr_b16 v[130:131], v223 offset:26176
  s_waitcnt vmcnt(14)
  s_barrier
  s_cmp_lg_u32 s36, 3
  s_cbranch_scc1 sequential_preLN__spectral_fnet__dense_activation_squared_relu__prompt_kernel_sig14
  v_mov_b32 v0, s42
  v_mov_b32 v1, s43
  v_mov_b32 v2, 0
  v_mov_b32 v3, 0
  s_mov_b64 exec, 15
  buffer_store_dwordx4 v[0:3], v251, s[8:11], s54 offen sc1
  s_mov_b64 exec, -1
sequential_preLN__spectral_fnet__dense_activation_squared_relu__prompt_kernel_sig14:
  s_waitcnt lgkmcnt(10)
  v_mfma_f32_16x16x32_bf16 v[80:83], v[136:139], a[80:83], v[80:83]
  ds_read_b64_tr_b16 v[132:133], v224 offset:23136
  v_mfma_f32_16x16x32_bf16 v[84:87], v[136:139], a[84:87], v[84:87]
  ds_read_b64_tr_b16 v[134:135], v224 offset:26208
  s_add_u32 s50, s90, 196608
  s_add_u32 m0, s49, 110592
  v_mfma_f32_16x16x32_bf16 v[88:91], v[140:143], a[80:83], v[88:91]
  ds_read_b64_tr_b16 v[136:137], v223 offset:23168
  v_mfma_f32_16x16x32_bf16 v[92:95], v[140:143], a[84:87], v[92:95]
  buffer_load_dwordx4 v240, s[16:19], s50 offen lds
  ds_read_b64_tr_b16 v[138:139], v223 offset:26240
  s_waitcnt lgkmcnt(10)
  v_mfma_f32_16x16x32_bf16 v[96:99], v[112:115], a[80:83], v[96:99]
  ds_read_b64_tr_b16 v[140:141], v224 offset:23200
  v_mfma_f32_16x16x32_bf16 v[100:103], v[112:115], a[84:87], v[100:103]
  ds_read_b64_tr_b16 v[142:143], v224 offset:26272
  v_mfma_f32_16x16x32_bf16 v[104:107], v[116:119], a[80:83], v[104:107]
  s_waitcnt vmcnt(13)
  s_barrier
  ds_read_b64_tr_b16 v[112:113], v223 offset:33792
  v_mfma_f32_16x16x32_bf16 v[108:111], v[116:119], a[84:87], v[108:111]
  ds_read_b64_tr_b16 v[114:115], v223 offset:36864
  s_getpc_b64 s[88:89]
sequential_preLN__spectral_fnet__dense_activation_squared_relu__prompt_kernel_cp15:
  s_lshr_b32 s3, s2, 3
  s_lshl_b32 s3, s3, 10
  v_min_u32 v232, 7, v248
  v_lshl_add_u32 v232, v232, 7, s3
  v_min_u32 v232, sequential_preLN__spectral_fnet__dense_activation_squared_relu__prompt_kernel_end-sequential_preLN__spectral_fnet__dense_activation_squared_relu__prompt_kernel_cp15-4, v232
  global_load_dword v233, v232, s[88:89]
  s_waitcnt lgkmcnt(10)
  v_mfma_f32_16x16x32_bf16 v[64:67], v[120:123], a[88:91], v[64:67]
  ds_read_b64_tr_b16 v[116:117], v224 offset:33824
  v_mfma_f32_16x16x32_bf16 v[68:71], v[120:123], a[92:95], v[68:71]
  ds_read_b64_tr_b16 v[118:119], v224 offset:36896
  s_add_u32 s52, s85, 6425600
  s_add_u32 m0, s44, 0
  v_mfma_f32_16x16x32_bf16 v[72:75], v[124:127], a[88:91], v[72:75]
  ds_read_b64_tr_b16 v[120:121], v223 offset:33856
  v_mfma_f32_16x16x32_bf16 v[76:79], v[124:127], a[92:95], v[76:79]
  buffer_load_dwordx4 v216, s[12:15], s52 offen offset:0 lds
  ds_read_b64_tr_b16 v[122:123], v223 offset:36928
  s_waitcnt lgkmcnt(10)
  v_mfma_f32_16x16x32_bf16 v[80:83], v[128:131], a[88:91], v[80:83]
  ds_read_b64_tr_b16 v[124:125], v224 offset:33888
  v_mfma_f32_16x16x32_bf16 v[84:87], v[128:131], a[92:95], v[84:87]
  ds_read_b64_tr_b16 v[126:127], v224 offset:36960
  s_nop 0
  buffer_load_dwordx4 v217, s[12:15], s52 offen offset:1024 lds
  v_mfma_f32_16x16x32_bf16 v[88:91], v[132:135], a[88:91], v[88:91]
  ds_read_b64_tr_b16 v[128:129], v223 offset:33920
  v_mfma_f32_16x16x32_bf16 v[92:95], v[132:135], a[92:95], v[92:95]
  buffer_load_dwordx4 v218, s[12:15], s52 offen offset:2048 lds
  ds_read_b64_tr_b16 v[130:131], v223 offset:36992
  s_waitcnt lgkmcnt(10)
  v_mfma_f32_16x16x32_bf16 v[96:99], v[136:139], a[88:91], v[96:99]
  ds_read_b64_tr_b16 v[132:133], v224 offset:33952
  v_mfma_f32_16x16x32_bf16 v[100:103], v[136:139], a[92:95], v[100:103]
  ds_read_b64_tr_b16 v[134:135], v224 offset:37024
  s_add_u32 m0, s49, 114688
  v_mfma_f32_16x16x32_bf16 v[104:107], v[140:143], a[88:91], v[104:107]
  ds_read_b64_tr_b16 v[136:137], v223 offset:39936
  v_mfma_f32_16x16x32_bf16 v[108:111], v[140:143], a[92:95], v[108:111]
  buffer_load_dwordx4 v240, s[28:31], s50 offen lds
  ds_read_b64_tr_b16 v[138:139], v223 offset:43008
  s_waitcnt lgkmcnt(10)
  v_mfma_f32_16x16x32_bf16 v[64:67], v[112:115], a[96:99], v[64:67]
  ds_read_b64_tr_b16 v[140:141], v224 offset:39968
  v_mfma_f32_16x16x32_bf16 v[68:71], v[112:115], a[100:103], v[68:71]
  ds_read_b64_tr_b16 v[142:143], v224 offset:43040
  s_add_u32 s50, s91, 262144
  s_add_u32 m0, s49, 118784
  v_mfma_f32_16x16x32_bf16 v[72:75], v[116:119], a[96:99], v[72:75]
  ds_read_b64_tr_b16 v[112:113], v223 offset:40000
  v_mfma_f32_16x16x32_bf16 v[76:79], v[116:119], a[100:103], v[76:79]
  buffer_load_dwordx4 v240, s[16:19], s50 offen lds
  ds_read_b64_tr_b16 v[114:115], v223 offset:43072
  s_waitcnt lgkmcnt(10)
  v_mfma_f32_16x16x32_bf16 v[80:83], v[120:123], a[96:99], v[80:83]
  ds_read_b64_tr_b16 v[116:117], v224 offset:40032
  v_mfma_f32_16x16x32_bf16 v[84:87], v[120:123], a[100:103], v[84:87]
  ds_read_b64_tr_b16 v[118:119], v224 offset:43104
  s_add_u32 m0, s49, 122880
  v_mfma_f32_16x16x32_bf16 v[88:91], v[124:127], a[96:99], v[88:91]
  ds_read_b64_tr_b16 v[120:121], v223 offset:40064
  v_mfma_f32_16x16x32_bf16 v[92:95], v[124:127], a[100:103], v[92:95]
  buffer_load_dwordx4 v240, s[28:31], s50 offen lds
  ds_read_b64_tr_b16 v[122:123], v223 offset:43136
  s_waitcnt lgkmcnt(10)
  v_mfma_f32_16x16x32_bf16 v[96:99], v[128:131], a[96:99], v[96:99]
  ds_read_b64_tr_b16 v[124:125], v224 offset:40096
  v_mfma_f32_16x16x32_bf16 v[100:103], v[128:131], a[100:103], v[100:103]
  ds_read_b64_tr_b16 v[126:127], v224 offset:43168
  v_mfma_f32_16x16x32_bf16 v[104:107], v[132:135], a[96:99], v[104:107]
  s_waitcnt vmcnt(15)
  s_barrier
  ds_read_b64_tr_b16 v[128:129], v225 offset:0
  v_mfma_f32_16x16x32_bf16 v[108:111], v[132:135], a[100:103], v[108:111]
  ds_read_b64_tr_b16 v[130:131], v225 offset:3072
  s_waitcnt lgkmcnt(10)
  v_mfma_f32_16x16x32_bf16 v[64:67], v[136:139], a[104:107], v[64:67]
  ds_read_b64_tr_b16 v[132:133], v226 offset:32
  v_mfma_f32_16x16x32_bf16 v[68:71], v[136:139], a[108:111], v[68:71]
  ds_read_b64_tr_b16 v[134:135], v226 offset:3104
  v_mfma_f32_16x16x32_bf16 v[72:75], v[140:143], a[104:107], v[72:75]
  ds_read_b64_tr_b16 v[136:137], v225 offset:64
  v_mfma_f32_16x16x32_bf16 v[76:79], v[140:143], a[108:111], v[76:79]
  ds_read_b64_tr_b16 v[138:139], v225 offset:3136
  s_waitcnt lgkmcnt(10)
  v_mfma_f32_16x16x32_bf16 v[80:83], v[112:115], a[104:107], v[80:83]
  ds_read_b64_tr_b16 v[140:141], v226 offset:96
  v_mfma_f32_16x16x32_bf16 v[84:87], v[112:115], a[108:111], v[84:87]
  ds_read_b64_tr_b16 v[142:143], v226 offset:3168
  s_add_u32 s52, s85, 5966848
  s_add_u32 m0, s44, 16896
  s_nop 0
  buffer_load_dwordx4 v216, s[12:15], s52 offen offset:0 lds
  v_mfma_f32_16x16x32_bf16 v[88:91], v[116:119], a[104:107], v[88:91]
  ds_read_b64_tr_b16 v[112:113], v225 offset:128
  v_mfma_f32_16x16x32_bf16 v[92:95], v[116:119], a[108:111], v[92:95]
  buffer_load_dwordx4 v217, s[12:15], s52 offen offset:1024 lds
  ds_read_b64_tr_b16 v[114:115], v225 offset:3200
  s_waitcnt lgkmcnt(10)
  v_mfma_f32_16x16x32_bf16 v[96:99], v[120:123], a[104:107], v[96:99]
  ds_read_b64_tr_b16 v[116:117], v226 offset:160
  v_mfma_f32_16x16x32_bf16 v[100:103], v[120:123], a[108:111], v[100:103]
  ds_read_b64_tr_b16 v[118:119], v226 offset:3232
  s_nop 0
  buffer_load_dwordx4 v218, s[12:15], s52 offen offset:2048 lds
  s_add_u32 s50, s91, 327680
  s_add_u32 m0, s49, 126976
  v_mfma_f32_16x16x32_bf16 v[104:107], v[124:127], a[104:107], v[104:107]
  ds_read_b64_tr_b16 v[120:121], v225 offset:6144
  v_mfma_f32_16x16x32_bf16 v[108:111], v[124:127], a[108:111], v[108:111]
  buffer_load_dwordx4 v240, s[16:19], s50 offen lds
  ds_read_b64_tr_b16 v[122:123], v225 offset:9216
  s_waitcnt lgkmcnt(10)
  v_mfma_f32_16x16x32_bf16 v[64:67], v[128:131], a[112:115], v[64:67]
  ds_read_b64_tr_b16 v[124:125], v226 offset:6176
  v_mfma_f32_16x16x32_bf16 v[68:71], v[128:131], a[116:119], v[68:71]
  ds_read_b64_tr_b16 v[126:127], v226 offset:9248
  v_mfma_f32_16x16x32_bf16 v[72:75], v[132:135], a[112:115], v[72:75]
  ds_read_b64_tr_b16 v[128:129], v225 offset:6208
  v_mfma_f32_16x16x32_bf16 v[76:79], v[132:135], a[116:119], v[76:79]
  ds_read_b64_tr_b16 v[130:131], v225 offset:9280
  s_mul_i32 s3, s40, 229376
  s_mul_i32 s48, s38, 114688
  s_add_u32 s3, s3, s48
  s_add_u32 s3, s3, 10485760
  s_add_u32 s4, s100, s3
  s_addc_u32 s5, s101, 0
  s_and_b32 s5, s5, 0xffff
  s_mov_b32 s6, 114688
  s_mov_b32 s7, 0x20000
  s_lshl_b32 s55, s37, 10
  s_add_u32 s55, s55, 4243456
  s_lshl_b32 s48, s38, 3
  v_and_b32 v239, 7, v248
  v_add_u32 v239, s48, v239
  s_xor_b32 s48, s41, 8
  v_mov_b32 v4, s48
  v_cmp_gt_u32 vcc, 8, v248
  s_nop 1
  v_cndmask_b32 v239, v4, v239, vcc
  v_lshlrev_b32 v239, 6, v239
  buffer_load_dwordx2 v[4:5], v239, s[8:11], s55 offen sc1
  s_waitcnt lgkmcnt(10)
  v_mfma_f32_16x16x32_bf16 v[80:83], v[136:139], a[112:115], v[80:83]
  ds_read_b64_tr_b16 v[132:133], v226 offset:6240
  v_mfma_f32_16x16x32_bf16 v[84:87], v[136:139], a[116:119], v[84:87]
  ds_read_b64_tr_b16 v[134:135], v226 offset:9312
  v_mfma_f32_16x16x32_bf16 v[88:91], v[140:143], a[112:115], v[88:91]
  ds_read_b64_tr_b16 v[136:137], v225 offset:6272
  v_mfma_f32_16x16x32_bf16 v[92:95], v[140:143], a[116:119], v[92:95]
  ds_read_b64_tr_b16 v[138:139], v225 offset:9344
  s_waitcnt lgkmcnt(10)
  v_mfma_f32_16x16x32_bf16 v[96:99], v[112:115], a[112:115], v[96:99]
  ds_read_b64_tr_b16 v[140:141], v226 offset:6304
  v_mfma_f32_16x16x32_bf16 v[100:103], v[112:115], a[116:119], v[100:103]
  ds_read_b64_tr_b16 v[142:143], v226 offset:9376
  v_mfma_f32_16x16x32_bf16 v[104:107], v[116:119], a[112:115], v[104:107]
  s_waitcnt vmcnt(14)
  s_barrier
  ds_read_b64_tr_b16 v[112:113], v225 offset:16896
  v_mfma_f32_16x16x32_bf16 v[108:111], v[116:119], a[116:119], v[108:111]
  ds_read_b64_tr_b16 v[114:115], v225 offset:19968
  s_waitcnt lgkmcnt(10)
  v_mfma_f32_16x16x32_bf16 v[64:67], v[120:123], a[120:123], v[64:67]
  ds_read_b64_tr_b16 v[116:117], v226 offset:16928
  v_mfma_f32_16x16x32_bf16 v[68:71], v[120:123], a[124:127], v[68:71]
  ds_read_b64_tr_b16 v[118:119], v226 offset:20000
  s_add_u32 s52, s85, 5508096
  s_add_u32 m0, s44, 33792
  v_mfma_f32_16x16x32_bf16 v[72:75], v[124:127], a[120:123], v[72:75]
  ds_read_b64_tr_b16 v[120:121], v225 offset:16960
  v_mfma_f32_16x16x32_bf16 v[76:79], v[124:127], a[124:127], v[76:79]
  buffer_load_dwordx4 v216, s[12:15], s52 offen offset:0 lds
  ds_read_b64_tr_b16 v[122:123], v225 offset:20032
  s_waitcnt lgkmcnt(10)
  v_mfma_f32_16x16x32_bf16 v[80:83], v[128:131], a[120:123], v[80:83]
  ds_read_b64_tr_b16 v[124:125], v226 offset:16992
  v_mfma_f32_16x16x32_bf16 v[84:87], v[128:131], a[124:127], v[84:87]
  ds_read_b64_tr_b16 v[126:127], v226 offset:20064
  s_nop 0
  buffer_load_dwordx4 v217, s[12:15], s52 offen offset:1024 lds
  v_mfma_f32_16x16x32_bf16 v[88:91], v[132:135], a[120:123], v[88:91]
  ds_read_b64_tr_b16 v[128:129], v225 offset:17024
  v_mfma_f32_16x16x32_bf16 v[92:95], v[132:135], a[124:127], v[92:95]
  buffer_load_dwordx4 v218, s[12:15], s52 offen offset:2048 lds
  ds_read_b64_tr_b16 v[130:131], v225 offset:20096
  s_waitcnt lgkmcnt(10)
  v_mfma_f32_16x16x32_bf16 v[96:99], v[136:139], a[120:123], v[96:99]
  ds_read_b64_tr_b16 v[132:133], v226 offset:17056
  v_mfma_f32_16x16x32_bf16 v[100:103], v[136:139], a[124:127], v[100:103]
  ds_read_b64_tr_b16 v[134:135], v226 offset:20128
  v_mfma_f32_16x16x32_bf16 v[104:107], v[140:143], a[120:123], v[104:107]
  ds_read_b64_tr_b16 v[136:137], v225 offset:23040
  v_mfma_f32_16x16x32_bf16 v[108:111], v[140:143], a[124:127], v[108:111]
  ds_read_b64_tr_b16 v[138:139], v225 offset:26112
  s_waitcnt lgkmcnt(10)
  v_mfma_f32_16x16x32_bf16 v[64:67], v[112:115], a[128:131], v[64:67]
  ds_read_b64_tr_b16 v[140:141], v226 offset:23072
  v_mfma_f32_16x16x32_bf16 v[68:71], v[112:115], a[132:135], v[68:71]
  ds_read_b64_tr_b16 v[142:143], v226 offset:26144
  v_mfma_f32_16x16x32_bf16 v[72:75], v[116:119], a[128:131], v[72:75]
  ds_read_b64_tr_b16 v[112:113], v225 offset:23104
  v_mfma_f32_16x16x32_bf16 v[76:79], v[116:119], a[132:135], v[76:79]
  ds_read_b64_tr_b16 v[114:115], v225 offset:26176
  s_waitcnt lgkmcnt(10)
  v_mfma_f32_16x16x32_bf16 v[80:83], v[120:123], a[128:131], v[80:83]
  ds_read_b64_tr_b16 v[116:117], v226 offset:23136
  v_mfma_f32_16x16x32_bf16 v[84:87], v[120:123], a[132:135], v[84:87]
  ds_read_b64_tr_b16 v[118:119], v226 offset:26208
  v_mfma_f32_16x16x32_bf16 v[88:91], v[124:127], a[128:131], v[88:91]
  ds_read_b64_tr_b16 v[120:121], v225 offset:23168
  v_mfma_f32_16x16x32_bf16 v[92:95], v[124:127], a[132:135], v[92:95]
  ds_read_b64_tr_b16 v[122:123], v225 offset:26240
  s_waitcnt lgkmcnt(10)
  v_mfma_f32_16x16x32_bf16 v[96:99], v[128:131], a[128:131], v[96:99]
  ds_read_b64_tr_b16 v[124:125], v226 offset:23200
  v_mfma_f32_16x16x32_bf16 v[100:103], v[128:131], a[132:135], v[100:103]
  ds_read_b64_tr_b16 v[126:127], v226 offset:26272
  v_mfma_f32_16x16x32_bf16 v[104:107], v[132:135], a[128:131], v[104:107]
  s_waitcnt vmcnt(11)
  s_barrier
  ds_read_b64_tr_b16 v[128:129], v223 offset:0
  v_mfma_f32_16x16x32_bf16 v[108:111], v[132:135], a[132:135], v[108:111]
  ds_read_b64_tr_b16 v[130:131], v223 offset:3072
  s_waitcnt lgkmcnt(10)
  v_mfma_f32_16x16x32_bf16 v[64:67], v[136:139], a[136:139], v[64:67]
  ds_read_b64_tr_b16 v[132:133], v224 offset:32
  v_mfma_f32_16x16x32_bf16 v[68:71], v[136:139], a[140:143], v[68:71]
  ds_read_b64_tr_b16 v[134:135], v224 offset:3104
  v_mfma_f32_16x16x32_bf16 v[72:75], v[140:143], a[136:139], v[72:75]
  ds_read_b64_tr_b16 v[136:137], v223 offset:64
  v_mfma_f32_16x16x32_bf16 v[76:79], v[140:143], a[140:143], v[76:79]
  ds_read_b64_tr_b16 v[138:139], v223 offset:3136
  s_waitcnt lgkmcnt(10)
  v_mfma_f32_16x16x32_bf16 v[80:83], v[112:115], a[136:139], v[80:83]
  ds_read_b64_tr_b16 v[140:141], v224 offset:96
  v_mfma_f32_16x16x32_bf16 v[84:87], v[112:115], a[140:143], v[84:87]
  ds_read_b64_tr_b16 v[142:143], v224 offset:3168
  s_add_u32 s52, s85, 5049344
  s_add_u32 m0, s44, 50688
  s_nop 0
  buffer_load_dwordx4 v216, s[12:15], s52 offen offset:0 lds
  v_mfma_f32_16x16x32_bf16 v[88:91], v[116:119], a[136:139], v[88:91]
  ds_read_b64_tr_b16 v[112:113], v223 offset:128
  v_mfma_f32_16x16x32_bf16 v[92:95], v[116:119], a[140:143], v[92:95]
  buffer_load_dwordx4 v217, s[12:15], s52 offen offset:1024 lds
  ds_read_b64_tr_b16 v[114:115], v223 offset:3200
  s_waitcnt lgkmcnt(10)
  v_mfma_f32_16x16x32_bf16 v[96:99], v[120:123], a[136:139], v[96:99]
  ds_read_b64_tr_b16 v[116:117], v224 offset:160
  v_mfma_f32_16x16x32_bf16 v[100:103], v[120:123], a[140:143], v[100:103]
  ds_read_b64_tr_b16 v[118:119], v224 offset:3232
  s_nop 0
  buffer_load_dwordx4 v218, s[12:15], s52 offen offset:2048 lds
  v_mfma_f32_16x16x32_bf16 v[104:107], v[124:127], a[136:139], v[104:107]
  ds_read_b64_tr_b16 v[120:121], v223 offset:6144
  v_mfma_f32_16x16x32_bf16 v[108:111], v[124:127], a[140:143], v[108:111]
  ds_read_b64_tr_b16 v[122:123], v223 offset:9216
  s_waitcnt lgkmcnt(10)
  v_mfma_f32_16x16x32_bf16 v[64:67], v[128:131], a[144:147], v[64:67]
  ds_read_b64_tr_b16 v[124:125], v224 offset:6176
  v_mfma_f32_16x16x32_bf16 v[68:71], v[128:131], a[148:151], v[68:71]
  ds_read_b64_tr_b16 v[126:127], v224 offset:9248
  v_mfma_f32_16x16x32_bf16 v[72:75], v[132:135], a[144:147], v[72:75]
  ds_read_b64_tr_b16 v[128:129], v223 offset:6208
  v_mfma_f32_16x16x32_bf16 v[76:79], v[132:135], a[148:151], v[76:79]
  ds_read_b64_tr_b16 v[130:131], v223 offset:9280
  s_waitcnt vmcnt(6)
  s_mov_b32 s47, 262144
sequential_preLN__spectral_fnet__dense_activation_squared_relu__prompt_kernel_poll16:
  v_cmp_ne_u64 vcc, s[42:43], v[4:5]
  s_sub_u32 s47, s47, 1
  s_cbranch_scc1 sequential_preLN__spectral_fnet__dense_activation_squared_relu__prompt_kernel_pok17
  s_cmp_eq_u64 vcc, 0
  s_cbranch_scc1 sequential_preLN__spectral_fnet__dense_activation_squared_relu__prompt_kernel_pok17
  s_sleep 1
  s_mov_b64 exec, vcc
  buffer_load_dwordx2 v[4:5], v239, s[8:11], s55 offen sc1
  s_mov_b64 exec, -1
  s_waitcnt vmcnt(0)
  s_branch sequential_preLN__spectral_fnet__dense_activation_squared_relu__prompt_kernel_poll16
sequential_preLN__spectral_fnet__dense_activation_squared_relu__prompt_kernel_pok17:
  s_waitcnt lgkmcnt(10)
  v_mfma_f32_16x16x32_bf16 v[80:83], v[136:139], a[144:147], v[80:83]
  ds_read_b64_tr_b16 v[132:133], v224 offset:6240
  v_mfma_f32_16x16x32_bf16 v[84:87], v[136:139], a[148:151], v[84:87]
  ds_read_b64_tr_b16 v[134:135], v224 offset:9312
  v_mfma_f32_16x16x32_bf16 v[88:91], v[140:143], a[144:147], v[88:91]
  ds_read_b64_tr_b16 v[136:137], v223 offset:6272
  v_mfma_f32_16x16x32_bf16 v[92:95], v[140:143], a[148:151], v[92:95]
  ds_read_b64_tr_b16 v[138:139], v223 offset:9344
  s_waitcnt lgkmcnt(10)
  v_mfma_f32_16x16x32_bf16 v[96:99], v[112:115], a[144:147], v[96:99]
  ds_read_b64_tr_b16 v[140:141], v224 offset:6304
  v_mfma_f32_16x16x32_bf16 v[100:103], v[112:115], a[148:151], v[100:103]
  ds_read_b64_tr_b16 v[142:143], v224 offset:9376
  v_mfma_f32_16x16x32_bf16 v[104:107], v[116:119], a[144:147], v[104:107]
  s_barrier
  ds_read_b64_tr_b16 v[112:113], v223 offset:16896
  v_mfma_f32_16x16x32_bf16 v[108:111], v[116:119], a[148:151], v[108:111]
  ds_read_b64_tr_b16 v[114:115], v223 offset:19968
  s_waitcnt lgkmcnt(10)
  v_mfma_f32_16x16x32_bf16 v[64:67], v[120:123], a[152:155], v[64:67]
  ds_read_b64_tr_b16 v[116:117], v224 offset:16928
  v_mfma_f32_16x16x32_bf16 v[68:71], v[120:123], a[156:159], v[68:71]
  ds_read_b64_tr_b16 v[118:119], v224 offset:20000
  s_add_u32 s52, s85, 4590592
  s_add_u32 m0, s44, 67584
  v_mfma_f32_16x16x32_bf16 v[72:75], v[124:127], a[152:155], v[72:75]
  ds_read_b64_tr_b16 v[120:121], v223 offset:16960
  v_mfma_f32_16x16x32_bf16 v[76:79], v[124:127], a[156:159], v[76:79]
  buffer_load_dwordx4 v216, s[12:15], s52 offen offset:0 lds
  ds_read_b64_tr_b16 v[122:123], v223 offset:20032
  s_waitcnt lgkmcnt(10)
  v_mfma_f32_16x16x32_bf16 v[80:83], v[128:131], a[152:155], v[80:83]
  ds_read_b64_tr_b16 v[124:125], v224 offset:16992
  v_mfma_f32_16x16x32_bf16 v[84:87], v[128:131], a[156:159], v[84:87]
  ds_read_b64_tr_b16 v[126:127], v224 offset:20064
  s_nop 0
  buffer_load_dwordx4 v217, s[12:15], s52 offen offset:1024 lds
  v_mfma_f32_16x16x32_bf16 v[88:91], v[132:135], a[152:155], v[88:91]
  ds_read_b64_tr_b16 v[128:129], v223 offset:17024
  v_mfma_f32_16x16x32_bf16 v[92:95], v[132:135], a[156:159], v[92:95]
  buffer_load_dwordx4 v218, s[12:15], s52 offen offset:2048 lds
  ds_read_b64_tr_b16 v[130:131], v223 offset:20096
  s_waitcnt lgkmcnt(10)
  v_mfma_f32_16x16x32_bf16 v[96:99], v[136:139], a[152:155], v[96:99]
  ds_read_b64_tr_b16 v[132:133], v224 offset:17056
  v_mfma_f32_16x16x32_bf16 v[100:103], v[136:139], a[156:159], v[100:103]
  ds_read_b64_tr_b16 v[134:135], v224 offset:20128
  s_mul_i32 s46, s39, 14336
  s_add_u32 s46, s46, 14336
  s_cmp_eq_u32 s39, 7
  s_cselect_b32 s3, 114688, 0
  s_sub_u32 s46, s46, s3
  s_add_u32 s51, s46, 0
  v_mfma_f32_16x16x32_bf16 v[104:107], v[140:143], a[152:155], v[104:107]
  ds_read_b64_tr_b16 v[136:137], v223 offset:23040
  v_mfma_f32_16x16x32_bf16 v[108:111], v[140:143], a[156:159], v[108:111]
  buffer_load_dwordx4 a[0:3], v251, s[4:7], s51 offen offset:0 sc1
  ds_read_b64_tr_b16 v[138:139], v223 offset:26112
  s_waitcnt lgkmcnt(10)
  v_mfma_f32_16x16x32_bf16 v[64:67], v[112:115], a[160:163], v[64:67]
  ds_read_b64_tr_b16 v[140:141], v224 offset:23072
  v_mfma_f32_16x16x32_bf16 v[68:71], v[112:115], a[164:167], v[68:71]
  ds_read_b64_tr_b16 v[142:143], v224 offset:26144
  v_mfma_f32_16x16x32_bf16 v[72:75], v[116:119], a[160:163], v[72:75]
  ds_read_b64_tr_b16 v[112:113], v223 offset:23104
  v_mfma_f32_16x16x32_bf16 v[76:79], v[116:119], a[164:167], v[76:79]
  buffer_load_dwordx4 a[4:7], v251, s[4:7], s51 offen offset:1024 sc1
  ds_read_b64_tr_b16 v[114:115], v223 offset:26176
  s_waitcnt lgkmcnt(10)
  v_mfma_f32_16x16x32_bf16 v[80:83], v[120:123], a[160:163], v[80:83]
  ds_read_b64_tr_b16 v[116:117], v224 offset:23136
  v_mfma_f32_16x16x32_bf16 v[84:87], v[120:123], a[164:167], v[84:87]
  ds_read_b64_tr_b16 v[118:119], v224 offset:26208
  v_mfma_f32_16x16x32_bf16 v[88:91], v[124:127], a[160:163], v[88:91]
  ds_read_b64_tr_b16 v[120:121], v223 offset:23168
  v_mfma_f32_16x16x32_bf16 v[92:95], v[124:127], a[164:167], v[92:95]
  buffer_load_dwordx4 a[8:11], v251, s[4:7], s51 offen offset:2048 sc1
  ds_read_b64_tr_b16 v[122:123], v223 offset:26240
  s_waitcnt lgkmcnt(10)
  v_mfma_f32_16x16x32_bf16 v[96:99], v[128:131], a[160:163], v[96:99]
  ds_read_b64_tr_b16 v[124:125], v224 offset:23200
  v_mfma_f32_16x16x32_bf16 v[100:103], v[128:131], a[164:167], v[100:103]
  ds_read_b64_tr_b16 v[126:127], v224 offset:26272
  v_mfma_f32_16x16x32_bf16 v[104:107], v[132:135], a[160:163], v[104:107]
  s_waitcnt vmcnt(9)
  s_barrier
  ds_read_b64_tr_b16 v[128:129], v223 offset:33792
  v_mfma_f32_16x16x32_bf16 v[108:111], v[132:135], a[164:167], v[108:111]
  ds_read_b64_tr_b16 v[130:131], v223 offset:36864
  s_waitcnt lgkmcnt(10)
  v_mfma_f32_16x16x32_bf16 v[64:67], v[136:139], a[168:171], v[64:67]
  ds_read_b64_tr_b16 v[132:133], v224 offset:33824
  v_mfma_f32_16x16x32_bf16 v[68:71], v[136:139], a[172:175], v[68:71]
  ds_read_b64_tr_b16 v[134:135], v224 offset:36896
  v_mfma_f32_16x16x32_bf16 v[72:75], v[140:143], a[168:171], v[72:75]
  ds_read_b64_tr_b16 v[136:137], v223 offset:33856
  v_mfma_f32_16x16x32_bf16 v[76:79], v[140:143], a[172:175], v[76:79]
  ds_read_b64_tr_b16 v[138:139], v223 offset:36928
  s_waitcnt lgkmcnt(10)
  v_mfma_f32_16x16x32_bf16 v[80:83], v[112:115], a[168:171], v[80:83]
  ds_read_b64_tr_b16 v[140:141], v224 offset:33888
  v_mfma_f32_16x16x32_bf16 v[84:87], v[112:115], a[172:175], v[84:87]
  ds_read_b64_tr_b16 v[142:143], v224 offset:36960
  s_add_u32 s52, s85, 4131840
  s_add_u32 m0, s44, 0
  s_nop 0
  buffer_load_dwordx4 v216, s[12:15], s52 offen offset:0 lds
  v_mfma_f32_16x16x32_bf16 v[88:91], v[116:119], a[168:171], v[88:91]
  ds_read_b64_tr_b16 v[112:113], v223 offset:33920
  v_mfma_f32_16x16x32_bf16 v[92:95], v[116:119], a[172:175], v[92:95]
  buffer_load_dwordx4 v217, s[12:15], s52 offen offset:1024 lds
  ds_read_b64_tr_b16 v[114:115], v223 offset:36992
  s_waitcnt lgkmcnt(10)
  v_mfma_f32_16x16x32_bf16 v[96:99], v[120:123], a[168:171], v[96:99]
  ds_read_b64_tr_b16 v[116:117], v224 offset:33952
  v_mfma_f32_16x16x32_bf16 v[100:103], v[120:123], a[172:175], v[100:103]
  ds_read_b64_tr_b16 v[118:119], v224 offset:37024
  s_nop 0
  buffer_load_dwordx4 v218, s[12:15], s52 offen offset:2048 lds
  v_mfma_f32_16x16x32_bf16 v[104:107], v[124:127], a[168:171], v[104:107]
  ds_read_b64_tr_b16 v[120:121], v223 offset:39936
  v_mfma_f32_16x16x32_bf16 v[108:111], v[124:127], a[172:175], v[108:111]
  buffer_load_dwordx4 a[12:15], v251, s[4:7], s51 offen offset:3072 sc1
  ds_read_b64_tr_b16 v[122:123], v223 offset:43008
  s_waitcnt lgkmcnt(10)
  v_mfma_f32_16x16x32_bf16 v[64:67], v[128:131], a[176:179], v[64:67]
  ds_read_b64_tr_b16 v[124:125], v224 offset:39968
  v_mfma_f32_16x16x32_bf16 v[68:71], v[128:131], a[180:183], v[68:71]
  ds_read_b64_tr_b16 v[126:127], v224 offset:43040
  s_add_u32 s51, s46, 4096
  v_mfma_f32_16x16x32_bf16 v[72:75], v[132:135], a[176:179], v[72:75]
  ds_read_b64_tr_b16 v[128:129], v223 offset:40000
  v_mfma_f32_16x16x32_bf16 v[76:79], v[132:135], a[180:183], v[76:79]
  buffer_load_dwordx4 a[16:19], v251, s[4:7], s51 offen offset:0 sc1
  ds_read_b64_tr_b16 v[130:131], v223 offset:43072
  s_waitcnt lgkmcnt(10)
  v_mfma_f32_16x16x32_bf16 v[80:83], v[136:139], a[176:179], v[80:83]
  ds_read_b64_tr_b16 v[132:133], v224 offset:40032
  v_mfma_f32_16x16x32_bf16 v[84:87], v[136:139], a[180:183], v[84:87]
  ds_read_b64_tr_b16 v[134:135], v224 offset:43104
  v_mfma_f32_16x16x32_bf16 v[88:91], v[140:143], a[176:179], v[88:91]
  ds_read_b64_tr_b16 v[136:137], v223 offset:40064
  v_mfma_f32_16x16x32_bf16 v[92:95], v[140:143], a[180:183], v[92:95]
  buffer_load_dwordx4 a[20:23], v251, s[4:7], s51 offen offset:1024 sc1
  ds_read_b64_tr_b16 v[138:139], v223 offset:43136
  s_waitcnt lgkmcnt(10)
  v_mfma_f32_16x16x32_bf16 v[96:99], v[112:115], a[176:179], v[96:99]
  ds_read_b64_tr_b16 v[140:141], v224 offset:40096
  v_mfma_f32_16x16x32_bf16 v[100:103], v[112:115], a[180:183], v[100:103]
  ds_read_b64_tr_b16 v[142:143], v224 offset:43168
  v_mfma_f32_16x16x32_bf16 v[104:107], v[116:119], a[176:179], v[104:107]
  s_waitcnt vmcnt(12)
  s_barrier
  ds_read_b64_tr_b16 v[112:113], v225 offset:0
  v_mfma_f32_16x16x32_bf16 v[108:111], v[116:119], a[180:183], v[108:111]
  ds_read_b64_tr_b16 v[114:115], v225 offset:3072
  s_waitcnt lgkmcnt(10)
  v_mfma_f32_16x16x32_bf16 v[64:67], v[120:123], a[184:187], v[64:67]
  ds_read_b64_tr_b16 v[116:117], v226 offset:32
  v_mfma_f32_16x16x32_bf16 v[68:71], v[120:123], a[188:191], v[68:71]
  ds_read_b64_tr_b16 v[118:119], v226 offset:3104
  s_add_u32 s52, s85, 3673088
  s_add_u32 m0, s44, 16896
  v_mfma_f32_16x16x32_bf16 v[72:75], v[124:127], a[184:187], v[72:75]
  ds_read_b64_tr_b16 v[120:121], v225 offset:64
  v_mfma_f32_16x16x32_bf16 v[76:79], v[124:127], a[188:191], v[76:79]
  buffer_load_dwordx4 v216, s[12:15], s52 offen offset:0 lds
  ds_read_b64_tr_b16 v[122:123], v225 offset:3136
  s_waitcnt lgkmcnt(10)
  v_mfma_f32_16x16x32_bf16 v[80:83], v[128:131], a[184:187], v[80:83]
  ds_read_b64_tr_b16 v[124:125], v226 offset:96
  v_mfma_f32_16x16x32_bf16 v[84:87], v[128:131], a[188:191], v[84:87]
  ds_read_b64_tr_b16 v[126:127], v226 offset:3168
  s_nop 0
  buffer_load_dwordx4 v217, s[12:15], s52 offen offset:1024 lds
  v_mfma_f32_16x16x32_bf16 v[88:91], v[132:135], a[184:187], v[88:91]
  ds_read_b64_tr_b16 v[128:129], v225 offset:128
  v_mfma_f32_16x16x32_bf16 v[92:95], v[132:135], a[188:191], v[92:95]
  buffer_load_dwordx4 v218, s[12:15], s52 offen offset:2048 lds
  ds_read_b64_tr_b16 v[130:131], v225 offset:3200
  s_waitcnt lgkmcnt(10)
  v_mfma_f32_16x16x32_bf16 v[96:99], v[136:139], a[184:187], v[96:99]
  ds_read_b64_tr_b16 v[132:133], v226 offset:160
  v_mfma_f32_16x16x32_bf16 v[100:103], v[136:139], a[188:191], v[100:103]
  ds_read_b64_tr_b16 v[134:135], v226 offset:3232
  v_mfma_f32_16x16x32_bf16 v[104:107], v[140:143], a[184:187], v[104:107]
  ds_read_b64_tr_b16 v[136:137], v225 offset:6144
  v_mfma_f32_16x16x32_bf16 v[108:111], v[140:143], a[188:191], v[108:111]
  buffer_load_dwordx4 a[24:27], v251, s[4:7], s51 offen offset:2048 sc1
  ds_read_b64_tr_b16 v[138:139], v225 offset:9216
  s_waitcnt lgkmcnt(10)
  v_mfma_f32_16x16x32_bf16 v[64:67], v[112:115], a[192:195], v[64:67]
  ds_read_b64_tr_b16 v[140:141], v226 offset:6176
  v_mfma_f32_16x16x32_bf16 v[68:71], v[112:115], a[196:199], v[68:71]
  ds_read_b64_tr_b16 v[142:143], v226 offset:9248
  v_mov_b32 v17, 0
  v_mfma_f32_16x16x32_bf16 v[72:75], v[116:119], a[192:195], v[72:75]
  ds_read_b64_tr_b16 v[112:113], v225 offset:6208
  v_mfma_f32_16x16x32_bf16 v[76:79], v[116:119], a[196:199], v[76:79]
  buffer_load_dwordx4 a[28:31], v251, s[4:7], s51 offen offset:3072 sc1
  ds_read_b64_tr_b16 v[114:115], v225 offset:9280
  s_waitcnt lgkmcnt(10)
  v_mfma_f32_16x16x32_bf16 v[80:83], v[120:123], a[192:195], v[80:83]
  ds_read_b64_tr_b16 v[116:117], v226 offset:6240
  v_mfma_f32_16x16x32_bf16 v[84:87], v[120:123], a[196:199], v[84:87]
  ds_read_b64_tr_b16 v[118:119], v226 offset:9312
  v_mov_b32 v19, 0
  s_cmp_eq_u32 s39, 6
  s_cselect_b32 s3, 114688, 0
  s_sub_u32 s46, s46, s3
  s_add_u32 s51, s46, 14336
  v_mfma_f32_16x16x32_bf16 v[88:91], v[124:127], a[192:195], v[88:91]
  ds_read_b64_tr_b16 v[120:121], v225 offset:6272
  v_mfma_f32_16x16x32_bf16 v[92:95], v[124:127], a[196:199], v[92:95]
  buffer_load_dwordx4 a[32:35], v251, s[4:7], s51 offen offset:0 sc1
  ds_read_b64_tr_b16 v[122:123], v225 offset:9344
  s_waitcnt lgkmcnt(10)
  v_mfma_f32_16x16x32_bf16 v[96:99], v[128:131], a[192:195], v[96:99]
  ds_read_b64_tr_b16 v[124:125], v226 offset:6304
  v_mfma_f32_16x16x32_bf16 v[100:103], v[128:131], a[196:199], v[100:103]
  ds_read_b64_tr_b16 v[126:127], v226 offset:9376
  v_mov_b32 v21, 0
  v_mfma_f32_16x16x32_bf16 v[104:107], v[132:135], a[192:195], v[104:107]
  s_waitcnt vmcnt(15)
  s_barrier
  ds_read_b64_tr_b16 v[128:129], v225 offset:16896
  v_mfma_f32_16x16x32_bf16 v[108:111], v[132:135], a[196:199], v[108:111]
  ds_read_b64_tr_b16 v[130:131], v225 offset:19968
  s_waitcnt lgkmcnt(10)
  v_mfma_f32_16x16x32_bf16 v[64:67], v[136:139], a[200:203], v[64:67]
  ds_read_b64_tr_b16 v[132:133], v226 offset:16928
  v_mfma_f32_16x16x32_bf16 v[68:71], v[136:139], a[204:207], v[68:71]
  ds_read_b64_tr_b16 v[134:135], v226 offset:20000
  v_mov_b32 v23, 0
  v_mfma_f32_16x16x32_bf16 v[72:75], v[140:143], a[200:203], v[72:75]
  ds_read_b64_tr_b16 v[136:137], v225 offset:16960
  v_mfma_f32_16x16x32_bf16 v[76:79], v[140:143], a[204:207], v[76:79]
  ds_read_b64_tr_b16 v[138:139], v225 offset:20032
  s_waitcnt lgkmcnt(10)
  v_mfma_f32_16x16x32_bf16 v[80:83], v[112:115], a[200:203], v[80:83]
  ds_read_b64_tr_b16 v[140:141], v226 offset:16992
  v_mfma_f32_16x16x32_bf16 v[84:87], v[112:115], a[204:207], v[84:87]
  ds_read_b64_tr_b16 v[142:143], v226 offset:20064
  v_mov_b32 v25, 0
  v_mfma_f32_16x16x32_bf16 v[88:91], v[116:119], a[200:203], v[88:91]
  ds_read_b64_tr_b16 v[112:113], v225 offset:17024
  v_mfma_f32_16x16x32_bf16 v[92:95], v[116:119], a[204:207], v[92:95]
  buffer_load_dwordx4 a[36:39], v251, s[4:7], s51 offen offset:1024 sc1
  ds_read_b64_tr_b16 v[114:115], v225 offset:20096
  s_waitcnt lgkmcnt(10)
  v_mfma_f32_16x16x32_bf16 v[96:99], v[120:123], a[200:203], v[96:99]
  ds_read_b64_tr_b16 v[116:117], v226 offset:17056
  v_mfma_f32_16x16x32_bf16 v[100:103], v[120:123], a[204:207], v[100:103]
  ds_read_b64_tr_b16 v[118:119], v226 offset:20128
  v_mov_b32 v27, 0
  v_mfma_f32_16x16x32_bf16 v[104:107], v[124:127], a[200:203], v[104:107]
  ds_read_b64_tr_b16 v[120:121], v225 offset:23040
  v_mfma_f32_16x16x32_bf16 v[108:111], v[124:127], a[204:207], v[108:111]
  buffer_load_dwordx4 a[40:43], v251, s[4:7], s51 offen offset:2048 sc1
  ds_read_b64_tr_b16 v[122:123], v225 offset:26112
  s_waitcnt lgkmcnt(10)
  v_mfma_f32_16x16x32_bf16 v[64:67], v[128:131], a[208:211], v[64:67]
  ds_read_b64_tr_b16 v[124:125], v226 offset:23072
  v_mfma_f32_16x16x32_bf16 v[68:71], v[128:131], a[212:215], v[68:71]
  ds_read_b64_tr_b16 v[126:127], v226 offset:26144
  v_mfma_f32_16x16x32_bf16 v[72:75], v[132:135], a[208:211], v[72:75]
  ds_read_b64_tr_b16 v[128:129], v225 offset:23104
  v_mfma_f32_16x16x32_bf16 v[76:79], v[132:135], a[212:215], v[76:79]
  buffer_load_dwordx4 a[44:47], v251, s[4:7], s51 offen offset:3072 sc1
  ds_read_b64_tr_b16 v[130:131], v225 offset:26176
  s_waitcnt lgkmcnt(10)
  v_mfma_f32_16x16x32_bf16 v[80:83], v[136:139], a[208:211], v[80:83]
  ds_read_b64_tr_b16 v[132:133], v226 offset:23136
  v_mfma_f32_16x16x32_bf16 v[84:87], v[136:139], a[212:215], v[84:87]
  ds_read_b64_tr_b16 v[134:135], v226 offset:26208
  s_add_u32 s51, s46, 18432
  v_mfma_f32_16x16x32_bf16 v[88:91], v[140:143], a[208:211], v[88:91]
  ds_read_b64_tr_b16 v[136:137], v225 offset:23168
  v_mfma_f32_16x16x32_bf16 v[92:95], v[140:143], a[212:215], v[92:95]
  buffer_load_dwordx4 a[48:51], v251, s[4:7], s51 offen offset:0 sc1
  ds_read_b64_tr_b16 v[138:139], v225 offset:26240
  s_waitcnt lgkmcnt(10)
  v_mfma_f32_16x16x32_bf16 v[96:99], v[112:115], a[208:211], v[96:99]
  ds_read_b64_tr_b16 v[140:141], v226 offset:23200
  v_mfma_f32_16x16x32_bf16 v[100:103], v[112:115], a[212:215], v[100:103]
  ds_read_b64_tr_b16 v[142:143], v226 offset:26272
  v_mfma_f32_16x16x32_bf16 v[104:107], v[116:119], a[208:211], v[104:107]
  s_waitcnt vmcnt(13)
  s_barrier
  ds_read_b64_tr_b16 v[112:113], v223 offset:0
  v_mfma_f32_16x16x32_bf16 v[108:111], v[116:119], a[212:215], v[108:111]
  ds_read_b64_tr_b16 v[114:115], v223 offset:3072
  s_waitcnt lgkmcnt(10)
  v_mfma_f32_16x16x32_bf16 v[64:67], v[120:123], a[216:219], v[64:67]
  ds_read_b64_tr_b16 v[116:117], v224 offset:32
  v_mfma_f32_16x16x32_bf16 v[68:71], v[120:123], a[220:223], v[68:71]
  ds_read_b64_tr_b16 v[118:119], v224 offset:3104
  v_mfma_f32_16x16x32_bf16 v[72:75], v[124:127], a[216:219], v[72:75]
  ds_read_b64_tr_b16 v[120:121], v223 offset:64
  v_mfma_f32_16x16x32_bf16 v[76:79], v[124:127], a[220:223], v[76:79]
  buffer_load_dwordx4 a[52:55], v251, s[4:7], s51 offen offset:1024 sc1
  ds_read_b64_tr_b16 v[122:123], v223 offset:3136
  s_waitcnt lgkmcnt(10)
  v_mfma_f32_16x16x32_bf16 v[80:83], v[128:131], a[216:219], v[80:83]
  ds_read_b64_tr_b16 v[124:125], v224 offset:96
  v_mfma_f32_16x16x32_bf16 v[84:87], v[128:131], a[220:223], v[84:87]
  ds_read_b64_tr_b16 v[126:127], v224 offset:3168
  v_mfma_f32_16x16x32_bf16 v[88:91], v[132:135], a[216:219], v[88:91]
  ds_read_b64_tr_b16 v[128:129], v223 offset:128
  v_mfma_f32_16x16x32_bf16 v[92:95], v[132:135], a[220:223], v[92:95]
  buffer_load_dwordx4 a[56:59], v251, s[4:7], s51 offen offset:2048 sc1
  ds_read_b64_tr_b16 v[130:131], v223 offset:3200
  s_waitcnt lgkmcnt(10)
  v_mfma_f32_16x16x32_bf16 v[96:99], v[136:139], a[216:219], v[96:99]
  ds_read_b64_tr_b16 v[132:133], v224 offset:160
  v_mfma_f32_16x16x32_bf16 v[100:103], v[136:139], a[220:223], v[100:103]
  ds_read_b64_tr_b16 v[134:135], v224 offset:3232
  v_mfma_f32_16x16x32_bf16 v[104:107], v[140:143], a[216:219], v[104:107]
  ds_read_b64_tr_b16 v[136:137], v223 offset:6144
  v_mfma_f32_16x16x32_bf16 v[108:111], v[140:143], a[220:223], v[108:111]
  buffer_load_dwordx4 a[60:63], v251, s[4:7], s51 offen offset:3072 sc1
  ds_read_b64_tr_b16 v[138:139], v223 offset:9216
  s_waitcnt lgkmcnt(10)
  v_mfma_f32_16x16x32_bf16 v[64:67], v[112:115], a[224:227], v[64:67]
  ds_read_b64_tr_b16 v[140:141], v224 offset:6176
  v_mfma_f32_16x16x32_bf16 v[68:71], v[112:115], a[228:231], v[68:71]
  ds_read_b64_tr_b16 v[142:143], v224 offset:9248
  s_add_u32 s59, s57, s85
  v_mfma_f32_16x16x32_bf16 v[72:75], v[116:119], a[224:227], v[72:75]
  ds_read_b64_tr_b16 v[112:113], v223 offset:6208
  v_mfma_f32_16x16x32_bf16 v[76:79], v[116:119], a[228:231], v[76:79]
  ds_read_b64_tr_b16 v[114:115], v223 offset:9280
  buffer_load_ushort v16, v238, s[24:27], s59 offen offset:0
  s_waitcnt lgkmcnt(10)
  v_mfma_f32_16x16x32_bf16 v[80:83], v[120:123], a[224:227], v[80:83]
  ds_read_b64_tr_b16 v[116:117], v224 offset:6240
  v_mfma_f32_16x16x32_bf16 v[84:87], v[120:123], a[228:231], v[84:87]
  ds_read_b64_tr_b16 v[118:119], v224 offset:9312
  v_mfma_f32_16x16x32_bf16 v[88:91], v[124:127], a[224:227], v[88:91]
  ds_read_b64_tr_b16 v[120:121], v223 offset:6272
  v_mfma_f32_16x16x32_bf16 v[92:95], v[124:127], a[228:231], v[92:95]
  ds_read_b64_tr_b16 v[122:123], v223 offset:9344
  buffer_load_ushort v18, v238, s[24:27], s59 offen offset:32
  s_waitcnt lgkmcnt(10)
  v_mfma_f32_16x16x32_bf16 v[96:99], v[128:131], a[224:227], v[96:99]
  ds_read_b64_tr_b16 v[124:125], v224 offset:6304
  v_mfma_f32_16x16x32_bf16 v[100:103], v[128:131], a[228:231], v[100:103]
  ds_read_b64_tr_b16 v[126:127], v224 offset:9376
  v_mfma_f32_16x16x32_bf16 v[104:107], v[132:135], a[224:227], v[104:107]
  s_waitcnt vmcnt(12)
  s_barrier
  ds_read_b64_tr_b16 v[128:129], v223 offset:16896
  v_mfma_f32_16x16x32_bf16 v[108:111], v[132:135], a[228:231], v[108:111]
  ds_read_b64_tr_b16 v[130:131], v223 offset:19968
  buffer_load_ushort v20, v238, s[24:27], s59 offen offset:64
  s_waitcnt lgkmcnt(10)
  v_mfma_f32_16x16x32_bf16 v[64:67], v[136:139], a[232:235], v[64:67]
  ds_read_b64_tr_b16 v[132:133], v224 offset:16928
  v_mfma_f32_16x16x32_bf16 v[68:71], v[136:139], a[236:239], v[68:71]
  ds_read_b64_tr_b16 v[134:135], v224 offset:20000
  v_mfma_f32_16x16x32_bf16 v[72:75], v[140:143], a[232:235], v[72:75]
  ds_read_b64_tr_b16 v[136:137], v223 offset:16960
  v_mfma_f32_16x16x32_bf16 v[76:79], v[140:143], a[236:239], v[76:79]
  ds_read_b64_tr_b16 v[138:139], v223 offset:20032
  buffer_load_ushort v22, v238, s[24:27], s59 offen offset:96
  s_waitcnt lgkmcnt(10)
  v_mfma_f32_16x16x32_bf16 v[80:83], v[112:115], a[232:235], v[80:83]
  ds_read_b64_tr_b16 v[140:141], v224 offset:16992
  v_mfma_f32_16x16x32_bf16 v[84:87], v[112:115], a[236:239], v[84:87]
  ds_read_b64_tr_b16 v[142:143], v224 offset:20064
  v_mfma_f32_16x16x32_bf16 v[88:91], v[116:119], a[232:235], v[88:91]
  ds_read_b64_tr_b16 v[112:113], v223 offset:17024
  v_mfma_f32_16x16x32_bf16 v[92:95], v[116:119], a[236:239], v[92:95]
  ds_read_b64_tr_b16 v[114:115], v223 offset:20096
  buffer_load_ushort v24, v238, s[24:27], s59 offen offset:128
  s_waitcnt lgkmcnt(10)
  v_mfma_f32_16x16x32_bf16 v[96:99], v[120:123], a[232:235], v[96:99]
  ds_read_b64_tr_b16 v[116:117], v224 offset:17056
  v_mfma_f32_16x16x32_bf16 v[100:103], v[120:123], a[236:239], v[100:103]
  ds_read_b64_tr_b16 v[118:119], v224 offset:20128
  v_mfma_f32_16x16x32_bf16 v[104:107], v[124:127], a[232:235], v[104:107]
  ds_read_b64_tr_b16 v[120:121], v223 offset:23040
  v_mfma_f32_16x16x32_bf16 v[108:111], v[124:127], a[236:239], v[108:111]
  ds_read_b64_tr_b16 v[122:123], v223 offset:26112
  buffer_load_ushort v26, v238, s[24:27], s59 offen offset:160
  s_waitcnt lgkmcnt(10)
  v_mfma_f32_16x16x32_bf16 v[64:67], v[128:131], a[240:243], v[64:67]
  ds_read_b64_tr_b16 v[124:125], v224 offset:23072
  v_mfma_f32_16x16x32_bf16 v[68:71], v[128:131], a[244:247], v[68:71]
  ds_read_b64_tr_b16 v[126:127], v224 offset:26144
  s_cmp_eq_u32 s39, 5
  s_cselect_b32 s3, 114688, 0
  s_sub_u32 s46, s46, s3
  s_add_u32 s51, s46, 28672
  v_mfma_f32_16x16x32_bf16 v[72:75], v[132:135], a[240:243], v[72:75]
  ds_read_b64_tr_b16 v[128:129], v223 offset:23104
  v_mfma_f32_16x16x32_bf16 v[76:79], v[132:135], a[244:247], v[76:79]
  buffer_load_dwordx4 a[64:67], v251, s[4:7], s51 offen offset:0 sc1
  ds_read_b64_tr_b16 v[130:131], v223 offset:26176
  s_waitcnt lgkmcnt(10)
  v_mfma_f32_16x16x32_bf16 v[80:83], v[136:139], a[240:243], v[80:83]
  ds_read_b64_tr_b16 v[132:133], v224 offset:23136
  v_mfma_f32_16x16x32_bf16 v[84:87], v[136:139], a[244:247], v[84:87]
  ds_read_b64_tr_b16 v[134:135], v224 offset:26208
  v_mfma_f32_16x16x32_bf16 v[88:91], v[140:143], a[240:243], v[88:91]
  ds_read_b64_tr_b16 v[136:137], v223 offset:23168
  v_mfma_f32_16x16x32_bf16 v[92:95], v[140:143], a[244:247], v[92:95]
  buffer_load_dwordx4 a[68:71], v251, s[4:7], s51 offen offset:1024 sc1
  ds_read_b64_tr_b16 v[138:139], v223 offset:26240
  s_waitcnt lgkmcnt(10)
  v_mfma_f32_16x16x32_bf16 v[96:99], v[112:115], a[240:243], v[96:99]
  ds_read_b64_tr_b16 v[140:141], v224 offset:23200
  v_mfma_f32_16x16x32_bf16 v[100:103], v[112:115], a[244:247], v[100:103]
  ds_read_b64_tr_b16 v[142:143], v224 offset:26272
  v_mfma_f32_16x16x32_bf16 v[104:107], v[116:119], a[240:243], v[104:107]
  v_mfma_f32_16x16x32_bf16 v[108:111], v[116:119], a[244:247], v[108:111]
  buffer_load_dwordx4 a[72:75], v251, s[4:7], s51 offen offset:2048 sc1
  s_waitcnt lgkmcnt(8)
  v_mfma_f32_16x16x32_bf16 v[64:67], v[120:123], a[248:251], v[64:67]
  v_mfma_f32_16x16x32_bf16 v[68:71], v[120:123], a[252:255], v[68:71]
  v_mfma_f32_16x16x32_bf16 v[72:75], v[124:127], a[248:251], v[72:75]
  v_mfma_f32_16x16x32_bf16 v[76:79], v[124:127], a[252:255], v[76:79]
  buffer_load_dwordx4 a[76:79], v251, s[4:7], s51 offen offset:3072 sc1
  s_waitcnt lgkmcnt(4)
  v_mfma_f32_16x16x32_bf16 v[80:83], v[128:131], a[248:251], v[80:83]
  v_mfma_f32_16x16x32_bf16 v[84:87], v[128:131], a[252:255], v[84:87]
  s_add_u32 s51, s46, 32768
  v_mfma_f32_16x16x32_bf16 v[88:91], v[132:135], a[248:251], v[88:91]
  v_mfma_f32_16x16x32_bf16 v[92:95], v[132:135], a[252:255], v[92:95]
  buffer_load_dwordx4 a[80:83], v251, s[4:7], s51 offen offset:0 sc1
  s_waitcnt lgkmcnt(0)
  v_mfma_f32_16x16x32_bf16 v[96:99], v[136:139], a[248:251], v[96:99]
  v_mfma_f32_16x16x32_bf16 v[100:103], v[136:139], a[252:255], v[100:103]
  v_mfma_f32_16x16x32_bf16 v[104:107], v[140:143], a[248:251], v[104:107]
  v_mfma_f32_16x16x32_bf16 v[108:111], v[140:143], a[252:255], v[108:111]
  buffer_load_dwordx4 a[84:87], v251, s[4:7], s51 offen offset:1024 sc1
  s_waitcnt vmcnt(6)
  v_lshl_or_b32 v16, v16, 16, v16
  v_lshl_or_b32 v18, v18, 16, v18
  v_lshl_or_b32 v20, v20, 16, v20
  v_lshl_or_b32 v22, v22, 16, v22
  v_lshl_or_b32 v24, v24, 16, v24
  v_lshl_or_b32 v26, v26, 16, v26
  v_mfma_f32_16x16x16_bf16 v[64:67], v[16:17], v[200:201], v[64:67]
  v_mfma_f32_16x16x16_bf16 v[68:71], v[16:17], v[202:203], v[68:71]
  v_mfma_f32_16x16x16_bf16 v[72:75], v[18:19], v[200:201], v[72:75]
  v_mfma_f32_16x16x16_bf16 v[76:79], v[18:19], v[202:203], v[76:79]
  v_mfma_f32_16x16x16_bf16 v[80:83], v[20:21], v[200:201], v[80:83]
  v_mfma_f32_16x16x16_bf16 v[84:87], v[20:21], v[202:203], v[84:87]
  v_mfma_f32_16x16x16_bf16 v[88:91], v[22:23], v[200:201], v[88:91]
  v_mfma_f32_16x16x16_bf16 v[92:95], v[22:23], v[202:203], v[92:95]
  s_nop 1
  v_mfma_f32_16x16x16_bf16 v[96:99], v[24:25], v[200:201], v[96:99]
  v_mfma_f32_16x16x16_bf16 v[100:103], v[24:25], v[202:203], v[100:103]
  v_mfma_f32_16x16x16_bf16 v[104:107], v[26:27], v[200:201], v[104:107]
  v_mfma_f32_16x16x16_bf16 v[108:111], v[26:27], v[202:203], v[108:111]
  v_max_f32 v0, 0, v64
  v_max_f32 v1, 0, v65
  v_max_f32 v2, 0, v66
  v_max_f32 v3, 0, v67
  v_max_f32 v4, 0, v72
  v_max_f32 v5, 0, v73
  v_max_f32 v6, 0, v74
  v_max_f32 v7, 0, v75
  v_pk_mul_f32 v[64:65], v[64:65], v[0:1]
  v_pk_mul_f32 v[66:67], v[66:67], v[2:3]
  v_pk_mul_f32 v[72:73], v[72:73], v[4:5]
  v_pk_mul_f32 v[74:75], v[74:75], v[6:7]
  v_cvt_pk_bf16_f32 v176, v64, v65
  v_cvt_pk_bf16_f32 v177, v66, v67
  v_cvt_pk_bf16_f32 v178, v72, v73
  v_cvt_pk_bf16_f32 v179, v74, v75
  s_mov_b32 s53, 8192
  buffer_store_dwordx4 v[176:179], v251, s[20:23], s53 offen offset:0 sc1
  v_max_f32 v8, 0, v68
  v_max_f32 v9, 0, v69
  v_max_f32 v10, 0, v70
  v_max_f32 v11, 0, v71
  v_max_f32 v12, 0, v76
  v_max_f32 v13, 0, v77
  v_max_f32 v14, 0, v78
  v_max_f32 v15, 0, v79
  v_pk_mul_f32 v[68:69], v[68:69], v[8:9]
  v_pk_mul_f32 v[70:71], v[70:71], v[10:11]
  v_pk_mul_f32 v[76:77], v[76:77], v[12:13]
  v_pk_mul_f32 v[78:79], v[78:79], v[14:15]
  v_cvt_pk_bf16_f32 v180, v68, v69
  v_cvt_pk_bf16_f32 v181, v70, v71
  v_cvt_pk_bf16_f32 v182, v76, v77
  v_cvt_pk_bf16_f32 v183, v78, v79
  buffer_store_dwordx4 v[180:183], v251, s[20:23], s53 offen offset:1024 sc1
  v_max_f32 v0, 0, v80
  v_max_f32 v1, 0, v81
  v_max_f32 v2, 0, v82
  v_max_f32 v3, 0, v83
  v_max_f32 v4, 0, v88
  v_max_f32 v5, 0, v89
  v_max_f32 v6, 0, v90
  v_max_f32 v7, 0, v91
  v_pk_mul_f32 v[80:81], v[80:81], v[0:1]
  v_pk_mul_f32 v[82:83], v[82:83], v[2:3]
  v_pk_mul_f32 v[88:89], v[88:89], v[4:5]
  v_pk_mul_f32 v[90:91], v[90:91], v[6:7]
  v_cvt_pk_bf16_f32 v184, v80, v81
  v_cvt_pk_bf16_f32 v185, v82, v83
  v_cvt_pk_bf16_f32 v186, v88, v89
  v_cvt_pk_bf16_f32 v187, v90, v91
  v_max_f32 v8, 0, v84
  v_max_f32 v9, 0, v85
  v_max_f32 v10, 0, v86
  v_max_f32 v11, 0, v87
  v_max_f32 v12, 0, v92
  v_max_f32 v13, 0, v93
  v_max_f32 v14, 0, v94
  v_max_f32 v15, 0, v95
  v_pk_mul_f32 v[84:85], v[84:85], v[8:9]
  v_pk_mul_f32 v[86:87], v[86:87], v[10:11]
  v_pk_mul_f32 v[92:93], v[92:93], v[12:13]
  v_pk_mul_f32 v[94:95], v[94:95], v[14:15]
  v_cvt_pk_bf16_f32 v188, v84, v85
  v_cvt_pk_bf16_f32 v189, v86, v87
  v_cvt_pk_bf16_f32 v190, v92, v93
  v_cvt_pk_bf16_f32 v191, v94, v95
  v_max_f32 v0, 0, v96
  v_max_f32 v1, 0, v97
  v_max_f32 v2, 0, v98
  v_max_f32 v3, 0, v99
  v_max_f32 v4, 0, v104
  v_max_f32 v5, 0, v105
  v_max_f32 v6, 0, v106
  v_max_f32 v7, 0, v107
  v_pk_mul_f32 v[96:97], v[96:97], v[0:1]
  v_pk_mul_f32 v[98:99], v[98:99], v[2:3]
  v_pk_mul_f32 v[104:105], v[104:105], v[4:5]
  v_pk_mul_f32 v[106:107], v[106:107], v[6:7]
  v_cvt_pk_bf16_f32 v192, v96, v97
  v_cvt_pk_bf16_f32 v193, v98, v99
  v_cvt_pk_bf16_f32 v194, v104, v105
  v_cvt_pk_bf16_f32 v195, v106, v107
  v_max_f32 v8, 0, v100
  v_max_f32 v9, 0, v101
  v_max_f32 v10, 0, v102
  v_max_f32 v11, 0, v103
  v_max_f32 v12, 0, v108
  v_max_f32 v13, 0, v109
  v_max_f32 v14, 0, v110
  v_max_f32 v15, 0, v111
  v_pk_mul_f32 v[100:101], v[100:101], v[8:9]
  v_pk_mul_f32 v[102:103], v[102:103], v[10:11]
  v_pk_mul_f32 v[108:109], v[108:109], v[12:13]
  v_pk_mul_f32 v[110:111], v[110:111], v[14:15]
  v_cvt_pk_bf16_f32 v196, v100, v101
  v_cvt_pk_bf16_f32 v197, v102, v103
  v_cvt_pk_bf16_f32 v198, v108, v109
  v_cvt_pk_bf16_f32 v199, v110, v111
  v_lshrrev_b32 v104, 2, v248
  v_lshlrev_b32 v105, 7, v104
  v_and_b32 v106, 3, v248
  v_lshl_add_u32 v105, v106, 3, v105
  v_and_b32 v106, 6, v104
  v_lshlrev_b32 v106, 4, v106
  v_xor_b32 v107, 0, v106
  v_add_u32 v224, v105, v107
  v_add_u32 v228, 0x10000, v224
  v_xor_b32 v107, 32, v106
  v_add_u32 v225, v105, v107
  v_add_u32 v229, 0x10000, v225
  v_xor_b32 v107, 64, v106
  v_add_u32 v226, v105, v107
  v_add_u32 v230, 0x10000, v226
  v_xor_b32 v107, 96, v106
  v_add_u32 v227, v105, v107
  v_add_u32 v231, 0x10000, v227
  s_barrier
  ds_read_b64_tr_b16 v[112:113], v228 offset:20480
  ds_read_b64_tr_b16 v[114:115], v228 offset:22528
  ds_read_b64_tr_b16 v[116:117], v229 offset:20480
  ds_read_b64_tr_b16 v[118:119], v229 offset:22528
  ds_read_b64_tr_b16 v[120:121], v230 offset:20480
  ds_read_b64_tr_b16 v[122:123], v230 offset:22528
  ds_read_b64_tr_b16 v[124:125], v231 offset:20480
  ds_read_b64_tr_b16 v[126:127], v231 offset:22528
  ds_read_b64_tr_b16 v[128:129], v228 offset:24576
  ds_read_b64_tr_b16 v[130:131], v228 offset:26624
  ds_read_b64_tr_b16 v[132:133], v229 offset:24576
  ds_read_b64_tr_b16 v[134:135], v229 offset:26624
  ds_read_b64_tr_b16 v[136:137], v230 offset:24576
  ds_read_b64_tr_b16 v[138:139], v230 offset:26624
  s_waitcnt lgkmcnt(10)
  v_mfma_f32_16x16x32_bf16 v[32:35], v[112:115], v[144:147], 0
  ds_read_b64_tr_b16 v[140:141], v231 offset:24576
  v_mfma_f32_16x16x32_bf16 v[36:39], v[112:115], v[148:151], 0
  ds_read_b64_tr_b16 v[142:143], v231 offset:26624
  s_add_u32 m0, s49, 0
  s_nop 0
  buffer_load_dwordx4 v240, s[28:31], s50 offen lds
  s_add_u32 s50, s91, 393216
  s_add_u32 m0, s49, 4096
  v_mfma_f32_16x16x32_bf16 v[40:43], v[116:119], v[144:147], 0
  ds_read_b64_tr_b16 v[112:113], v228 offset:28672
  v_mfma_f32_16x16x32_bf16 v[44:47], v[116:119], v[148:151], 0
  buffer_load_dwordx4 v240, s[16:19], s50 offen lds
  ds_read_b64_tr_b16 v[114:115], v228 offset:30720
  s_waitcnt lgkmcnt(10)
  v_mfma_f32_16x16x32_bf16 v[48:51], v[120:123], v[144:147], 0
  ds_read_b64_tr_b16 v[116:117], v229 offset:28672
  v_mfma_f32_16x16x32_bf16 v[52:55], v[120:123], v[148:151], 0
  ds_read_b64_tr_b16 v[118:119], v229 offset:30720
  v_mfma_f32_16x16x32_bf16 v[56:59], v[124:127], v[144:147], 0
  ds_read_b64_tr_b16 v[120:121], v230 offset:28672
  v_mfma_f32_16x16x32_bf16 v[60:63], v[124:127], v[148:151], 0
  ds_read_b64_tr_b16 v[122:123], v230 offset:30720
  buffer_store_dwordx4 v[184:187], v251, s[20:23], s53 offen offset:2048 sc1
  s_waitcnt lgkmcnt(10)
  v_mfma_f32_16x16x32_bf16 v[64:67], v[128:131], v[144:147], 0
  ds_read_b64_tr_b16 v[124:125], v231 offset:28672
  v_mfma_f32_16x16x32_bf16 v[68:71], v[128:131], v[148:151], 0
  ds_read_b64_tr_b16 v[126:127], v231 offset:30720
  s_add_u32 m0, s49, 8192
  v_mfma_f32_16x16x32_bf16 v[72:75], v[132:135], v[144:147], 0
  ds_read_b64_tr_b16 v[128:129], v228 offset:32768
  v_mfma_f32_16x16x32_bf16 v[76:79], v[132:135], v[148:151], 0
  buffer_load_dwordx4 v240, s[28:31], s50 offen lds
  ds_read_b64_tr_b16 v[130:131], v228 offset:34816
  s_waitcnt lgkmcnt(10)
  v_mfma_f32_16x16x32_bf16 v[80:83], v[136:139], v[144:147], 0
  ds_read_b64_tr_b16 v[132:133], v229 offset:32768
  v_mfma_f32_16x16x32_bf16 v[84:87], v[136:139], v[148:151], 0
  ds_read_b64_tr_b16 v[134:135], v229 offset:34816
  s_mul_i32 s86, s39, 458752
  s_add_u32 s86, s86, 458752
  s_bitcmp1_b32 s39, 0
  s_cselect_b32 s3, 196608, 0
  s_cselect_b32 s48, 0, 196608
  s_add_u32 s87, s86, s3
  s_add_u32 s86, s86, s48
  s_cmp_eq_u32 s39, 7
  s_cselect_b32 s3, 3670016, 0
  s_sub_u32 s86, s86, s3
  s_sub_u32 s87, s87, s3
  s_add_u32 s50, s86, 0
  s_add_u32 m0, s49, 12288
  v_mfma_f32_16x16x32_bf16 v[88:91], v[140:143], v[144:147], 0
  ds_read_b64_tr_b16 v[136:137], v230 offset:32768
  v_mfma_f32_16x16x32_bf16 v[92:95], v[140:143], v[148:151], 0
  buffer_load_dwordx4 v241, s[16:19], s50 offen lds
  ds_read_b64_tr_b16 v[138:139], v230 offset:34816
  s_waitcnt lgkmcnt(10)
  v_mfma_f32_16x16x32_bf16 v[32:35], v[112:115], v[152:155], v[32:35]
  ds_read_b64_tr_b16 v[140:141], v231 offset:32768
  v_mfma_f32_16x16x32_bf16 v[36:39], v[112:115], v[156:159], v[36:39]
  ds_read_b64_tr_b16 v[142:143], v231 offset:34816
  v_mfma_f32_16x16x32_bf16 v[40:43], v[116:119], v[152:155], v[40:43]
  s_barrier
  ds_read_b64_tr_b16 v[112:113], v228 offset:36864
  v_mfma_f32_16x16x32_bf16 v[44:47], v[116:119], v[156:159], v[44:47]
  ds_read_b64_tr_b16 v[114:115], v228 offset:38912
  buffer_store_dwordx4 v[188:191], v251, s[20:23], s53 offen offset:3072 sc1
  s_waitcnt lgkmcnt(10)
  v_mfma_f32_16x16x32_bf16 v[48:51], v[120:123], v[152:155], v[48:51]
  ds_read_b64_tr_b16 v[116:117], v229 offset:36864
  v_mfma_f32_16x16x32_bf16 v[52:55], v[120:123], v[156:159], v[52:55]
  ds_read_b64_tr_b16 v[118:119], v229 offset:38912
  s_add_u32 m0, s49, 16384
  v_mfma_f32_16x16x32_bf16 v[56:59], v[124:127], v[152:155], v[56:59]
  ds_read_b64_tr_b16 v[120:121], v230 offset:36864
  v_mfma_f32_16x16x32_bf16 v[60:63], v[124:127], v[156:159], v[60:63]
  buffer_load_dwordx4 v241, s[28:31], s50 offen lds
  ds_read_b64_tr_b16 v[122:123], v230 offset:38912
  s_waitcnt lgkmcnt(10)
  v_mfma_f32_16x16x32_bf16 v[64:67], v[128:131], v[152:155], v[64:67]
  ds_read_b64_tr_b16 v[124:125], v231 offset:36864
  v_mfma_f32_16x16x32_bf16 v[68:71], v[128:131], v[156:159], v[68:71]
  ds_read_b64_tr_b16 v[126:127], v231 offset:38912
  s_add_u32 s50, s86, 65536
  s_add_u32 m0, s49, 20480
  v_mfma_f32_16x16x32_bf16 v[72:75], v[132:135], v[152:155], v[72:75]
  ds_read_b64_tr_b16 v[128:129], v228 offset:40960
  v_mfma_f32_16x16x32_bf16 v[76:79], v[132:135], v[156:159], v[76:79]
  buffer_load_dwordx4 v241, s[16:19], s50 offen lds
  ds_read_b64_tr_b16 v[130:131], v228 offset:43008
  s_waitcnt lgkmcnt(10)
  v_mfma_f32_16x16x32_bf16 v[80:83], v[136:139], v[152:155], v[80:83]
  ds_read_b64_tr_b16 v[132:133], v229 offset:40960
  v_mfma_f32_16x16x32_bf16 v[84:87], v[136:139], v[156:159], v[84:87]
  ds_read_b64_tr_b16 v[134:135], v229 offset:43008
  v_mfma_f32_16x16x32_bf16 v[88:91], v[140:143], v[152:155], v[88:91]
  ds_read_b64_tr_b16 v[136:137], v230 offset:40960
  v_mfma_f32_16x16x32_bf16 v[92:95], v[140:143], v[156:159], v[92:95]
  ds_read_b64_tr_b16 v[138:139], v230 offset:43008
  s_mov_b32 s53, 12288
  buffer_store_dwordx4 v[192:195], v251, s[20:23], s53 offen offset:0 sc1
  s_waitcnt lgkmcnt(10)
  v_mfma_f32_16x16x32_bf16 v[32:35], v[112:115], v[160:163], v[32:35]
  ds_read_b64_tr_b16 v[140:141], v231 offset:40960
  v_mfma_f32_16x16x32_bf16 v[36:39], v[112:115], v[164:167], v[36:39]
  ds_read_b64_tr_b16 v[142:143], v231 offset:43008
  s_add_u32 m0, s49, 24576
  v_mfma_f32_16x16x32_bf16 v[40:43], v[116:119], v[160:163], v[40:43]
  ds_read_b64_tr_b16 v[112:113], v228 offset:45056
  v_mfma_f32_16x16x32_bf16 v[44:47], v[116:119], v[164:167], v[44:47]
  buffer_load_dwordx4 v241, s[28:31], s50 offen lds
  ds_read_b64_tr_b16 v[114:115], v228 offset:47104
  s_waitcnt lgkmcnt(10)
  v_mfma_f32_16x16x32_bf16 v[48:51], v[120:123], v[160:163], v[48:51]
  ds_read_b64_tr_b16 v[116:117], v229 offset:45056
  v_mfma_f32_16x16x32_bf16 v[52:55], v[120:123], v[164:167], v[52:55]
  ds_read_b64_tr_b16 v[118:119], v229 offset:47104
  s_add_u32 s50, s86, 131072
  s_add_u32 m0, s49, 28672
  v_mfma_f32_16x16x32_bf16 v[56:59], v[124:127], v[160:163], v[56:59]
  ds_read_b64_tr_b16 v[120:121], v230 offset:45056
  v_mfma_f32_16x16x32_bf16 v[60:63], v[124:127], v[164:167], v[60:63]
  buffer_load_dwordx4 v241, s[16:19], s50 offen lds
  ds_read_b64_tr_b16 v[122:123], v230 offset:47104
  s_waitcnt lgkmcnt(10)
  v_mfma_f32_16x16x32_bf16 v[64:67], v[128:131], v[160:163], v[64:67]
  ds_read_b64_tr_b16 v[124:125], v231 offset:45056
  v_mfma_f32_16x16x32_bf16 v[68:71], v[128:131], v[164:167], v[68:71]
  ds_read_b64_tr_b16 v[126:127], v231 offset:47104
  v_mfma_f32_16x16x32_bf16 v[72:75], v[132:135], v[160:163], v[72:75]
  ds_read_b64_tr_b16 v[128:129], v228 offset:49152
  v_mfma_f32_16x16x32_bf16 v[76:79], v[132:135], v[164:167], v[76:79]
  ds_read_b64_tr_b16 v[130:131], v228 offset:51200
  buffer_store_dwordx4 v[196:199], v251, s[20:23], s53 offen offset:1024 sc1
  s_waitcnt lgkmcnt(10)
  v_mfma_f32_16x16x32_bf16 v[80:83], v[136:139], v[160:163], v[80:83]
  ds_read_b64_tr_b16 v[132:133], v229 offset:49152
  v_mfma_f32_16x16x32_bf16 v[84:87], v[136:139], v[164:167], v[84:87]
  ds_read_b64_tr_b16 v[134:135], v229 offset:51200
  s_add_u32 m0, s49, 32768
  v_mfma_f32_16x16x32_bf16 v[88:91], v[140:143], v[160:163], v[88:91]
  ds_read_b64_tr_b16 v[136:137], v230 offset:49152
  v_mfma_f32_16x16x32_bf16 v[92:95], v[140:143], v[164:167], v[92:95]
  buffer_load_dwordx4 v241, s[28:31], s50 offen lds
  ds_read_b64_tr_b16 v[138:139], v230 offset:51200
  s_waitcnt lgkmcnt(10)
  v_mfma_f32_16x16x32_bf16 v[32:35], v[112:115], v[168:171], v[32:35]
  ds_read_b64_tr_b16 v[140:141], v231 offset:49152
  v_mfma_f32_16x16x32_bf16 v[36:39], v[112:115], v[172:175], v[36:39]
  ds_read_b64_tr_b16 v[142:143], v231 offset:51200
  s_add_u32 s50, s86, 196608
  s_add_u32 m0, s49, 36864
  v_mfma_f32_16x16x32_bf16 v[40:43], v[116:119], v[168:171], v[40:43]
  buffer_load_dwordx4 v241, s[16:19], s50 offen lds
  s_waitcnt vmcnt(13)
  s_barrier
  ds_read_b64_tr_b16 v[112:113], v228 offset:53248
  v_mfma_f32_16x16x32_bf16 v[44:47], v[116:119], v[172:175], v[44:47]
  ds_read_b64_tr_b16 v[114:115], v228 offset:55296
  s_waitcnt lgkmcnt(10)
  v_mfma_f32_16x16x32_bf16 v[48:51], v[120:123], v[168:171], v[48:51]
  ds_read_b64_tr_b16 v[116:117], v229 offset:53248
  v_mfma_f32_16x16x32_bf16 v[52:55], v[120:123], v[172:175], v[52:55]
  ds_read_b64_tr_b16 v[118:119], v229 offset:55296
  s_add_u32 m0, s49, 40960
  v_mfma_f32_16x16x32_bf16 v[56:59], v[124:127], v[168:171], v[56:59]
  ds_read_b64_tr_b16 v[120:121], v230 offset:53248
  v_mfma_f32_16x16x32_bf16 v[60:63], v[124:127], v[172:175], v[60:63]
  buffer_load_dwordx4 v241, s[28:31], s50 offen lds
  ds_read_b64_tr_b16 v[122:123], v230 offset:55296
  s_waitcnt lgkmcnt(10)
  v_mfma_f32_16x16x32_bf16 v[64:67], v[128:131], v[168:171], v[64:67]
  ds_read_b64_tr_b16 v[124:125], v231 offset:53248
  v_mfma_f32_16x16x32_bf16 v[68:71], v[128:131], v[172:175], v[68:71]
  ds_read_b64_tr_b16 v[126:127], v231 offset:55296
  s_cmp_eq_u32 s39, 6
  s_cselect_b32 s3, 3670016, 0
  s_sub_u32 s86, s86, s3
  s_sub_u32 s87, s87, s3
  s_add_u32 s50, s87, 458752
  s_add_u32 m0, s49, 45056
  v_mfma_f32_16x16x32_bf16 v[72:75], v[132:135], v[168:171], v[72:75]
  ds_read_b64_tr_b16 v[128:129], v228 offset:57344
  v_mfma_f32_16x16x32_bf16 v[76:79], v[132:135], v[172:175], v[76:79]
  buffer_load_dwordx4 v241, s[16:19], s50 offen lds
  ds_read_b64_tr_b16 v[130:131], v228 offset:59392
  s_waitcnt lgkmcnt(10)
  v_mfma_f32_16x16x32_bf16 v[80:83], v[136:139], v[168:171], v[80:83]
  ds_read_b64_tr_b16 v[132:133], v229 offset:57344
  v_mfma_f32_16x16x32_bf16 v[84:87], v[136:139], v[172:175], v[84:87]
  ds_read_b64_tr_b16 v[134:135], v229 offset:59392
  s_add_u32 m0, s49, 49152
  v_mfma_f32_16x16x32_bf16 v[88:91], v[140:143], v[168:171], v[88:91]
  ds_read_b64_tr_b16 v[136:137], v230 offset:57344
  v_mfma_f32_16x16x32_bf16 v[92:95], v[140:143], v[172:175], v[92:95]
  buffer_load_dwordx4 v241, s[28:31], s50 offen lds
  ds_read_b64_tr_b16 v[138:139], v230 offset:59392
  s_waitcnt lgkmcnt(10)
  v_mfma_f32_16x16x32_bf16 v[32:35], v[112:115], v[176:179], v[32:35]
  ds_read_b64_tr_b16 v[140:141], v231 offset:57344
  v_mfma_f32_16x16x32_bf16 v[36:39], v[112:115], v[180:183], v[36:39]
  ds_read_b64_tr_b16 v[142:143], v231 offset:59392
  s_add_u32 s50, s87, 524288
  s_add_u32 m0, s49, 53248
  v_mfma_f32_16x16x32_bf16 v[40:43], v[116:119], v[176:179], v[40:43]
  ds_read_b64_tr_b16 v[112:113], v228 offset:61440
  v_mfma_f32_16x16x32_bf16 v[44:47], v[116:119], v[180:183], v[44:47]
  buffer_load_dwordx4 v241, s[16:19], s50 offen lds
  ds_read_b64_tr_b16 v[114:115], v228 offset:63488
  s_waitcnt lgkmcnt(10)
  v_mfma_f32_16x16x32_bf16 v[48:51], v[120:123], v[176:179], v[48:51]
  ds_read_b64_tr_b16 v[116:117], v229 offset:61440
  v_mfma_f32_16x16x32_bf16 v[52:55], v[120:123], v[180:183], v[52:55]
  ds_read_b64_tr_b16 v[118:119], v229 offset:63488
  s_add_u32 m0, s49, 57344
  v_mfma_f32_16x16x32_bf16 v[56:59], v[124:127], v[176:179], v[56:59]
  ds_read_b64_tr_b16 v[120:121], v230 offset:61440
  v_mfma_f32_16x16x32_bf16 v[60:63], v[124:127], v[180:183], v[60:63]
  buffer_load_dwordx4 v241, s[28:31], s50 offen lds
  ds_read_b64_tr_b16 v[122:123], v230 offset:63488
  s_waitcnt lgkmcnt(10)
  v_mfma_f32_16x16x32_bf16 v[64:67], v[128:131], v[176:179], v[64:67]
  ds_read_b64_tr_b16 v[124:125], v231 offset:61440
  v_mfma_f32_16x16x32_bf16 v[68:71], v[128:131], v[180:183], v[68:71]
  ds_read_b64_tr_b16 v[126:127], v231 offset:63488
  s_add_u32 s50, s87, 589824
  s_add_u32 m0, s49, 61440
  v_mfma_f32_16x16x32_bf16 v[72:75], v[132:135], v[176:179], v[72:75]
  ds_read_b64_tr_b16 v[128:129], v224 offset:0
  v_mfma_f32_16x16x32_bf16 v[76:79], v[132:135], v[180:183], v[76:79]
  buffer_load_dwordx4 v241, s[16:19], s50 offen lds
  ds_read_b64_tr_b16 v[130:131], v224 offset:2048
  s_waitcnt lgkmcnt(10)
  v_mfma_f32_16x16x32_bf16 v[80:83], v[136:139], v[176:179], v[80:83]
  ds_read_b64_tr_b16 v[132:133], v225 offset:0
  v_mfma_f32_16x16x32_bf16 v[84:87], v[136:139], v[180:183], v[84:87]
  ds_read_b64_tr_b16 v[134:135], v225 offset:2048
  s_add_u32 m0, s49, 65536
  v_mfma_f32_16x16x32_bf16 v[88:91], v[140:143], v[176:179], v[88:91]
  ds_read_b64_tr_b16 v[136:137], v226 offset:0
  v_mfma_f32_16x16x32_bf16 v[92:95], v[140:143], v[180:183], v[92:95]
  buffer_load_dwordx4 v241, s[28:31], s50 offen lds
  ds_read_b64_tr_b16 v[138:139], v226 offset:2048
  s_waitcnt lgkmcnt(10)
  v_mfma_f32_16x16x32_bf16 v[32:35], v[112:115], v[184:187], v[32:35]
  ds_read_b64_tr_b16 v[140:141], v227 offset:0
  v_mfma_f32_16x16x32_bf16 v[36:39], v[112:115], v[188:191], v[36:39]
  ds_read_b64_tr_b16 v[142:143], v227 offset:2048
  s_add_u32 s50, s87, 655360
  s_add_u32 m0, s49, 69632
  v_mfma_f32_16x16x32_bf16 v[40:43], v[116:119], v[184:187], v[40:43]
  buffer_load_dwordx4 v241, s[16:19], s50 offen lds
  s_waitcnt vmcnt(15)
  s_barrier
  ds_read_b64_tr_b16 v[112:113], v224 offset:4096
  v_mfma_f32_16x16x32_bf16 v[44:47], v[116:119], v[188:191], v[44:47]
  ds_read_b64_tr_b16 v[114:115], v224 offset:6144
  s_waitcnt lgkmcnt(10)
  v_mfma_f32_16x16x32_bf16 v[48:51], v[120:123], v[184:187], v[48:51]
  ds_read_b64_tr_b16 v[116:117], v225 offset:4096
  v_mfma_f32_16x16x32_bf16 v[52:55], v[120:123], v[188:191], v[52:55]
  ds_read_b64_tr_b16 v[118:119], v225 offset:6144
  s_add_u32 m0, s49, 73728
  v_mfma_f32_16x16x32_bf16 v[56:59], v[124:127], v[184:187], v[56:59]
  ds_read_b64_tr_b16 v[120:121], v226 offset:4096
  v_mfma_f32_16x16x32_bf16 v[60:63], v[124:127], v[188:191], v[60:63]
  buffer_load_dwordx4 v241, s[28:31], s50 offen lds
  ds_read_b64_tr_b16 v[122:123], v226 offset:6144
  s_waitcnt lgkmcnt(10)
  v_mfma_f32_16x16x32_bf16 v[64:67], v[128:131], v[184:187], v[64:67]
  ds_read_b64_tr_b16 v[124:125], v227 offset:4096
  v_mfma_f32_16x16x32_bf16 v[68:71], v[128:131], v[188:191], v[68:71]
  ds_read_b64_tr_b16 v[126:127], v227 offset:6144
  s_cmp_eq_u32 s39, 5
  s_cselect_b32 s3, 3670016, 0
  s_sub_u32 s86, s86, s3
  s_sub_u32 s87, s87, s3
  s_add_u32 s50, s86, 917504
  s_add_u32 m0, s49, 77824
  v_mfma_f32_16x16x32_bf16 v[72:75], v[132:135], v[184:187], v[72:75]
  ds_read_b64_tr_b16 v[128:129], v224 offset:8192
  v_mfma_f32_16x16x32_bf16 v[76:79], v[132:135], v[188:191], v[76:79]
  buffer_load_dwordx4 v241, s[16:19], s50 offen lds
  ds_read_b64_tr_b16 v[130:131], v224 offset:10240
  s_waitcnt lgkmcnt(10)
  v_mfma_f32_16x16x32_bf16 v[80:83], v[136:139], v[184:187], v[80:83]
  ds_read_b64_tr_b16 v[132:133], v225 offset:8192
  v_mfma_f32_16x16x32_bf16 v[84:87], v[136:139], v[188:191], v[84:87]
  ds_read_b64_tr_b16 v[134:135], v225 offset:10240
  s_add_u32 m0, s49, 81920
  v_mfma_f32_16x16x32_bf16 v[88:91], v[140:143], v[184:187], v[88:91]
  ds_read_b64_tr_b16 v[136:137], v226 offset:8192
  v_mfma_f32_16x16x32_bf16 v[92:95], v[140:143], v[188:191], v[92:95]
  buffer_load_dwordx4 v241, s[28:31], s50 offen lds
  ds_read_b64_tr_b16 v[138:139], v226 offset:10240
  s_waitcnt lgkmcnt(10)
  v_mfma_f32_16x16x32_bf16 v[32:35], v[112:115], v[192:195], v[32:35]
  ds_read_b64_tr_b16 v[140:141], v227 offset:8192
  v_mfma_f32_16x16x32_bf16 v[36:39], v[112:115], v[196:199], v[36:39]
  ds_read_b64_tr_b16 v[142:143], v227 offset:10240
  s_add_u32 s50, s86, 983040
  s_add_u32 m0, s49, 86016
  v_mfma_f32_16x16x32_bf16 v[40:43], v[116:119], v[192:195], v[40:43]
  ds_read_b64_tr_b16 v[112:113], v224 offset:12288
  v_mfma_f32_16x16x32_bf16 v[44:47], v[116:119], v[196:199], v[44:47]
  buffer_load_dwordx4 v241, s[16:19], s50 offen lds
  ds_read_b64_tr_b16 v[114:115], v224 offset:14336
  s_waitcnt lgkmcnt(10)
  v_mfma_f32_16x16x32_bf16 v[48:51], v[120:123], v[192:195], v[48:51]
  ds_read_b64_tr_b16 v[116:117], v225 offset:12288
  v_mfma_f32_16x16x32_bf16 v[52:55], v[120:123], v[196:199], v[52:55]
  ds_read_b64_tr_b16 v[118:119], v225 offset:14336
  s_add_u32 m0, s49, 90112
  v_mfma_f32_16x16x32_bf16 v[56:59], v[124:127], v[192:195], v[56:59]
  ds_read_b64_tr_b16 v[120:121], v226 offset:12288
  v_mfma_f32_16x16x32_bf16 v[60:63], v[124:127], v[196:199], v[60:63]
  buffer_load_dwordx4 v241, s[28:31], s50 offen lds
  ds_read_b64_tr_b16 v[122:123], v226 offset:14336
  s_waitcnt lgkmcnt(10)
  v_mfma_f32_16x16x32_bf16 v[64:67], v[128:131], v[192:195], v[64:67]
  ds_read_b64_tr_b16 v[124:125], v227 offset:12288
  v_mfma_f32_16x16x32_bf16 v[68:71], v[128:131], v[196:199], v[68:71]
  ds_read_b64_tr_b16 v[126:127], v227 offset:14336
  s_add_u32 s50, s86, 1048576
  s_add_u32 m0, s49, 94208
  v_mfma_f32_16x16x32_bf16 v[72:75], v[132:135], v[192:195], v[72:75]
  ds_read_b64_tr_b16 v[128:129], v224 offset:16384
  v_mfma_f32_16x16x32_bf16 v[76:79], v[132:135], v[196:199], v[76:79]
  buffer_load_dwordx4 v241, s[16:19], s50 offen lds
  ds_read_b64_tr_b16 v[130:131], v224 offset:18432
  s_waitcnt lgkmcnt(10)
  v_mfma_f32_16x16x32_bf16 v[80:83], v[136:139], v[192:195], v[80:83]
  ds_read_b64_tr_b16 v[132:133], v225 offset:16384
  v_mfma_f32_16x16x32_bf16 v[84:87], v[136:139], v[196:199], v[84:87]
  ds_read_b64_tr_b16 v[134:135], v225 offset:18432
  s_add_u32 m0, s49, 98304
  v_mfma_f32_16x16x32_bf16 v[88:91], v[140:143], v[192:195], v[88:91]
  ds_read_b64_tr_b16 v[136:137], v226 offset:16384
  v_mfma_f32_16x16x32_bf16 v[92:95], v[140:143], v[196:199], v[92:95]
  buffer_load_dwordx4 v241, s[28:31], s50 offen lds
  ds_read_b64_tr_b16 v[138:139], v226 offset:18432
  s_waitcnt lgkmcnt(10)
  v_mfma_f32_16x16x32_bf16 v[32:35], v[112:115], a[0:3], v[32:35]
  ds_read_b64_tr_b16 v[140:141], v227 offset:16384
  v_mfma_f32_16x16x32_bf16 v[36:39], v[112:115], a[4:7], v[36:39]
  ds_read_b64_tr_b16 v[142:143], v227 offset:18432
  s_add_u32 s50, s86, 1114112
  s_add_u32 m0, s49, 102400
  v_mfma_f32_16x16x32_bf16 v[40:43], v[116:119], a[0:3], v[40:43]
  buffer_load_dwordx4 v241, s[16:19], s50 offen lds
  s_waitcnt vmcnt(17)
  s_barrier
  ds_read_b64_tr_b16 v[112:113], v224 offset:20480
  v_mfma_f32_16x16x32_bf16 v[44:47], v[116:119], a[4:7], v[44:47]
  ds_read_b64_tr_b16 v[114:115], v224 offset:22528
  s_waitcnt lgkmcnt(10)
  v_mfma_f32_16x16x32_bf16 v[48:51], v[120:123], a[0:3], v[48:51]
  ds_read_b64_tr_b16 v[116:117], v225 offset:20480
  v_mfma_f32_16x16x32_bf16 v[52:55], v[120:123], a[4:7], v[52:55]
  ds_read_b64_tr_b16 v[118:119], v225 offset:22528
  s_add_u32 m0, s49, 106496
  v_mfma_f32_16x16x32_bf16 v[56:59], v[124:127], a[0:3], v[56:59]
  ds_read_b64_tr_b16 v[120:121], v226 offset:20480
  v_mfma_f32_16x16x32_bf16 v[60:63], v[124:127], a[4:7], v[60:63]
  buffer_load_dwordx4 v241, s[28:31], s50 offen lds
  ds_read_b64_tr_b16 v[122:123], v226 offset:22528
  s_waitcnt lgkmcnt(10)
  v_mfma_f32_16x16x32_bf16 v[64:67], v[128:131], a[0:3], v[64:67]
  ds_read_b64_tr_b16 v[124:125], v227 offset:20480
  v_mfma_f32_16x16x32_bf16 v[68:71], v[128:131], a[4:7], v[68:71]
  ds_read_b64_tr_b16 v[126:127], v227 offset:22528
  v_mfma_f32_16x16x32_bf16 v[72:75], v[132:135], a[0:3], v[72:75]
  ds_read_b64_tr_b16 v[128:129], v224 offset:24576
  v_mfma_f32_16x16x32_bf16 v[76:79], v[132:135], a[4:7], v[76:79]
  buffer_load_dwordx4 a[88:91], v251, s[4:7], s51 offen offset:2048 sc1
  ds_read_b64_tr_b16 v[130:131], v224 offset:26624
  s_waitcnt lgkmcnt(10)
  v_mfma_f32_16x16x32_bf16 v[80:83], v[136:139], a[0:3], v[80:83]
  ds_read_b64_tr_b16 v[132:133], v225 offset:24576
  v_mfma_f32_16x16x32_bf16 v[84:87], v[136:139], a[4:7], v[84:87]
  ds_read_b64_tr_b16 v[134:135], v225 offset:26624
  v_mfma_f32_16x16x32_bf16 v[88:91], v[140:143], a[0:3], v[88:91]
  ds_read_b64_tr_b16 v[136:137], v226 offset:24576
  v_mfma_f32_16x16x32_bf16 v[92:95], v[140:143], a[4:7], v[92:95]
  buffer_load_dwordx4 a[92:95], v251, s[4:7], s51 offen offset:3072 sc1
  ds_read_b64_tr_b16 v[138:139], v226 offset:26624
  s_waitcnt lgkmcnt(10)
  v_mfma_f32_16x16x32_bf16 v[32:35], v[112:115], a[8:11], v[32:35]
  ds_read_b64_tr_b16 v[140:141], v227 offset:24576
  v_mfma_f32_16x16x32_bf16 v[36:39], v[112:115], a[12:15], v[36:39]
  ds_read_b64_tr_b16 v[142:143], v227 offset:26624
  v_mfma_f32_16x16x32_bf16 v[40:43], v[116:119], a[8:11], v[40:43]
  ds_read_b64_tr_b16 v[112:113], v224 offset:28672
  v_mfma_f32_16x16x32_bf16 v[44:47], v[116:119], a[12:15], v[44:47]
  ds_read_b64_tr_b16 v[114:115], v224 offset:30720
  s_add_u32 s54, s54, 16384
  s_barrier
  s_cmp_lg_u32 s36, 3
  s_cbranch_scc1 sequential_preLN__spectral_fnet__dense_activation_squared_relu__prompt_kernel_sig18
  v_mov_b32 v96, s42
  v_mov_b32 v97, s43
  v_mov_b32 v98, 0
  v_mov_b32 v99, 0
  s_mov_b64 exec, 15
  buffer_store_dwordx4 v[96:99], v251, s[8:11], s54 offen sc1
  s_mov_b64 exec, -1
sequential_preLN__spectral_fnet__dense_activation_squared_relu__prompt_kernel_sig18:
  s_waitcnt lgkmcnt(10)
  v_mfma_f32_16x16x32_bf16 v[48:51], v[120:123], a[8:11], v[48:51]
  ds_read_b64_tr_b16 v[116:117], v225 offset:28672
  v_mfma_f32_16x16x32_bf16 v[52:55], v[120:123], a[12:15], v[52:55]
  ds_read_b64_tr_b16 v[118:119], v225 offset:30720
  s_cmp_eq_u32 s39, 4
  s_cselect_b32 s3, 3670016, 0
  s_sub_u32 s86, s86, s3
  s_sub_u32 s87, s87, s3
  s_add_u32 s50, s87, 1376256
  s_add_u32 m0, s49, 110592
  v_mfma_f32_16x16x32_bf16 v[56:59], v[124:127], a[8:11], v[56:59]
  ds_read_b64_tr_b16 v[120:121], v226 offset:28672
  v_mfma_f32_16x16x32_bf16 v[60:63], v[124:127], a[12:15], v[60:63]
  buffer_load_dwordx4 v241, s[16:19], s50 offen lds
  ds_read_b64_tr_b16 v[122:123], v226 offset:30720
  s_waitcnt lgkmcnt(10)
  v_mfma_f32_16x16x32_bf16 v[64:67], v[128:131], a[8:11], v[64:67]
  ds_read_b64_tr_b16 v[124:125], v227 offset:28672
  v_mfma_f32_16x16x32_bf16 v[68:71], v[128:131], a[12:15], v[68:71]
  ds_read_b64_tr_b16 v[126:127], v227 offset:30720
  v_mfma_f32_16x16x32_bf16 v[72:75], v[132:135], a[8:11], v[72:75]
  ds_read_b64_tr_b16 v[128:129], v224 offset:32768
  v_mfma_f32_16x16x32_bf16 v[76:79], v[132:135], a[12:15], v[76:79]
  ds_read_b64_tr_b16 v[130:131], v224 offset:34816
  s_mov_b32 s24, s94
  s_and_b32 s25, s95, 0xffff
  s_mov_b32 s26, 2048
  s_mov_b32 s27, 0x20000
  s_mov_b32 s20, s96
  s_and_b32 s21, s97, 0xffff
  s_mov_b32 s22, 4194304
  s_mov_b32 s23, 0x20000
  s_add_u32 s32, s100, 27262976
  s_addc_u32 s33, s101, 0
  s_and_b32 s33, s33, 0xffff
  s_mov_b32 s34, 8388608
  s_mov_b32 s35, 0x20000
  s_lshl_b32 s57, s39, 1
  s_add_u32 s57, s57, s38
  s_sub_u32 s3, 23, s57
  s_cmp_ge_u32 s57, 8
  s_cselect_b32 s3, s3, s57
  s_cselect_b32 s48, 3, 0
  s_lshl_b32 s3, s3, 12
  s_lshl_b32 s44, s40, 16
  s_add_u32 s44, s44, 6291456
  s_add_u32 s44, s44, s3
  v_xor_b32 v108, s48, v250
  v_lshlrev_b32 v108, 8, v108
  v_lshl_add_u32 v108, v249, 4, v108
  v_sub_u32 v109, 0, v250
  v_and_b32 v109, 3, v109
  v_lshlrev_b32 v109, 8, v109
  v_lshl_add_u32 v109, v249, 4, v109
  v_cmp_eq_u32 vcc, 0, v250
  v_add_u32 v110, 8, v109
  v_add_u32 v111, 2040, v109
  v_cndmask_b32 v110, v109, v110, vcc
  v_cndmask_b32 v109, v109, v111, vcc
  s_cmp_eq_u32 s57, 8
  s_cselect_b32 s3, 0xffff8000, 0
  v_mov_b32 v111, s3
  v_cndmask_b32 v111, 0, v111, vcc
  v_add_u32 v111, v111, v109
  v_add_u32 v111, 61440, v111
  s_sub_u32 s59, s44, 61440
  s_lshl_b32 s45, s57, 7
  v_mov_b32 v145, 0x3f803f80
  v_cndmask_b32 v145, 0, v145, vcc
  v_mov_b32 v147, v145
  v_mov_b32 v149, v145
  v_mov_b32 v151, v145
  s_lshl_b32 s12, s36, 9
  s_add_u32 s12, s12, s37
  s_lshl_b32 s12, s12, 11
  s_add_u32 s12, s12, s45
  s_add_u32 s13, s12, 524288
  v_lshlrev_b32 v244, 15, v249
  v_and_b32 v100, 1, v250
  v_lshl_add_u32 v244, v100, 5, v244
  v_lshrrev_b32 v100, 1, v250
  v_lshl_add_u32 v244, v100, 4, v244
  s_lshl_b32 s3, s2, 2
  s_add_u32 s3, s3, s36
  s_lshl_b32 s14, s3, 12
  s_xor_b32 s15, s14, 16384
  s_lshl_b32 s52, s3, 6
  s_add_u32 s52, s52, 4276224
  s_xor_b32 s58, s52, 256
  v_mov_b32 v100, 0
  s_waitcnt lgkmcnt(10)
  v_mfma_f32_16x16x32_bf16 v[80:83], v[136:139], a[8:11], v[80:83]
  ds_read_b64_tr_b16 v[132:133], v225 offset:32768
  v_mfma_f32_16x16x32_bf16 v[84:87], v[136:139], a[12:15], v[84:87]
  ds_read_b64_tr_b16 v[134:135], v225 offset:34816
  s_add_u32 m0, s49, 114688
  v_mfma_f32_16x16x32_bf16 v[88:91], v[140:143], a[8:11], v[88:91]
  ds_read_b64_tr_b16 v[136:137], v226 offset:32768
  v_mfma_f32_16x16x32_bf16 v[92:95], v[140:143], a[12:15], v[92:95]
  buffer_load_dwordx4 v241, s[28:31], s50 offen lds
  ds_read_b64_tr_b16 v[138:139], v226 offset:34816
  s_waitcnt lgkmcnt(10)
  v_mfma_f32_16x16x32_bf16 v[32:35], v[112:115], a[16:19], v[32:35]
  ds_read_b64_tr_b16 v[140:141], v227 offset:32768
  v_mfma_f32_16x16x32_bf16 v[36:39], v[112:115], a[20:23], v[36:39]
  ds_read_b64_tr_b16 v[142:143], v227 offset:34816
  s_cmp_eq_u32 s39, 4
  s_cselect_b32 s3, 114688, 0
  s_sub_u32 s46, s46, s3
  s_add_u32 s51, s46, 43008
  v_mfma_f32_16x16x32_bf16 v[40:43], v[116:119], a[16:19], v[40:43]
  buffer_load_dwordx4 a[96:99], v251, s[4:7], s51 offen offset:0 sc1
  s_waitcnt vmcnt(19)
  s_barrier
  ds_read_b64_tr_b16 v[112:113], v224 offset:36864
  v_mfma_f32_16x16x32_bf16 v[44:47], v[116:119], a[20:23], v[44:47]
  ds_read_b64_tr_b16 v[114:115], v224 offset:38912
  s_waitcnt lgkmcnt(10)
  v_mfma_f32_16x16x32_bf16 v[48:51], v[120:123], a[16:19], v[48:51]
  ds_read_b64_tr_b16 v[116:117], v225 offset:36864
  v_mfma_f32_16x16x32_bf16 v[52:55], v[120:123], a[20:23], v[52:55]
  ds_read_b64_tr_b16 v[118:119], v225 offset:38912
  v_mfma_f32_16x16x32_bf16 v[56:59], v[124:127], a[16:19], v[56:59]
  ds_read_b64_tr_b16 v[120:121], v226 offset:36864
  v_mfma_f32_16x16x32_bf16 v[60:63], v[124:127], a[20:23], v[60:63]
  buffer_load_dwordx4 a[100:103], v251, s[4:7], s51 offen offset:1024 sc1
  ds_read_b64_tr_b16 v[122:123], v226 offset:38912
  s_waitcnt lgkmcnt(10)
  v_mfma_f32_16x16x32_bf16 v[64:67], v[128:131], a[16:19], v[64:67]
  ds_read_b64_tr_b16 v[124:125], v227 offset:36864
  v_mfma_f32_16x16x32_bf16 v[68:71], v[128:131], a[20:23], v[68:71]
  ds_read_b64_tr_b16 v[126:127], v227 offset:38912
  s_add_u32 s50, s87, 1441792
  s_add_u32 m0, s49, 118784
  v_mfma_f32_16x16x32_bf16 v[72:75], v[132:135], a[16:19], v[72:75]
  ds_read_b64_tr_b16 v[128:129], v224 offset:40960
  v_mfma_f32_16x16x32_bf16 v[76:79], v[132:135], a[20:23], v[76:79]
  buffer_load_dwordx4 v241, s[16:19], s50 offen lds
  ds_read_b64_tr_b16 v[130:131], v224 offset:43008
  s_waitcnt lgkmcnt(10)
  v_mfma_f32_16x16x32_bf16 v[80:83], v[136:139], a[16:19], v[80:83]
  ds_read_b64_tr_b16 v[132:133], v225 offset:40960
  v_mfma_f32_16x16x32_bf16 v[84:87], v[136:139], a[20:23], v[84:87]
  ds_read_b64_tr_b16 v[134:135], v225 offset:43008
  s_add_u32 m0, s49, 122880
  v_mfma_f32_16x16x32_bf16 v[88:91], v[140:143], a[16:19], v[88:91]
  ds_read_b64_tr_b16 v[136:137], v226 offset:40960
  v_mfma_f32_16x16x32_bf16 v[92:95], v[140:143], a[20:23], v[92:95]
  buffer_load_dwordx4 v241, s[28:31], s50 offen lds
  ds_read_b64_tr_b16 v[138:139], v226 offset:43008
  s_waitcnt lgkmcnt(10)
  v_mfma_f32_16x16x32_bf16 v[32:35], v[112:115], a[24:27], v[32:35]
  ds_read_b64_tr_b16 v[140:141], v227 offset:40960
  v_mfma_f32_16x16x32_bf16 v[36:39], v[112:115], a[28:31], v[36:39]
  ds_read_b64_tr_b16 v[142:143], v227 offset:43008
  v_mfma_f32_16x16x32_bf16 v[40:43], v[116:119], a[24:27], v[40:43]
  ds_read_b64_tr_b16 v[112:113], v224 offset:45056
  v_mfma_f32_16x16x32_bf16 v[44:47], v[116:119], a[28:31], v[44:47]
  buffer_load_dwordx4 a[104:107], v251, s[4:7], s51 offen offset:2048 sc1
  ds_read_b64_tr_b16 v[114:115], v224 offset:47104
  s_waitcnt lgkmcnt(10)
  v_mfma_f32_16x16x32_bf16 v[48:51], v[120:123], a[24:27], v[48:51]
  ds_read_b64_tr_b16 v[116:117], v225 offset:45056
  v_mfma_f32_16x16x32_bf16 v[52:55], v[120:123], a[28:31], v[52:55]
  ds_read_b64_tr_b16 v[118:119], v225 offset:47104
  v_mfma_f32_16x16x32_bf16 v[56:59], v[124:127], a[24:27], v[56:59]
  ds_read_b64_tr_b16 v[120:121], v226 offset:45056
  v_mfma_f32_16x16x32_bf16 v[60:63], v[124:127], a[28:31], v[60:63]
  buffer_load_dwordx4 a[108:111], v251, s[4:7], s51 offen offset:3072 sc1
  ds_read_b64_tr_b16 v[122:123], v226 offset:47104
  s_waitcnt lgkmcnt(10)
  v_mfma_f32_16x16x32_bf16 v[64:67], v[128:131], a[24:27], v[64:67]
  ds_read_b64_tr_b16 v[124:125], v227 offset:45056
  v_mfma_f32_16x16x32_bf16 v[68:71], v[128:131], a[28:31], v[68:71]
  ds_read_b64_tr_b16 v[126:127], v227 offset:47104
  s_add_u32 s50, s87, 1507328
  s_add_u32 m0, s49, 126976
  v_mfma_f32_16x16x32_bf16 v[72:75], v[132:135], a[24:27], v[72:75]
  ds_read_b64_tr_b16 v[128:129], v224 offset:49152
  v_mfma_f32_16x16x32_bf16 v[76:79], v[132:135], a[28:31], v[76:79]
  buffer_load_dwordx4 v241, s[16:19], s50 offen lds
  ds_read_b64_tr_b16 v[130:131], v224 offset:51200
  s_waitcnt lgkmcnt(10)
  v_mfma_f32_16x16x32_bf16 v[80:83], v[136:139], a[24:27], v[80:83]
  ds_read_b64_tr_b16 v[132:133], v225 offset:49152
  v_mfma_f32_16x16x32_bf16 v[84:87], v[136:139], a[28:31], v[84:87]
  ds_read_b64_tr_b16 v[134:135], v225 offset:51200
  s_add_u32 m0, s49, 0
  v_mfma_f32_16x16x32_bf16 v[88:91], v[140:143], a[24:27], v[88:91]
  ds_read_b64_tr_b16 v[136:137], v226 offset:49152
  v_mfma_f32_16x16x32_bf16 v[92:95], v[140:143], a[28:31], v[92:95]
  buffer_load_dwordx4 v241, s[28:31], s50 offen lds
  ds_read_b64_tr_b16 v[138:139], v226 offset:51200
  s_waitcnt lgkmcnt(10)
  v_mfma_f32_16x16x32_bf16 v[32:35], v[112:115], a[32:35], v[32:35]
  ds_read_b64_tr_b16 v[140:141], v227 offset:49152
  v_mfma_f32_16x16x32_bf16 v[36:39], v[112:115], a[36:39], v[36:39]
  ds_read_b64_tr_b16 v[142:143], v227 offset:51200
  s_add_u32 s51, s46, 47104
  v_mfma_f32_16x16x32_bf16 v[40:43], v[116:119], a[32:35], v[40:43]
  buffer_load_dwordx4 a[112:115], v251, s[4:7], s51 offen offset:0 sc1
  s_waitcnt vmcnt(23)
  s_barrier
  ds_read_b64_tr_b16 v[112:113], v224 offset:53248
  v_mfma_f32_16x16x32_bf16 v[44:47], v[116:119], a[36:39], v[44:47]
  ds_read_b64_tr_b16 v[114:115], v224 offset:55296
  s_waitcnt lgkmcnt(10)
  v_mfma_f32_16x16x32_bf16 v[48:51], v[120:123], a[32:35], v[48:51]
  ds_read_b64_tr_b16 v[116:117], v225 offset:53248
  v_mfma_f32_16x16x32_bf16 v[52:55], v[120:123], a[36:39], v[52:55]
  ds_read_b64_tr_b16 v[118:119], v225 offset:55296
  v_mfma_f32_16x16x32_bf16 v[56:59], v[124:127], a[32:35], v[56:59]
  ds_read_b64_tr_b16 v[120:121], v226 offset:53248
  v_mfma_f32_16x16x32_bf16 v[60:63], v[124:127], a[36:39], v[60:63]
  buffer_load_dwordx4 a[116:119], v251, s[4:7], s51 offen offset:1024 sc1
  ds_read_b64_tr_b16 v[122:123], v226 offset:55296
  s_waitcnt lgkmcnt(10)
  v_mfma_f32_16x16x32_bf16 v[64:67], v[128:131], a[32:35], v[64:67]
  ds_read_b64_tr_b16 v[124:125], v227 offset:53248
  v_mfma_f32_16x16x32_bf16 v[68:71], v[128:131], a[36:39], v[68:71]
  ds_read_b64_tr_b16 v[126:127], v227 offset:55296
  s_add_u32 s50, s87, 1572864
  s_add_u32 m0, s49, 4096
  v_mfma_f32_16x16x32_bf16 v[72:75], v[132:135], a[32:35], v[72:75]
  ds_read_b64_tr_b16 v[128:129], v224 offset:57344
  v_mfma_f32_16x16x32_bf16 v[76:79], v[132:135], a[36:39], v[76:79]
  buffer_load_dwordx4 v241, s[16:19], s50 offen lds
  ds_read_b64_tr_b16 v[130:131], v224 offset:59392
  s_waitcnt lgkmcnt(10)
  v_mfma_f32_16x16x32_bf16 v[80:83], v[136:139], a[32:35], v[80:83]
  ds_read_b64_tr_b16 v[132:133], v225 offset:57344
  v_mfma_f32_16x16x32_bf16 v[84:87], v[136:139], a[36:39], v[84:87]
  ds_read_b64_tr_b16 v[134:135], v225 offset:59392
  s_add_u32 m0, s49, 8192
  v_mfma_f32_16x16x32_bf16 v[88:91], v[140:143], a[32:35], v[88:91]
  ds_read_b64_tr_b16 v[136:137], v226 offset:57344
  v_mfma_f32_16x16x32_bf16 v[92:95], v[140:143], a[36:39], v[92:95]
  buffer_load_dwordx4 v241, s[28:31], s50 offen lds
  ds_read_b64_tr_b16 v[138:139], v226 offset:59392
  s_waitcnt lgkmcnt(10)
  v_mfma_f32_16x16x32_bf16 v[32:35], v[112:115], a[40:43], v[32:35]
  ds_read_b64_tr_b16 v[140:141], v227 offset:57344
  v_mfma_f32_16x16x32_bf16 v[36:39], v[112:115], a[44:47], v[36:39]
  ds_read_b64_tr_b16 v[142:143], v227 offset:59392
  v_mfma_f32_16x16x32_bf16 v[40:43], v[116:119], a[40:43], v[40:43]
  ds_read_b64_tr_b16 v[112:113], v224 offset:61440
  v_mfma_f32_16x16x32_bf16 v[44:47], v[116:119], a[44:47], v[44:47]
  buffer_load_dwordx4 a[120:123], v251, s[4:7], s51 offen offset:2048 sc1
  ds_read_b64_tr_b16 v[114:115], v224 offset:63488
  s_waitcnt lgkmcnt(10)
  v_mfma_f32_16x16x32_bf16 v[48:51], v[120:123], a[40:43], v[48:51]
  ds_read_b64_tr_b16 v[116:117], v225 offset:61440
  v_mfma_f32_16x16x32_bf16 v[52:55], v[120:123], a[44:47], v[52:55]
  ds_read_b64_tr_b16 v[118:119], v225 offset:63488
  v_mfma_f32_16x16x32_bf16 v[56:59], v[124:127], a[40:43], v[56:59]
  ds_read_b64_tr_b16 v[120:121], v226 offset:61440
  v_mfma_f32_16x16x32_bf16 v[60:63], v[124:127], a[44:47], v[60:63]
  buffer_load_dwordx4 a[124:127], v251, s[4:7], s51 offen offset:3072 sc1
  ds_read_b64_tr_b16 v[122:123], v226 offset:63488
  s_waitcnt lgkmcnt(10)
  v_mfma_f32_16x16x32_bf16 v[64:67], v[128:131], a[40:43], v[64:67]
  ds_read_b64_tr_b16 v[124:125], v227 offset:61440
  v_mfma_f32_16x16x32_bf16 v[68:71], v[128:131], a[44:47], v[68:71]
  ds_read_b64_tr_b16 v[126:127], v227 offset:63488
  s_cmp_eq_u32 s39, 3
  s_cselect_b32 s3, 3670016, 0
  s_sub_u32 s86, s86, s3
  s_sub_u32 s87, s87, s3
  s_add_u32 s50, s86, 1835008
  s_add_u32 m0, s49, 12288
  v_mfma_f32_16x16x32_bf16 v[72:75], v[132:135], a[40:43], v[72:75]
  ds_read_b64_tr_b16 v[128:129], v228 offset:0
  v_mfma_f32_16x16x32_bf16 v[76:79], v[132:135], a[44:47], v[76:79]
  buffer_load_dwordx4 v241, s[16:19], s50 offen lds
  ds_read_b64_tr_b16 v[130:131], v228 offset:2048
  s_waitcnt lgkmcnt(10)
  v_mfma_f32_16x16x32_bf16 v[80:83], v[136:139], a[40:43], v[80:83]
  ds_read_b64_tr_b16 v[132:133], v229 offset:0
  v_mfma_f32_16x16x32_bf16 v[84:87], v[136:139], a[44:47], v[84:87]
  ds_read_b64_tr_b16 v[134:135], v229 offset:2048
  s_add_u32 m0, s49, 16384
  v_mfma_f32_16x16x32_bf16 v[88:91], v[140:143], a[40:43], v[88:91]
  ds_read_b64_tr_b16 v[136:137], v230 offset:0
  v_mfma_f32_16x16x32_bf16 v[92:95], v[140:143], a[44:47], v[92:95]
  buffer_load_dwordx4 v241, s[28:31], s50 offen lds
  ds_read_b64_tr_b16 v[138:139], v230 offset:2048
  s_waitcnt lgkmcnt(10)
  v_mfma_f32_16x16x32_bf16 v[32:35], v[112:115], a[48:51], v[32:35]
  ds_read_b64_tr_b16 v[140:141], v231 offset:0
  v_mfma_f32_16x16x32_bf16 v[36:39], v[112:115], a[52:55], v[36:39]
  ds_read_b64_tr_b16 v[142:143], v231 offset:2048
  s_cmp_eq_u32 s39, 3
  s_cselect_b32 s3, 114688, 0
  s_sub_u32 s46, s46, s3
  s_add_u32 s51, s46, 57344
  v_mfma_f32_16x16x32_bf16 v[40:43], v[116:119], a[48:51], v[40:43]
  buffer_load_dwordx4 a[128:131], v251, s[4:7], s51 offen offset:0 sc1
  s_waitcnt vmcnt(27)
  s_barrier
  ds_read_b64_tr_b16 v[112:113], v228 offset:4096
  v_mfma_f32_16x16x32_bf16 v[44:47], v[116:119], a[52:55], v[44:47]
  ds_read_b64_tr_b16 v[114:115], v228 offset:6144
  s_waitcnt lgkmcnt(10)
  v_mfma_f32_16x16x32_bf16 v[48:51], v[120:123], a[48:51], v[48:51]
  ds_read_b64_tr_b16 v[116:117], v229 offset:4096
  v_mfma_f32_16x16x32_bf16 v[52:55], v[120:123], a[52:55], v[52:55]
  ds_read_b64_tr_b16 v[118:119], v229 offset:6144
  v_mfma_f32_16x16x32_bf16 v[56:59], v[124:127], a[48:51], v[56:59]
  ds_read_b64_tr_b16 v[120:121], v230 offset:4096
  v_mfma_f32_16x16x32_bf16 v[60:63], v[124:127], a[52:55], v[60:63]
  buffer_load_dwordx4 a[132:135], v251, s[4:7], s51 offen offset:1024 sc1
  ds_read_b64_tr_b16 v[122:123], v230 offset:6144
  s_waitcnt lgkmcnt(10)
  v_mfma_f32_16x16x32_bf16 v[64:67], v[128:131], a[48:51], v[64:67]
  ds_read_b64_tr_b16 v[124:125], v231 offset:4096
  v_mfma_f32_16x16x32_bf16 v[68:71], v[128:131], a[52:55], v[68:71]
  ds_read_b64_tr_b16 v[126:127], v231 offset:6144
  s_add_u32 s50, s86, 1900544
  s_add_u32 m0, s49, 20480
  v_mfma_f32_16x16x32_bf16 v[72:75], v[132:135], a[48:51], v[72:75]
  ds_read_b64_tr_b16 v[128:129], v228 offset:8192
  v_mfma_f32_16x16x32_bf16 v[76:79], v[132:135], a[52:55], v[76:79]
  buffer_load_dwordx4 v241, s[16:19], s50 offen lds
  ds_read_b64_tr_b16 v[130:131], v228 offset:10240
  s_waitcnt lgkmcnt(10)
  v_mfma_f32_16x16x32_bf16 v[80:83], v[136:139], a[48:51], v[80:83]
  ds_read_b64_tr_b16 v[132:133], v229 offset:8192
  v_mfma_f32_16x16x32_bf16 v[84:87], v[136:139], a[52:55], v[84:87]
  ds_read_b64_tr_b16 v[134:135], v229 offset:10240
  v_mfma_f32_16x16x32_bf16 v[88:91], v[140:143], a[48:51], v[88:91]
  ds_read_b64_tr_b16 v[136:137], v230 offset:8192
  v_mfma_f32_16x16x32_bf16 v[92:95], v[140:143], a[52:55], v[92:95]
  ds_read_b64_tr_b16 v[138:139], v230 offset:10240
  s_add_u32 s55, s55, 16384
  buffer_load_dwordx2 v[96:97], v239, s[8:11], s55 offen sc1
  s_waitcnt lgkmcnt(10)
  v_mfma_f32_16x16x32_bf16 v[32:35], v[112:115], a[56:59], v[32:35]
  ds_read_b64_tr_b16 v[140:141], v231 offset:8192
  v_mfma_f32_16x16x32_bf16 v[36:39], v[112:115], a[60:63], v[36:39]
  ds_read_b64_tr_b16 v[142:143], v231 offset:10240
  s_add_u32 m0, s49, 24576
  v_mfma_f32_16x16x32_bf16 v[40:43], v[116:119], a[56:59], v[40:43]
  ds_read_b64_tr_b16 v[112:113], v228 offset:12288
  v_mfma_f32_16x16x32_bf16 v[44:47], v[116:119], a[60:63], v[44:47]
  buffer_load_dwordx4 v241, s[28:31], s50 offen lds
  ds_read_b64_tr_b16 v[114:115], v228 offset:14336
  s_waitcnt lgkmcnt(10)
  v_mfma_f32_16x16x32_bf16 v[48:51], v[120:123], a[56:59], v[48:51]
  ds_read_b64_tr_b16 v[116:117], v229 offset:12288
  v_mfma_f32_16x16x32_bf16 v[52:55], v[120:123], a[60:63], v[52:55]
  ds_read_b64_tr_b16 v[118:119], v229 offset:14336
  v_mfma_f32_16x16x32_bf16 v[56:59], v[124:127], a[56:59], v[56:59]
  ds_read_b64_tr_b16 v[120:121], v230 offset:12288
  v_mfma_f32_16x16x32_bf16 v[60:63], v[124:127], a[60:63], v[60:63]
  buffer_load_dwordx4 a[136:139], v251, s[4:7], s51 offen offset:2048 sc1
  ds_read_b64_tr_b16 v[122:123], v230 offset:14336
  s_waitcnt lgkmcnt(10)
  v_mfma_f32_16x16x32_bf16 v[64:67], v[128:131], a[56:59], v[64:67]
  ds_read_b64_tr_b16 v[124:125], v231 offset:12288
  v_mfma_f32_16x16x32_bf16 v[68:71], v[128:131], a[60:63], v[68:71]
  ds_read_b64_tr_b16 v[126:127], v231 offset:14336
  v_mfma_f32_16x16x32_bf16 v[72:75], v[132:135], a[56:59], v[72:75]
  ds_read_b64_tr_b16 v[128:129], v228 offset:16384
  v_mfma_f32_16x16x32_bf16 v[76:79], v[132:135], a[60:63], v[76:79]
  buffer_load_dwordx4 a[140:143], v251, s[4:7], s51 offen offset:3072 sc1
  ds_read_b64_tr_b16 v[130:131], v228 offset:18432
  s_waitcnt lgkmcnt(10)
  v_mfma_f32_16x16x32_bf16 v[80:83], v[136:139], a[56:59], v[80:83]
  ds_read_b64_tr_b16 v[132:133], v229 offset:16384
  v_mfma_f32_16x16x32_bf16 v[84:87], v[136:139], a[60:63], v[84:87]
  ds_read_b64_tr_b16 v[134:135], v229 offset:18432
  s_add_u32 s50, s86, 1966080
  s_add_u32 m0, s49, 28672
  v_mfma_f32_16x16x32_bf16 v[88:91], v[140:143], a[56:59], v[88:91]
  ds_read_b64_tr_b16 v[136:137], v230 offset:16384
  v_mfma_f32_16x16x32_bf16 v[92:95], v[140:143], a[60:63], v[92:95]
  buffer_load_dwordx4 v241, s[16:19], s50 offen lds
  ds_read_b64_tr_b16 v[138:139], v230 offset:18432
  s_waitcnt lgkmcnt(10)
  v_mfma_f32_16x16x32_bf16 v[32:35], v[112:115], a[64:67], v[32:35]
  ds_read_b64_tr_b16 v[140:141], v231 offset:16384
  v_mfma_f32_16x16x32_bf16 v[36:39], v[112:115], a[68:71], v[36:39]
  ds_read_b64_tr_b16 v[142:143], v231 offset:18432
  s_add_u32 m0, s49, 32768
  v_mfma_f32_16x16x32_bf16 v[40:43], v[116:119], a[64:67], v[40:43]
  buffer_load_dwordx4 v241, s[28:31], s50 offen lds
  s_waitcnt vmcnt(31)
  s_barrier
  ds_read_b64_tr_b16 v[112:113], v228 offset:20480
  v_mfma_f32_16x16x32_bf16 v[44:47], v[116:119], a[68:71], v[44:47]
  ds_read_b64_tr_b16 v[114:115], v228 offset:22528
  s_waitcnt lgkmcnt(10)
  v_mfma_f32_16x16x32_bf16 v[48:51], v[120:123], a[64:67], v[48:51]
  ds_read_b64_tr_b16 v[116:117], v229 offset:20480
  v_mfma_f32_16x16x32_bf16 v[52:55], v[120:123], a[68:71], v[52:55]
  ds_read_b64_tr_b16 v[118:119], v229 offset:22528
  s_add_u32 s51, s46, 61440
  v_mfma_f32_16x16x32_bf16 v[56:59], v[124:127], a[64:67], v[56:59]
  ds_read_b64_tr_b16 v[120:121], v230 offset:20480
  v_mfma_f32_16x16x32_bf16 v[60:63], v[124:127], a[68:71], v[60:63]
  buffer_load_dwordx4 a[144:147], v251, s[4:7], s51 offen offset:0 sc1
  ds_read_b64_tr_b16 v[122:123], v230 offset:22528
  s_waitcnt lgkmcnt(10)
  v_mfma_f32_16x16x32_bf16 v[64:67], v[128:131], a[64:67], v[64:67]
  ds_read_b64_tr_b16 v[124:125], v231 offset:20480
  v_mfma_f32_16x16x32_bf16 v[68:71], v[128:131], a[68:71], v[68:71]
  ds_read_b64_tr_b16 v[126:127], v231 offset:22528
  v_mfma_f32_16x16x32_bf16 v[72:75], v[132:135], a[64:67], v[72:75]
  ds_read_b64_tr_b16 v[128:129], v228 offset:24576
  v_mfma_f32_16x16x32_bf16 v[76:79], v[132:135], a[68:71], v[76:79]
  buffer_load_dwordx4 a[148:151], v251, s[4:7], s51 offen offset:1024 sc1
  ds_read_b64_tr_b16 v[130:131], v228 offset:26624
  s_waitcnt lgkmcnt(10)
  v_mfma_f32_16x16x32_bf16 v[80:83], v[136:139], a[64:67], v[80:83]
  ds_read_b64_tr_b16 v[132:133], v229 offset:24576
  v_mfma_f32_16x16x32_bf16 v[84:87], v[136:139], a[68:71], v[84:87]
  ds_read_b64_tr_b16 v[134:135], v229 offset:26624
  s_add_u32 s50, s86, 2031616
  s_add_u32 m0, s49, 36864
  v_mfma_f32_16x16x32_bf16 v[88:91], v[140:143], a[64:67], v[88:91]
  ds_read_b64_tr_b16 v[136:137], v230 offset:24576
  v_mfma_f32_16x16x32_bf16 v[92:95], v[140:143], a[68:71], v[92:95]
  buffer_load_dwordx4 v241, s[16:19], s50 offen lds
  ds_read_b64_tr_b16 v[138:139], v230 offset:26624
  s_waitcnt lgkmcnt(10)
  v_mfma_f32_16x16x32_bf16 v[32:35], v[112:115], a[72:75], v[32:35]
  ds_read_b64_tr_b16 v[140:141], v231 offset:24576
  v_mfma_f32_16x16x32_bf16 v[36:39], v[112:115], a[76:79], v[36:39]
  ds_read_b64_tr_b16 v[142:143], v231 offset:26624
  s_add_u32 m0, s49, 40960
  v_mfma_f32_16x16x32_bf16 v[40:43], v[116:119], a[72:75], v[40:43]
  ds_read_b64_tr_b16 v[112:113], v228 offset:28672
  v_mfma_f32_16x16x32_bf16 v[44:47], v[116:119], a[76:79], v[44:47]
  buffer_load_dwordx4 v241, s[28:31], s50 offen lds
  ds_read_b64_tr_b16 v[114:115], v228 offset:30720
  s_waitcnt lgkmcnt(10)
  v_mfma_f32_16x16x32_bf16 v[48:51], v[120:123], a[72:75], v[48:51]
  ds_read_b64_tr_b16 v[116:117], v229 offset:28672
  v_mfma_f32_16x16x32_bf16 v[52:55], v[120:123], a[76:79], v[52:55]
  ds_read_b64_tr_b16 v[118:119], v229 offset:30720
  v_mfma_f32_16x16x32_bf16 v[56:59], v[124:127], a[72:75], v[56:59]
  ds_read_b64_tr_b16 v[120:121], v230 offset:28672
  v_mfma_f32_16x16x32_bf16 v[60:63], v[124:127], a[76:79], v[60:63]
  buffer_load_dwordx4 a[152:155], v251, s[4:7], s51 offen offset:2048 sc1
  ds_read_b64_tr_b16 v[122:123], v230 offset:30720
  s_waitcnt lgkmcnt(10)
  v_mfma_f32_16x16x32_bf16 v[64:67], v[128:131], a[72:75], v[64:67]
  ds_read_b64_tr_b16 v[124:125], v231 offset:28672
  v_mfma_f32_16x16x32_bf16 v[68:71], v[128:131], a[76:79], v[68:71]
  ds_read_b64_tr_b16 v[126:127], v231 offset:30720
  v_mfma_f32_16x16x32_bf16 v[72:75], v[132:135], a[72:75], v[72:75]
  ds_read_b64_tr_b16 v[128:129], v228 offset:32768
  v_mfma_f32_16x16x32_bf16 v[76:79], v[132:135], a[76:79], v[76:79]
  buffer_load_dwordx4 a[156:159], v251, s[4:7], s51 offen offset:3072 sc1
  ds_read_b64_tr_b16 v[130:131], v228 offset:34816
  s_waitcnt lgkmcnt(10)
  v_mfma_f32_16x16x32_bf16 v[80:83], v[136:139], a[72:75], v[80:83]
  ds_read_b64_tr_b16 v[132:133], v229 offset:32768
  v_mfma_f32_16x16x32_bf16 v[84:87], v[136:139], a[76:79], v[84:87]
  ds_read_b64_tr_b16 v[134:135], v229 offset:34816
  v_mfma_f32_16x16x32_bf16 v[88:91], v[140:143], a[72:75], v[88:91]
  ds_read_b64_tr_b16 v[136:137], v230 offset:32768
  v_mfma_f32_16x16x32_bf16 v[92:95], v[140:143], a[76:79], v[92:95]
  ds_read_b64_tr_b16 v[138:139], v230 offset:34816
  s_waitcnt vmcnt(11)
  s_mov_b32 s47, 262144
sequential_preLN__spectral_fnet__dense_activation_squared_relu__prompt_kernel_poll19:
  v_cmp_ne_u64 vcc, s[42:43], v[96:97]
  s_sub_u32 s47, s47, 1
  s_cbranch_scc1 sequential_preLN__spectral_fnet__dense_activation_squared_relu__prompt_kernel_pok20
  s_cmp_eq_u64 vcc, 0
  s_cbranch_scc1 sequential_preLN__spectral_fnet__dense_activation_squared_relu__prompt_kernel_pok20
  s_sleep 1
  s_mov_b64 exec, vcc
  buffer_load_dwordx2 v[96:97], v239, s[8:11], s55 offen sc1
  s_mov_b64 exec, -1
  s_waitcnt vmcnt(0)
  s_branch sequential_preLN__spectral_fnet__dense_activation_squared_relu__prompt_kernel_poll19
sequential_preLN__spectral_fnet__dense_activation_squared_relu__prompt_kernel_pok20:
  s_waitcnt lgkmcnt(10)
  v_mfma_f32_16x16x32_bf16 v[32:35], v[112:115], a[80:83], v[32:35]
  ds_read_b64_tr_b16 v[140:141], v231 offset:32768
  v_mfma_f32_16x16x32_bf16 v[36:39], v[112:115], a[84:87], v[36:39]
  ds_read_b64_tr_b16 v[142:143], v231 offset:34816
  s_cmp_eq_u32 s39, 2
  s_cselect_b32 s3, 3670016, 0
  s_sub_u32 s86, s86, s3
  s_sub_u32 s87, s87, s3
  s_add_u32 s50, s87, 2293760
  s_add_u32 m0, s49, 45056
  v_mfma_f32_16x16x32_bf16 v[40:43], v[116:119], a[80:83], v[40:43]
  buffer_load_dwordx4 v241, s[16:19], s50 offen lds
  s_barrier
  ds_read_b64_tr_b16 v[112:113], v228 offset:36864
  v_mfma_f32_16x16x32_bf16 v[44:47], v[116:119], a[84:87], v[44:47]
  ds_read_b64_tr_b16 v[114:115], v228 offset:38912
  s_waitcnt lgkmcnt(10)
  v_mfma_f32_16x16x32_bf16 v[48:51], v[120:123], a[80:83], v[48:51]
  ds_read_b64_tr_b16 v[116:117], v229 offset:36864
  v_mfma_f32_16x16x32_bf16 v[52:55], v[120:123], a[84:87], v[52:55]
  ds_read_b64_tr_b16 v[118:119], v229 offset:38912
  s_add_u32 m0, s49, 49152
  v_mfma_f32_16x16x32_bf16 v[56:59], v[124:127], a[80:83], v[56:59]
  ds_read_b64_tr_b16 v[120:121], v230 offset:36864
  v_mfma_f32_16x16x32_bf16 v[60:63], v[124:127], a[84:87], v[60:63]
  buffer_load_dwordx4 v241, s[28:31], s50 offen lds
  ds_read_b64_tr_b16 v[122:123], v230 offset:38912
  s_waitcnt lgkmcnt(10)
  v_mfma_f32_16x16x32_bf16 v[64:67], v[128:131], a[80:83], v[64:67]
  ds_read_b64_tr_b16 v[124:125], v231 offset:36864
  v_mfma_f32_16x16x32_bf16 v[68:71], v[128:131], a[84:87], v[68:71]
  ds_read_b64_tr_b16 v[126:127], v231 offset:38912
  s_cmp_eq_u32 s39, 2
  s_cselect_b32 s3, 114688, 0
  s_sub_u32 s46, s46, s3
  s_add_u32 s51, s46, 71680
  v_mfma_f32_16x16x32_bf16 v[72:75], v[132:135], a[80:83], v[72:75]
  ds_read_b64_tr_b16 v[128:129], v228 offset:40960
  v_mfma_f32_16x16x32_bf16 v[76:79], v[132:135], a[84:87], v[76:79]
  buffer_load_dwordx4 a[160:163], v251, s[4:7], s51 offen offset:0 sc1
  ds_read_b64_tr_b16 v[130:131], v228 offset:43008
  s_waitcnt lgkmcnt(10)
  v_mfma_f32_16x16x32_bf16 v[80:83], v[136:139], a[80:83], v[80:83]
  ds_read_b64_tr_b16 v[132:133], v229 offset:40960
  v_mfma_f32_16x16x32_bf16 v[84:87], v[136:139], a[84:87], v[84:87]
  ds_read_b64_tr_b16 v[134:135], v229 offset:43008
  v_mfma_f32_16x16x32_bf16 v[88:91], v[140:143], a[80:83], v[88:91]
  ds_read_b64_tr_b16 v[136:137], v230 offset:40960
  v_mfma_f32_16x16x32_bf16 v[92:95], v[140:143], a[84:87], v[92:95]
  buffer_load_dwordx4 a[164:167], v251, s[4:7], s51 offen offset:1024 sc1
  ds_read_b64_tr_b16 v[138:139], v230 offset:43008
  s_waitcnt lgkmcnt(10)
  v_mfma_f32_16x16x32_bf16 v[32:35], v[112:115], a[88:91], v[32:35]
  ds_read_b64_tr_b16 v[140:141], v231 offset:40960
  v_mfma_f32_16x16x32_bf16 v[36:39], v[112:115], a[92:95], v[36:39]
  ds_read_b64_tr_b16 v[142:143], v231 offset:43008
  s_add_u32 s50, s87, 2359296
  s_add_u32 m0, s49, 53248
  v_mfma_f32_16x16x32_bf16 v[40:43], v[116:119], a[88:91], v[40:43]
  ds_read_b64_tr_b16 v[112:113], v228 offset:45056
  v_mfma_f32_16x16x32_bf16 v[44:47], v[116:119], a[92:95], v[44:47]
  buffer_load_dwordx4 v241, s[16:19], s50 offen lds
  ds_read_b64_tr_b16 v[114:115], v228 offset:47104
  s_waitcnt lgkmcnt(10)
  v_mfma_f32_16x16x32_bf16 v[48:51], v[120:123], a[88:91], v[48:51]
  ds_read_b64_tr_b16 v[116:117], v229 offset:45056
  v_mfma_f32_16x16x32_bf16 v[52:55], v[120:123], a[92:95], v[52:55]
  ds_read_b64_tr_b16 v[118:119], v229 offset:47104
  s_add_u32 m0, s49, 57344
  v_mfma_f32_16x16x32_bf16 v[56:59], v[124:127], a[88:91], v[56:59]
  ds_read_b64_tr_b16 v[120:121], v230 offset:45056
  v_mfma_f32_16x16x32_bf16 v[60:63], v[124:127], a[92:95], v[60:63]
  buffer_load_dwordx4 v241, s[28:31], s50 offen lds
  ds_read_b64_tr_b16 v[122:123], v230 offset:47104
  s_waitcnt lgkmcnt(10)
  v_mfma_f32_16x16x32_bf16 v[64:67], v[128:131], a[88:91], v[64:67]
  ds_read_b64_tr_b16 v[124:125], v231 offset:45056
  v_mfma_f32_16x16x32_bf16 v[68:71], v[128:131], a[92:95], v[68:71]
  ds_read_b64_tr_b16 v[126:127], v231 offset:47104
  v_mfma_f32_16x16x32_bf16 v[72:75], v[132:135], a[88:91], v[72:75]
  ds_read_b64_tr_b16 v[128:129], v228 offset:49152
  v_mfma_f32_16x16x32_bf16 v[76:79], v[132:135], a[92:95], v[76:79]
  buffer_load_dwordx4 a[168:171], v251, s[4:7], s51 offen offset:2048 sc1
  ds_read_b64_tr_b16 v[130:131], v228 offset:51200
  s_waitcnt lgkmcnt(10)
  v_mfma_f32_16x16x32_bf16 v[80:83], v[136:139], a[88:91], v[80:83]
  ds_read_b64_tr_b16 v[132:133], v229 offset:49152
  v_mfma_f32_16x16x32_bf16 v[84:87], v[136:139], a[92:95], v[84:87]
  ds_read_b64_tr_b16 v[134:135], v229 offset:51200
  v_mfma_f32_16x16x32_bf16 v[88:91], v[140:143], a[88:91], v[88:91]
  ds_read_b64_tr_b16 v[136:137], v230 offset:49152
  v_mfma_f32_16x16x32_bf16 v[92:95], v[140:143], a[92:95], v[92:95]
  buffer_load_dwordx4 a[172:175], v251, s[4:7], s51 offen offset:3072 sc1
  ds_read_b64_tr_b16 v[138:139], v230 offset:51200
  s_waitcnt lgkmcnt(10)
  v_mfma_f32_16x16x32_bf16 v[32:35], v[112:115], a[96:99], v[32:35]
  ds_read_b64_tr_b16 v[140:141], v231 offset:49152
  v_mfma_f32_16x16x32_bf16 v[36:39], v[112:115], a[100:103], v[36:39]
  ds_read_b64_tr_b16 v[142:143], v231 offset:51200
  s_add_u32 s50, s87, 2424832
  s_add_u32 m0, s49, 61440
  v_mfma_f32_16x16x32_bf16 v[40:43], v[116:119], a[96:99], v[40:43]
  buffer_load_dwordx4 v241, s[16:19], s50 offen lds
  s_barrier
  ds_read_b64_tr_b16 v[112:113], v228 offset:53248
  v_mfma_f32_16x16x32_bf16 v[44:47], v[116:119], a[100:103], v[44:47]
  ds_read_b64_tr_b16 v[114:115], v228 offset:55296
  s_waitcnt lgkmcnt(10)
  v_mfma_f32_16x16x32_bf16 v[48:51], v[120:123], a[96:99], v[48:51]
  ds_read_b64_tr_b16 v[116:117], v229 offset:53248
  v_mfma_f32_16x16x32_bf16 v[52:55], v[120:123], a[100:103], v[52:55]
  ds_read_b64_tr_b16 v[118:119], v229 offset:55296
  s_add_u32 m0, s49, 65536
  v_mfma_f32_16x16x32_bf16 v[56:59], v[124:127], a[96:99], v[56:59]
  ds_read_b64_tr_b16 v[120:121], v230 offset:53248
  v_mfma_f32_16x16x32_bf16 v[60:63], v[124:127], a[100:103], v[60:63]
  buffer_load_dwordx4 v241, s[28:31], s50 offen lds
  ds_read_b64_tr_b16 v[122:123], v230 offset:55296
  s_waitcnt lgkmcnt(10)
  v_mfma_f32_16x16x32_bf16 v[64:67], v[128:131], a[96:99], v[64:67]
  ds_read_b64_tr_b16 v[124:125], v231 offset:53248
  v_mfma_f32_16x16x32_bf16 v[68:71], v[128:131], a[100:103], v[68:71]
  ds_read_b64_tr_b16 v[126:127], v231 offset:55296
  s_add_u32 s51, s46, 75776
  v_mfma_f32_16x16x32_bf16 v[72:75], v[132:135], a[96:99], v[72:75]
  ds_read_b64_tr_b16 v[128:129], v228 offset:57344
  v_mfma_f32_16x16x32_bf16 v[76:79], v[132:135], a[100:103], v[76:79]
  buffer_load_dwordx4 a[176:179], v251, s[4:7], s51 offen offset:0 sc1
  ds_read_b64_tr_b16 v[130:131], v228 offset:59392
  s_waitcnt lgkmcnt(10)
  v_mfma_f32_16x16x32_bf16 v[80:83], v[136:139], a[96:99], v[80:83]
  ds_read_b64_tr_b16 v[132:133], v229 offset:57344
  v_mfma_f32_16x16x32_bf16 v[84:87], v[136:139], a[100:103], v[84:87]
  ds_read_b64_tr_b16 v[134:135], v229 offset:59392
  v_mfma_f32_16x16x32_bf16 v[88:91], v[140:143], a[96:99], v[88:91]
  ds_read_b64_tr_b16 v[136:137], v230 offset:57344
  v_mfma_f32_16x16x32_bf16 v[92:95], v[140:143], a[100:103], v[92:95]
  buffer_load_dwordx4 a[180:183], v251, s[4:7], s51 offen offset:1024 sc1
  ds_read_b64_tr_b16 v[138:139], v230 offset:59392
  s_waitcnt lgkmcnt(10)
  v_mfma_f32_16x16x32_bf16 v[32:35], v[112:115], a[104:107], v[32:35]
  ds_read_b64_tr_b16 v[140:141], v231 offset:57344
  v_mfma_f32_16x16x32_bf16 v[36:39], v[112:115], a[108:111], v[36:39]
  ds_read_b64_tr_b16 v[142:143], v231 offset:59392
  s_add_u32 s50, s87, 2490368
  s_add_u32 m0, s49, 69632
  v_mfma_f32_16x16x32_bf16 v[40:43], v[116:119], a[104:107], v[40:43]
  ds_read_b64_tr_b16 v[112:113], v228 offset:61440
  v_mfma_f32_16x16x32_bf16 v[44:47], v[116:119], a[108:111], v[44:47]
  buffer_load_dwordx4 v241, s[16:19], s50 offen lds
  ds_read_b64_tr_b16 v[114:115], v228 offset:63488
  s_waitcnt lgkmcnt(10)
  v_mfma_f32_16x16x32_bf16 v[48:51], v[120:123], a[104:107], v[48:51]
  ds_read_b64_tr_b16 v[116:117], v229 offset:61440
  v_mfma_f32_16x16x32_bf16 v[52:55], v[120:123], a[108:111], v[52:55]
  ds_read_b64_tr_b16 v[118:119], v229 offset:63488
  s_add_u32 m0, s49, 73728
  v_mfma_f32_16x16x32_bf16 v[56:59], v[124:127], a[104:107], v[56:59]
  ds_read_b64_tr_b16 v[120:121], v230 offset:61440
  v_mfma_f32_16x16x32_bf16 v[60:63], v[124:127], a[108:111], v[60:63]
  buffer_load_dwordx4 v241, s[28:31], s50 offen lds
  ds_read_b64_tr_b16 v[122:123], v230 offset:63488
  s_waitcnt lgkmcnt(10)
  v_mfma_f32_16x16x32_bf16 v[64:67], v[128:131], a[104:107], v[64:67]
  ds_read_b64_tr_b16 v[124:125], v231 offset:61440
  v_mfma_f32_16x16x32_bf16 v[68:71], v[128:131], a[108:111], v[68:71]
  ds_read_b64_tr_b16 v[126:127], v231 offset:63488
  v_mfma_f32_16x16x32_bf16 v[72:75], v[132:135], a[104:107], v[72:75]
  ds_read_b64_tr_b16 v[128:129], v224 offset:0
  v_mfma_f32_16x16x32_bf16 v[76:79], v[132:135], a[108:111], v[76:79]
  buffer_load_dwordx4 a[184:187], v251, s[4:7], s51 offen offset:2048 sc1
  ds_read_b64_tr_b16 v[130:131], v224 offset:2048
  s_waitcnt lgkmcnt(10)
  v_mfma_f32_16x16x32_bf16 v[80:83], v[136:139], a[104:107], v[80:83]
  ds_read_b64_tr_b16 v[132:133], v225 offset:0
  v_mfma_f32_16x16x32_bf16 v[84:87], v[136:139], a[108:111], v[84:87]
  ds_read_b64_tr_b16 v[134:135], v225 offset:2048
  v_mfma_f32_16x16x32_bf16 v[88:91], v[140:143], a[104:107], v[88:91]
  ds_read_b64_tr_b16 v[136:137], v226 offset:0
  v_mfma_f32_16x16x32_bf16 v[92:95], v[140:143], a[108:111], v[92:95]
  buffer_load_dwordx4 a[188:191], v251, s[4:7], s51 offen offset:3072 sc1
  ds_read_b64_tr_b16 v[138:139], v226 offset:2048
  s_waitcnt lgkmcnt(10)
  v_mfma_f32_16x16x32_bf16 v[32:35], v[112:115], a[112:115], v[32:35]
  ds_read_b64_tr_b16 v[140:141], v227 offset:0
  v_mfma_f32_16x16x32_bf16 v[36:39], v[112:115], a[116:119], v[36:39]
  ds_read_b64_tr_b16 v[142:143], v227 offset:2048
  s_cmp_eq_u32 s39, 1
  s_cselect_b32 s3, 3670016, 0
  s_sub_u32 s86, s86, s3
  s_sub_u32 s87, s87, s3
  s_add_u32 s50, s86, 2752512
  s_add_u32 m0, s49, 77824
  v_mfma_f32_16x16x32_bf16 v[40:43], v[116:119], a[112:115], v[40:43]
  buffer_load_dwordx4 v241, s[16:19], s50 offen lds
  s_barrier
  ds_read_b64_tr_b16 v[112:113], v224 offset:4096
  v_mfma_f32_16x16x32_bf16 v[44:47], v[116:119], a[116:119], v[44:47]
  ds_read_b64_tr_b16 v[114:115], v224 offset:6144
  s_waitcnt lgkmcnt(10)
  v_mfma_f32_16x16x32_bf16 v[48:51], v[120:123], a[112:115], v[48:51]
  ds_read_b64_tr_b16 v[116:117], v225 offset:4096
  v_mfma_f32_16x16x32_bf16 v[52:55], v[120:123], a[116:119], v[52:55]
  ds_read_b64_tr_b16 v[118:119], v225 offset:6144
  s_add_u32 m0, s49, 81920
  v_mfma_f32_16x16x32_bf16 v[56:59], v[124:127], a[112:115], v[56:59]
  ds_read_b64_tr_b16 v[120:121], v226 offset:4096
  v_mfma_f32_16x16x32_bf16 v[60:63], v[124:127], a[116:119], v[60:63]
  buffer_load_dwordx4 v241, s[28:31], s50 offen lds
  ds_read_b64_tr_b16 v[122:123], v226 offset:6144
  s_waitcnt lgkmcnt(10)
  v_mfma_f32_16x16x32_bf16 v[64:67], v[128:131], a[112:115], v[64:67]
  ds_read_b64_tr_b16 v[124:125], v227 offset:4096
  v_mfma_f32_16x16x32_bf16 v[68:71], v[128:131], a[116:119], v[68:71]
  ds_read_b64_tr_b16 v[126:127], v227 offset:6144
  s_cmp_eq_u32 s39, 1
  s_cselect_b32 s3, 114688, 0
  s_sub_u32 s46, s46, s3
  s_add_u32 s51, s46, 86016
  v_mfma_f32_16x16x32_bf16 v[72:75], v[132:135], a[112:115], v[72:75]
  ds_read_b64_tr_b16 v[128:129], v224 offset:8192
  v_mfma_f32_16x16x32_bf16 v[76:79], v[132:135], a[116:119], v[76:79]
  buffer_load_dwordx4 a[192:195], v251, s[4:7], s51 offen offset:0 sc1
  ds_read_b64_tr_b16 v[130:131], v224 offset:10240
  s_waitcnt lgkmcnt(10)
  v_mfma_f32_16x16x32_bf16 v[80:83], v[136:139], a[112:115], v[80:83]
  ds_read_b64_tr_b16 v[132:133], v225 offset:8192
  v_mfma_f32_16x16x32_bf16 v[84:87], v[136:139], a[116:119], v[84:87]
  ds_read_b64_tr_b16 v[134:135], v225 offset:10240
  v_mfma_f32_16x16x32_bf16 v[88:91], v[140:143], a[112:115], v[88:91]
  ds_read_b64_tr_b16 v[136:137], v226 offset:8192
  v_mfma_f32_16x16x32_bf16 v[92:95], v[140:143], a[116:119], v[92:95]
  buffer_load_dwordx4 a[196:199], v251, s[4:7], s51 offen offset:1024 sc1
  ds_read_b64_tr_b16 v[138:139], v226 offset:10240
  s_waitcnt lgkmcnt(10)
  v_mfma_f32_16x16x32_bf16 v[32:35], v[112:115], a[120:123], v[32:35]
  ds_read_b64_tr_b16 v[140:141], v227 offset:8192
  v_mfma_f32_16x16x32_bf16 v[36:39], v[112:115], a[124:127], v[36:39]
  ds_read_b64_tr_b16 v[142:143], v227 offset:10240
  s_add_u32 s50, s86, 2818048
  s_add_u32 m0, s49, 86016
  v_mfma_f32_16x16x32_bf16 v[40:43], v[116:119], a[120:123], v[40:43]
  ds_read_b64_tr_b16 v[112:113], v224 offset:12288
  v_mfma_f32_16x16x32_bf16 v[44:47], v[116:119], a[124:127], v[44:47]
  buffer_load_dwordx4 v241, s[16:19], s50 offen lds
  ds_read_b64_tr_b16 v[114:115], v224 offset:14336
  s_waitcnt lgkmcnt(10)
  v_mfma_f32_16x16x32_bf16 v[48:51], v[120:123], a[120:123], v[48:51]
  ds_read_b64_tr_b16 v[116:117], v225 offset:12288
  v_mfma_f32_16x16x32_bf16 v[52:55], v[120:123], a[124:127], v[52:55]
  ds_read_b64_tr_b16 v[118:119], v225 offset:14336
  s_add_u32 m0, s49, 90112
  v_mfma_f32_16x16x32_bf16 v[56:59], v[124:127], a[120:123], v[56:59]
  ds_read_b64_tr_b16 v[120:121], v226 offset:12288
  v_mfma_f32_16x16x32_bf16 v[60:63], v[124:127], a[124:127], v[60:63]
  buffer_load_dwordx4 v241, s[28:31], s50 offen lds
  ds_read_b64_tr_b16 v[122:123], v226 offset:14336
  s_waitcnt lgkmcnt(10)
  v_mfma_f32_16x16x32_bf16 v[64:67], v[128:131], a[120:123], v[64:67]
  ds_read_b64_tr_b16 v[124:125], v227 offset:12288
  v_mfma_f32_16x16x32_bf16 v[68:71], v[128:131], a[124:127], v[68:71]
  ds_read_b64_tr_b16 v[126:127], v227 offset:14336
  v_mfma_f32_16x16x32_bf16 v[72:75], v[132:135], a[120:123], v[72:75]
  ds_read_b64_tr_b16 v[128:129], v224 offset:16384
  v_mfma_f32_16x16x32_bf16 v[76:79], v[132:135], a[124:127], v[76:79]
  buffer_load_dwordx4 a[200:203], v251, s[4:7], s51 offen offset:2048 sc1
  ds_read_b64_tr_b16 v[130:131], v224 offset:18432
  s_waitcnt lgkmcnt(10)
  v_mfma_f32_16x16x32_bf16 v[80:83], v[136:139], a[120:123], v[80:83]
  ds_read_b64_tr_b16 v[132:133], v225 offset:16384
  v_mfma_f32_16x16x32_bf16 v[84:87], v[136:139], a[124:127], v[84:87]
  ds_read_b64_tr_b16 v[134:135], v225 offset:18432
  v_mfma_f32_16x16x32_bf16 v[88:91], v[140:143], a[120:123], v[88:91]
  ds_read_b64_tr_b16 v[136:137], v226 offset:16384
  v_mfma_f32_16x16x32_bf16 v[92:95], v[140:143], a[124:127], v[92:95]
  buffer_load_dwordx4 a[204:207], v251, s[4:7], s51 offen offset:3072 sc1
  ds_read_b64_tr_b16 v[138:139], v226 offset:18432
  s_waitcnt lgkmcnt(10)
  v_mfma_f32_16x16x32_bf16 v[32:35], v[112:115], a[128:131], v[32:35]
  ds_read_b64_tr_b16 v[140:141], v227 offset:16384
  v_mfma_f32_16x16x32_bf16 v[36:39], v[112:115], a[132:135], v[36:39]
  ds_read_b64_tr_b16 v[142:143], v227 offset:18432
  s_add_u32 s50, s86, 2883584
  s_add_u32 m0, s49, 94208
  v_mfma_f32_16x16x32_bf16 v[40:43], v[116:119], a[128:131], v[40:43]
  buffer_load_dwordx4 v241, s[16:19], s50 offen lds
  s_waitcnt vmcnt(31)
  s_barrier
  ds_read_b64_tr_b16 v[112:113], v224 offset:20480
  v_mfma_f32_16x16x32_bf16 v[44:47], v[116:119], a[132:135], v[44:47]
  ds_read_b64_tr_b16 v[114:115], v224 offset:22528
  s_waitcnt lgkmcnt(10)
  v_mfma_f32_16x16x32_bf16 v[48:51], v[120:123], a[128:131], v[48:51]
  ds_read_b64_tr_b16 v[116:117], v225 offset:20480
  v_mfma_f32_16x16x32_bf16 v[52:55], v[120:123], a[132:135], v[52:55]
  ds_read_b64_tr_b16 v[118:119], v225 offset:22528
  s_add_u32 m0, s49, 98304
  v_mfma_f32_16x16x32_bf16 v[56:59], v[124:127], a[128:131], v[56:59]
  ds_read_b64_tr_b16 v[120:121], v226 offset:20480
  v_mfma_f32_16x16x32_bf16 v[60:63], v[124:127], a[132:135], v[60:63]
  buffer_load_dwordx4 v241, s[28:31], s50 offen lds
  ds_read_b64_tr_b16 v[122:123], v226 offset:22528
  s_waitcnt lgkmcnt(10)
  v_mfma_f32_16x16x32_bf16 v[64:67], v[128:131], a[128:131], v[64:67]
  ds_read_b64_tr_b16 v[124:125], v227 offset:20480
  v_mfma_f32_16x16x32_bf16 v[68:71], v[128:131], a[132:135], v[68:71]
  ds_read_b64_tr_b16 v[126:127], v227 offset:22528
  s_add_u32 s51, s46, 90112
  v_mfma_f32_16x16x32_bf16 v[72:75], v[132:135], a[128:131], v[72:75]
  ds_read_b64_tr_b16 v[128:129], v224 offset:24576
  v_mfma_f32_16x16x32_bf16 v[76:79], v[132:135], a[132:135], v[76:79]
  buffer_load_dwordx4 a[208:211], v251, s[4:7], s51 offen offset:0 sc1
  ds_read_b64_tr_b16 v[130:131], v224 offset:26624
  s_waitcnt lgkmcnt(10)
  v_mfma_f32_16x16x32_bf16 v[80:83], v[136:139], a[128:131], v[80:83]
  ds_read_b64_tr_b16 v[132:133], v225 offset:24576
  v_mfma_f32_16x16x32_bf16 v[84:87], v[136:139], a[132:135], v[84:87]
  ds_read_b64_tr_b16 v[134:135], v225 offset:26624
  v_mfma_f32_16x16x32_bf16 v[88:91], v[140:143], a[128:131], v[88:91]
  ds_read_b64_tr_b16 v[136:137], v226 offset:24576
  v_mfma_f32_16x16x32_bf16 v[92:95], v[140:143], a[132:135], v[92:95]
  buffer_load_dwordx4 a[212:215], v251, s[4:7], s51 offen offset:1024 sc1
  ds_read_b64_tr_b16 v[138:139], v226 offset:26624
  s_waitcnt lgkmcnt(10)
  v_mfma_f32_16x16x32_bf16 v[32:35], v[112:115], a[136:139], v[32:35]
  ds_read_b64_tr_b16 v[140:141], v227 offset:24576
  v_mfma_f32_16x16x32_bf16 v[36:39], v[112:115], a[140:143], v[36:39]
  ds_read_b64_tr_b16 v[142:143], v227 offset:26624
  v_mfma_f32_16x16x32_bf16 v[40:43], v[116:119], a[136:139], v[40:43]
  ds_read_b64_tr_b16 v[112:113], v224 offset:28672
  v_mfma_f32_16x16x32_bf16 v[44:47], v[116:119], a[140:143], v[44:47]
  buffer_load_dwordx2 v[200:201], v108, s[8:11], s44 offen offset:0 sc1
  ds_read_b64_tr_b16 v[114:115], v224 offset:30720
  s_waitcnt lgkmcnt(10)
  v_mfma_f32_16x16x32_bf16 v[48:51], v[120:123], a[136:139], v[48:51]
  ds_read_b64_tr_b16 v[116:117], v225 offset:28672
  v_mfma_f32_16x16x32_bf16 v[52:55], v[120:123], a[140:143], v[52:55]
  ds_read_b64_tr_b16 v[118:119], v225 offset:30720
  v_mfma_f32_16x16x32_bf16 v[56:59], v[124:127], a[136:139], v[56:59]
  ds_read_b64_tr_b16 v[120:121], v226 offset:28672
  v_mfma_f32_16x16x32_bf16 v[60:63], v[124:127], a[140:143], v[60:63]
  buffer_load_dwordx2 v[202:203], v108, s[8:11], s44 offen offset:1024 sc1
  ds_read_b64_tr_b16 v[122:123], v226 offset:30720
  s_waitcnt lgkmcnt(10)
  v_mfma_f32_16x16x32_bf16 v[64:67], v[128:131], a[136:139], v[64:67]
  ds_read_b64_tr_b16 v[124:125], v227 offset:28672
  v_mfma_f32_16x16x32_bf16 v[68:71], v[128:131], a[140:143], v[68:71]
  ds_read_b64_tr_b16 v[126:127], v227 offset:30720
  s_add_u32 s50, s86, 2949120
  s_add_u32 m0, s49, 102400
  v_mfma_f32_16x16x32_bf16 v[72:75], v[132:135], a[136:139], v[72:75]
  ds_read_b64_tr_b16 v[128:129], v224 offset:32768
  v_mfma_f32_16x16x32_bf16 v[76:79], v[132:135], a[140:143], v[76:79]
  buffer_load_dwordx4 v241, s[16:19], s50 offen lds
  ds_read_b64_tr_b16 v[130:131], v224 offset:34816
  s_waitcnt lgkmcnt(10)
  v_mfma_f32_16x16x32_bf16 v[80:83], v[136:139], a[136:139], v[80:83]
  ds_read_b64_tr_b16 v[132:133], v225 offset:32768
  v_mfma_f32_16x16x32_bf16 v[84:87], v[136:139], a[140:143], v[84:87]
  ds_read_b64_tr_b16 v[134:135], v225 offset:34816
  v_mfma_f32_16x16x32_bf16 v[88:91], v[140:143], a[136:139], v[88:91]
  ds_read_b64_tr_b16 v[136:137], v226 offset:32768
  v_mfma_f32_16x16x32_bf16 v[92:95], v[140:143], a[140:143], v[92:95]
  buffer_load_dwordx2 v[204:205], v108, s[8:11], s44 offen offset:8 sc1
  ds_read_b64_tr_b16 v[138:139], v226 offset:34816
  s_waitcnt vmcnt(36) lgkmcnt(10)
  v_mfma_f32_16x16x32_bf16 v[32:35], v[112:115], a[144:147], v[32:35]
  ds_read_b64_tr_b16 v[140:141], v227 offset:32768
  v_mfma_f32_16x16x32_bf16 v[36:39], v[112:115], a[148:151], v[36:39]
  ds_read_b64_tr_b16 v[142:143], v227 offset:34816
  v_mfma_f32_16x16x32_bf16 v[40:43], v[116:119], a[144:147], v[40:43]
  buffer_load_dwordx2 v[206:207], v108, s[8:11], s44 offen offset:1032 sc1
  s_waitcnt vmcnt(31)
  s_barrier
  ds_read_b64_tr_b16 v[112:113], v224 offset:36864
  v_mfma_f32_16x16x32_bf16 v[44:47], v[116:119], a[148:151], v[44:47]
  ds_read_b64_tr_b16 v[114:115], v224 offset:38912
  s_waitcnt lgkmcnt(10)
  v_mfma_f32_16x16x32_bf16 v[48:51], v[120:123], a[144:147], v[48:51]
  ds_read_b64_tr_b16 v[116:117], v225 offset:36864
  v_mfma_f32_16x16x32_bf16 v[52:55], v[120:123], a[148:151], v[52:55]
  ds_read_b64_tr_b16 v[118:119], v225 offset:38912
  v_mfma_f32_16x16x32_bf16 v[56:59], v[124:127], a[144:147], v[56:59]
  ds_read_b64_tr_b16 v[120:121], v226 offset:36864
  v_mfma_f32_16x16x32_bf16 v[60:63], v[124:127], a[148:151], v[60:63]
  buffer_load_dwordx2 v[208:209], v108, s[8:11], s44 offen offset:2048 sc1
  ds_read_b64_tr_b16 v[122:123], v226 offset:38912
  s_waitcnt lgkmcnt(10)
  v_mfma_f32_16x16x32_bf16 v[64:67], v[128:131], a[144:147], v[64:67]
  ds_read_b64_tr_b16 v[124:125], v227 offset:36864
  v_mfma_f32_16x16x32_bf16 v[68:71], v[128:131], a[148:151], v[68:71]
  ds_read_b64_tr_b16 v[126:127], v227 offset:38912
  v_mfma_f32_16x16x32_bf16 v[72:75], v[132:135], a[144:147], v[72:75]
  ds_read_b64_tr_b16 v[128:129], v224 offset:40960
  v_mfma_f32_16x16x32_bf16 v[76:79], v[132:135], a[148:151], v[76:79]
  buffer_load_dwordx2 v[210:211], v108, s[8:11], s44 offen offset:3072 sc1
  ds_read_b64_tr_b16 v[130:131], v224 offset:43008
  s_waitcnt lgkmcnt(10)
  v_mfma_f32_16x16x32_bf16 v[80:83], v[136:139], a[144:147], v[80:83]
  ds_read_b64_tr_b16 v[132:133], v225 offset:40960
  v_mfma_f32_16x16x32_bf16 v[84:87], v[136:139], a[148:151], v[84:87]
  ds_read_b64_tr_b16 v[134:135], v225 offset:43008
  s_add_u32 m0, s49, 106496
  v_mfma_f32_16x16x32_bf16 v[88:91], v[140:143], a[144:147], v[88:91]
  ds_read_b64_tr_b16 v[136:137], v226 offset:40960
  v_mfma_f32_16x16x32_bf16 v[92:95], v[140:143], a[148:151], v[92:95]
  buffer_load_dwordx4 v241, s[28:31], s50 offen lds
  ds_read_b64_tr_b16 v[138:139], v226 offset:43008
  s_waitcnt lgkmcnt(10)
  v_mfma_f32_16x16x32_bf16 v[32:35], v[112:115], a[152:155], v[32:35]
  ds_read_b64_tr_b16 v[140:141], v227 offset:40960
  v_mfma_f32_16x16x32_bf16 v[36:39], v[112:115], a[156:159], v[36:39]
  ds_read_b64_tr_b16 v[142:143], v227 offset:43008
  v_mfma_f32_16x16x32_bf16 v[40:43], v[116:119], a[152:155], v[40:43]
  ds_read_b64_tr_b16 v[112:113], v224 offset:45056
  v_mfma_f32_16x16x32_bf16 v[44:47], v[116:119], a[156:159], v[44:47]
  buffer_load_dwordx2 v[212:213], v108, s[8:11], s44 offen offset:2056 sc1
  ds_read_b64_tr_b16 v[114:115], v224 offset:47104
  s_waitcnt lgkmcnt(10)
  v_mfma_f32_16x16x32_bf16 v[48:51], v[120:123], a[152:155], v[48:51]
  ds_read_b64_tr_b16 v[116:117], v225 offset:45056
  v_mfma_f32_16x16x32_bf16 v[52:55], v[120:123], a[156:159], v[52:55]
  ds_read_b64_tr_b16 v[118:119], v225 offset:47104
  v_mfma_f32_16x16x32_bf16 v[56:59], v[124:127], a[152:155], v[56:59]
  ds_read_b64_tr_b16 v[120:121], v226 offset:45056
  v_mfma_f32_16x16x32_bf16 v[60:63], v[124:127], a[156:159], v[60:63]
  buffer_load_dwordx2 v[214:215], v108, s[8:11], s44 offen offset:3080 sc1
  ds_read_b64_tr_b16 v[122:123], v226 offset:47104
  s_waitcnt lgkmcnt(10)
  v_mfma_f32_16x16x32_bf16 v[64:67], v[128:131], a[152:155], v[64:67]
  ds_read_b64_tr_b16 v[124:125], v227 offset:45056
  v_mfma_f32_16x16x32_bf16 v[68:71], v[128:131], a[156:159], v[68:71]
  ds_read_b64_tr_b16 v[126:127], v227 offset:47104
  v_mfma_f32_16x16x32_bf16 v[72:75], v[132:135], a[152:155], v[72:75]
  ds_read_b64_tr_b16 v[128:129], v224 offset:49152
  v_mfma_f32_16x16x32_bf16 v[76:79], v[132:135], a[156:159], v[76:79]
  buffer_load_dwordx4 a[216:219], v251, s[4:7], s51 offen offset:2048 sc1
  ds_read_b64_tr_b16 v[130:131], v224 offset:51200
  s_waitcnt lgkmcnt(10)
  v_mfma_f32_16x16x32_bf16 v[80:83], v[136:139], a[152:155], v[80:83]
  ds_read_b64_tr_b16 v[132:133], v225 offset:49152
  v_mfma_f32_16x16x32_bf16 v[84:87], v[136:139], a[156:159], v[84:87]
  ds_read_b64_tr_b16 v[134:135], v225 offset:51200
  v_mfma_f32_16x16x32_bf16 v[88:91], v[140:143], a[152:155], v[88:91]
  ds_read_b64_tr_b16 v[136:137], v226 offset:49152
  v_mfma_f32_16x16x32_bf16 v[92:95], v[140:143], a[156:159], v[92:95]
  buffer_load_dwordx4 a[220:223], v251, s[4:7], s51 offen offset:3072 sc1
  ds_read_b64_tr_b16 v[138:139], v226 offset:51200
  s_waitcnt vmcnt(36) lgkmcnt(10)
  v_mfma_f32_16x16x32_bf16 v[32:35], v[112:115], a[160:163], v[32:35]
  ds_read_b64_tr_b16 v[140:141], v227 offset:49152
  v_mfma_f32_16x16x32_bf16 v[36:39], v[112:115], a[164:167], v[36:39]
  ds_read_b64_tr_b16 v[142:143], v227 offset:51200
  v_mfma_f32_16x16x32_bf16 v[40:43], v[116:119], a[160:163], v[40:43]
  buffer_load_dword v216, v110, s[8:11], s44 offen offset:0 sc1
  s_waitcnt vmcnt(31)
  s_barrier
  ds_read_b64_tr_b16 v[112:113], v224 offset:53248
  v_mfma_f32_16x16x32_bf16 v[44:47], v[116:119], a[164:167], v[44:47]
  ds_read_b64_tr_b16 v[114:115], v224 offset:55296
  s_waitcnt lgkmcnt(10)
  v_mfma_f32_16x16x32_bf16 v[48:51], v[120:123], a[160:163], v[48:51]
  ds_read_b64_tr_b16 v[116:117], v225 offset:53248
  v_mfma_f32_16x16x32_bf16 v[52:55], v[120:123], a[164:167], v[52:55]
  ds_read_b64_tr_b16 v[118:119], v225 offset:55296
  v_mfma_f32_16x16x32_bf16 v[56:59], v[124:127], a[160:163], v[56:59]
  ds_read_b64_tr_b16 v[120:121], v226 offset:53248
  v_mfma_f32_16x16x32_bf16 v[60:63], v[124:127], a[164:167], v[60:63]
  buffer_load_dword v217, v110, s[8:11], s44 offen offset:1024 sc1
  ds_read_b64_tr_b16 v[122:123], v226 offset:55296
  s_waitcnt lgkmcnt(10)
  v_mfma_f32_16x16x32_bf16 v[64:67], v[128:131], a[160:163], v[64:67]
  ds_read_b64_tr_b16 v[124:125], v227 offset:53248
  v_mfma_f32_16x16x32_bf16 v[68:71], v[128:131], a[164:167], v[68:71]
  ds_read_b64_tr_b16 v[126:127], v227 offset:55296
  s_mul_i32 s86, s39, 458752
  s_add_u32 s86, s86, 458752
  s_bitcmp1_b32 s39, 0
  s_cselect_b32 s3, 4294705152, 0
  s_cselect_b32 s48, 0, 4294705152
  s_add_u32 s87, s86, s3
  s_add_u32 s86, s86, s48
  s_cmp_eq_u32 s39, 7
  s_cselect_b32 s3, 3670016, 0
  s_sub_u32 s86, s86, s3
  s_sub_u32 s87, s87, s3
  s_add_u32 s50, s86, 262144
  s_add_u32 m0, s49, 110592
  v_mfma_f32_16x16x32_bf16 v[72:75], v[132:135], a[160:163], v[72:75]
  ds_read_b64_tr_b16 v[128:129], v224 offset:57344
  v_mfma_f32_16x16x32_bf16 v[76:79], v[132:135], a[164:167], v[76:79]
  buffer_load_dwordx4 v241, s[16:19], s50 offen lds
  ds_read_b64_tr_b16 v[130:131], v224 offset:59392
  s_waitcnt lgkmcnt(10)
  v_mfma_f32_16x16x32_bf16 v[80:83], v[136:139], a[160:163], v[80:83]
  ds_read_b64_tr_b16 v[132:133], v225 offset:57344
  v_mfma_f32_16x16x32_bf16 v[84:87], v[136:139], a[164:167], v[84:87]
  ds_read_b64_tr_b16 v[134:135], v225 offset:59392
  v_mfma_f32_16x16x32_bf16 v[88:91], v[140:143], a[160:163], v[88:91]
  ds_read_b64_tr_b16 v[136:137], v226 offset:57344
  v_mfma_f32_16x16x32_bf16 v[92:95], v[140:143], a[164:167], v[92:95]
  buffer_load_dword v218, v109, s[8:11], s44 offen offset:8 sc1
  ds_read_b64_tr_b16 v[138:139], v226 offset:59392
  s_waitcnt lgkmcnt(10)
  v_mfma_f32_16x16x32_bf16 v[32:35], v[112:115], a[168:171], v[32:35]
  ds_read_b64_tr_b16 v[140:141], v227 offset:57344
  v_mfma_f32_16x16x32_bf16 v[36:39], v[112:115], a[172:175], v[36:39]
  ds_read_b64_tr_b16 v[142:143], v227 offset:59392
  v_mfma_f32_16x16x32_bf16 v[40:43], v[116:119], a[168:171], v[40:43]
  ds_read_b64_tr_b16 v[112:113], v224 offset:61440
  v_mfma_f32_16x16x32_bf16 v[44:47], v[116:119], a[172:175], v[44:47]
  buffer_load_dword v219, v109, s[8:11], s44 offen offset:1032 sc1
  ds_read_b64_tr_b16 v[114:115], v224 offset:63488
  s_waitcnt lgkmcnt(10)
  v_mfma_f32_16x16x32_bf16 v[48:51], v[120:123], a[168:171], v[48:51]
  ds_read_b64_tr_b16 v[116:117], v225 offset:61440
  v_mfma_f32_16x16x32_bf16 v[52:55], v[120:123], a[172:175], v[52:55]
  ds_read_b64_tr_b16 v[118:119], v225 offset:63488
  v_mfma_f32_16x16x32_bf16 v[56:59], v[124:127], a[168:171], v[56:59]
  ds_read_b64_tr_b16 v[120:121], v226 offset:61440
  v_mfma_f32_16x16x32_bf16 v[60:63], v[124:127], a[172:175], v[60:63]
  buffer_load_dword v220, v110, s[8:11], s44 offen offset:2048 sc1
  ds_read_b64_tr_b16 v[122:123], v226 offset:63488
  s_waitcnt lgkmcnt(10)
  v_mfma_f32_16x16x32_bf16 v[64:67], v[128:131], a[168:171], v[64:67]
  ds_read_b64_tr_b16 v[124:125], v227 offset:61440
  v_mfma_f32_16x16x32_bf16 v[68:71], v[128:131], a[172:175], v[68:71]
  ds_read_b64_tr_b16 v[126:127], v227 offset:63488
  v_mfma_f32_16x16x32_bf16 v[72:75], v[132:135], a[168:171], v[72:75]
  ds_read_b64_tr_b16 v[128:129], v228 offset:0
  v_mfma_f32_16x16x32_bf16 v[76:79], v[132:135], a[172:175], v[76:79]
  buffer_load_dword v221, v110, s[8:11], s44 offen offset:3072 sc1
  ds_read_b64_tr_b16 v[130:131], v228 offset:2048
  s_waitcnt lgkmcnt(10)
  v_mfma_f32_16x16x32_bf16 v[80:83], v[136:139], a[168:171], v[80:83]
  ds_read_b64_tr_b16 v[132:133], v229 offset:0
  v_mfma_f32_16x16x32_bf16 v[84:87], v[136:139], a[172:175], v[84:87]
  ds_read_b64_tr_b16 v[134:135], v229 offset:2048
  s_add_u32 s50, s86, 327680
  s_add_u32 m0, s49, 114688
  v_mfma_f32_16x16x32_bf16 v[88:91], v[140:143], a[168:171], v[88:91]
  ds_read_b64_tr_b16 v[136:137], v230 offset:0
  v_mfma_f32_16x16x32_bf16 v[92:95], v[140:143], a[172:175], v[92:95]
  buffer_load_dwordx4 v241, s[16:19], s50 offen lds
  ds_read_b64_tr_b16 v[138:139], v230 offset:2048
  s_waitcnt vmcnt(36) lgkmcnt(10)
  v_mfma_f32_16x16x32_bf16 v[32:35], v[112:115], a[176:179], v[32:35]
  ds_read_b64_tr_b16 v[140:141], v231 offset:0
  v_mfma_f32_16x16x32_bf16 v[36:39], v[112:115], a[180:183], v[36:39]
  ds_read_b64_tr_b16 v[142:143], v231 offset:2048
  v_mfma_f32_16x16x32_bf16 v[40:43], v[116:119], a[176:179], v[40:43]
  buffer_load_dword v222, v111, s[8:11], s59 offen offset:2056 sc1
  s_waitcnt vmcnt(31)
  s_barrier
  ds_read_b64_tr_b16 v[112:113], v228 offset:4096
  v_mfma_f32_16x16x32_bf16 v[44:47], v[116:119], a[180:183], v[44:47]
  ds_read_b64_tr_b16 v[114:115], v228 offset:6144
  s_waitcnt lgkmcnt(10)
  v_mfma_f32_16x16x32_bf16 v[48:51], v[120:123], a[176:179], v[48:51]
  ds_read_b64_tr_b16 v[116:117], v229 offset:4096
  v_mfma_f32_16x16x32_bf16 v[52:55], v[120:123], a[180:183], v[52:55]
  ds_read_b64_tr_b16 v[118:119], v229 offset:6144
  v_mfma_f32_16x16x32_bf16 v[56:59], v[124:127], a[176:179], v[56:59]
  ds_read_b64_tr_b16 v[120:121], v230 offset:4096
  v_mfma_f32_16x16x32_bf16 v[60:63], v[124:127], a[180:183], v[60:63]
  buffer_load_dword v223, v111, s[8:11], s59 offen offset:3080 sc1
  ds_read_b64_tr_b16 v[122:123], v230 offset:6144
  s_waitcnt lgkmcnt(10)
  v_mfma_f32_16x16x32_bf16 v[64:67], v[128:131], a[176:179], v[64:67]
  ds_read_b64_tr_b16 v[124:125], v231 offset:4096
  v_mfma_f32_16x16x32_bf16 v[68:71], v[128:131], a[180:183], v[68:71]
  ds_read_b64_tr_b16 v[126:127], v231 offset:6144
  v_mfma_f32_16x16x32_bf16 v[72:75], v[132:135], a[176:179], v[72:75]
  ds_read_b64_tr_b16 v[128:129], v228 offset:8192
  v_mfma_f32_16x16x32_bf16 v[76:79], v[132:135], a[180:183], v[76:79]
  buffer_load_ushort v144, v238, s[24:27], s45 offen offset:0
  ds_read_b64_tr_b16 v[130:131], v228 offset:10240
  s_waitcnt lgkmcnt(10)
  v_mfma_f32_16x16x32_bf16 v[80:83], v[136:139], a[176:179], v[80:83]
  ds_read_b64_tr_b16 v[132:133], v229 offset:8192
  v_mfma_f32_16x16x32_bf16 v[84:87], v[136:139], a[180:183], v[84:87]
  ds_read_b64_tr_b16 v[134:135], v229 offset:10240
  s_mul_i32 s46, s39, 14336
  s_add_u32 s46, s46, 14336
  s_cmp_eq_u32 s39, 7
  s_cselect_b32 s3, 114688, 0
  s_sub_u32 s46, s46, s3
  s_add_u32 s51, s46, 8192
  v_mfma_f32_16x16x32_bf16 v[88:91], v[140:143], a[176:179], v[88:91]
  ds_read_b64_tr_b16 v[136:137], v230 offset:8192
  v_mfma_f32_16x16x32_bf16 v[92:95], v[140:143], a[180:183], v[92:95]
  buffer_load_dwordx4 a[224:227], v251, s[4:7], s51 offen offset:0 sc1
  ds_read_b64_tr_b16 v[138:139], v230 offset:10240
  s_waitcnt lgkmcnt(10)
  v_mfma_f32_16x16x32_bf16 v[32:35], v[112:115], a[184:187], v[32:35]
  ds_read_b64_tr_b16 v[140:141], v231 offset:8192
  v_mfma_f32_16x16x32_bf16 v[36:39], v[112:115], a[188:191], v[36:39]
  ds_read_b64_tr_b16 v[142:143], v231 offset:10240
  s_nop 0
  buffer_load_dwordx4 a[228:231], v251, s[4:7], s51 offen offset:1024 sc1
  v_mfma_f32_16x16x32_bf16 v[40:43], v[116:119], a[184:187], v[40:43]
  ds_read_b64_tr_b16 v[112:113], v228 offset:12288
  v_mfma_f32_16x16x32_bf16 v[44:47], v[116:119], a[188:191], v[44:47]
  buffer_load_ushort v146, v238, s[24:27], s45 offen offset:32
  ds_read_b64_tr_b16 v[114:115], v228 offset:14336
  s_waitcnt lgkmcnt(10)
  v_mfma_f32_16x16x32_bf16 v[48:51], v[120:123], a[184:187], v[48:51]
  ds_read_b64_tr_b16 v[116:117], v229 offset:12288
  v_mfma_f32_16x16x32_bf16 v[52:55], v[120:123], a[188:191], v[52:55]
  ds_read_b64_tr_b16 v[118:119], v229 offset:14336
  s_add_u32 s50, s86, 393216
  s_add_u32 m0, s49, 118784
  s_nop 0
  buffer_load_dwordx4 v241, s[16:19], s50 offen lds
  v_mfma_f32_16x16x32_bf16 v[56:59], v[124:127], a[184:187], v[56:59]
  ds_read_b64_tr_b16 v[120:121], v230 offset:12288
  v_mfma_f32_16x16x32_bf16 v[60:63], v[124:127], a[188:191], v[60:63]
  buffer_load_ushort v148, v238, s[24:27], s45 offen offset:64
  ds_read_b64_tr_b16 v[122:123], v230 offset:14336
  s_waitcnt lgkmcnt(10)
  v_mfma_f32_16x16x32_bf16 v[64:67], v[128:131], a[184:187], v[64:67]
  ds_read_b64_tr_b16 v[124:125], v231 offset:12288
  v_mfma_f32_16x16x32_bf16 v[68:71], v[128:131], a[188:191], v[68:71]
  ds_read_b64_tr_b16 v[126:127], v231 offset:14336
  s_nop 0
  buffer_load_ushort v150, v238, s[24:27], s45 offen offset:96
  v_mfma_f32_16x16x32_bf16 v[72:75], v[132:135], a[184:187], v[72:75]
  ds_read_b64_tr_b16 v[128:129], v228 offset:16384
  v_mfma_f32_16x16x32_bf16 v[76:79], v[132:135], a[188:191], v[76:79]
  buffer_load_dwordx4 a[232:235], v251, s[4:7], s51 offen offset:2048 sc1
  ds_read_b64_tr_b16 v[130:131], v228 offset:18432
  s_waitcnt lgkmcnt(10)
  v_mfma_f32_16x16x32_bf16 v[80:83], v[136:139], a[184:187], v[80:83]
  ds_read_b64_tr_b16 v[132:133], v229 offset:16384
  v_mfma_f32_16x16x32_bf16 v[84:87], v[136:139], a[188:191], v[84:87]
  ds_read_b64_tr_b16 v[134:135], v229 offset:18432
  s_nop 0
  buffer_load_dwordx4 a[236:239], v251, s[4:7], s51 offen offset:3072 sc1
  s_cmp_eq_u32 s39, 6
  s_cselect_b32 s3, 3670016, 0
  s_sub_u32 s86, s86, s3
  s_sub_u32 s87, s87, s3
  s_add_u32 s50, s87, 720896
  s_add_u32 m0, s49, 122880
  v_mfma_f32_16x16x32_bf16 v[88:91], v[140:143], a[184:187], v[88:91]
  ds_read_b64_tr_b16 v[136:137], v230 offset:16384
  v_mfma_f32_16x16x32_bf16 v[92:95], v[140:143], a[188:191], v[92:95]
  buffer_load_dwordx4 v241, s[16:19], s50 offen lds
  ds_read_b64_tr_b16 v[138:139], v230 offset:18432
  s_waitcnt vmcnt(40) lgkmcnt(10)
  v_mfma_f32_16x16x32_bf16 v[32:35], v[112:115], a[192:195], v[32:35]
  ds_read_b64_tr_b16 v[140:141], v231 offset:16384
  v_mfma_f32_16x16x32_bf16 v[36:39], v[112:115], a[196:199], v[36:39]
  ds_read_b64_tr_b16 v[142:143], v231 offset:18432
  s_add_u32 s51, s46, 12288
  s_nop 0
  buffer_load_dwordx4 a[240:243], v251, s[4:7], s51 offen offset:0 sc1
  v_mfma_f32_16x16x32_bf16 v[40:43], v[116:119], a[192:195], v[40:43]
  buffer_load_dwordx4 a[244:247], v251, s[4:7], s51 offen offset:1024 sc1
  s_waitcnt vmcnt(36)
  s_barrier
  ds_read_b64_tr_b16 v[112:113], v228 offset:20480
  v_mfma_f32_16x16x32_bf16 v[44:47], v[116:119], a[196:199], v[44:47]
  ds_read_b64_tr_b16 v[114:115], v228 offset:22528
  s_waitcnt lgkmcnt(10)
  v_mfma_f32_16x16x32_bf16 v[48:51], v[120:123], a[192:195], v[48:51]
  ds_read_b64_tr_b16 v[116:117], v229 offset:20480
  v_mfma_f32_16x16x32_bf16 v[52:55], v[120:123], a[196:199], v[52:55]
  ds_read_b64_tr_b16 v[118:119], v229 offset:22528
  s_add_u32 s50, s87, 786432
  s_add_u32 m0, s49, 126976
  s_nop 0
  buffer_load_dwordx4 v241, s[16:19], s50 offen lds
  s_cmp_eq_u32 s39, 6
  s_cselect_b32 s3, 114688, 0
  s_sub_u32 s46, s46, s3
  s_add_u32 s51, s46, 22528
  v_mfma_f32_16x16x32_bf16 v[56:59], v[124:127], a[192:195], v[56:59]
  ds_read_b64_tr_b16 v[120:121], v230 offset:20480
  v_mfma_f32_16x16x32_bf16 v[60:63], v[124:127], a[196:199], v[60:63]
  buffer_load_dwordx4 a[248:251], v251, s[4:7], s51 offen offset:0 sc1
  ds_read_b64_tr_b16 v[122:123], v230 offset:22528
  s_waitcnt lgkmcnt(10)
  v_mfma_f32_16x16x32_bf16 v[64:67], v[128:131], a[192:195], v[64:67]
  ds_read_b64_tr_b16 v[124:125], v231 offset:20480
  v_mfma_f32_16x16x32_bf16 v[68:71], v[128:131], a[196:199], v[68:71]
  ds_read_b64_tr_b16 v[126:127], v231 offset:22528
  s_nop 0
  buffer_load_dwordx4 a[252:255], v251, s[4:7], s51 offen offset:1024 sc1
  s_add_u32 s50, s87, 851968
  s_add_u32 m0, s49, 0
  v_mfma_f32_16x16x32_bf16 v[72:75], v[132:135], a[192:195], v[72:75]
  ds_read_b64_tr_b16 v[128:129], v228 offset:24576
  v_mfma_f32_16x16x32_bf16 v[76:79], v[132:135], a[196:199], v[76:79]
  buffer_load_dwordx4 v241, s[16:19], s50 offen lds
  ds_read_b64_tr_b16 v[130:131], v228 offset:26624
  s_waitcnt lgkmcnt(10)
  v_mfma_f32_16x16x32_bf16 v[80:83], v[136:139], a[192:195], v[80:83]
  ds_read_b64_tr_b16 v[132:133], v229 offset:24576
  v_mfma_f32_16x16x32_bf16 v[84:87], v[136:139], a[196:199], v[84:87]
  ds_read_b64_tr_b16 v[134:135], v229 offset:26624
  v_mfma_f32_16x16x32_bf16 v[88:91], v[140:143], a[192:195], v[88:91]
  ds_read_b64_tr_b16 v[136:137], v230 offset:24576
  v_mfma_f32_16x16x32_bf16 v[92:95], v[140:143], a[196:199], v[92:95]
  buffer_load_dwordx4 a[0:3], v251, s[4:7], s51 offen offset:2048 sc1
  ds_read_b64_tr_b16 v[138:139], v230 offset:26624
  s_waitcnt lgkmcnt(10)
  v_mfma_f32_16x16x32_bf16 v[32:35], v[112:115], a[200:203], v[32:35]
  ds_read_b64_tr_b16 v[140:141], v231 offset:24576
  v_mfma_f32_16x16x32_bf16 v[36:39], v[112:115], a[204:207], v[36:39]
  ds_read_b64_tr_b16 v[142:143], v231 offset:26624
  s_nop 0
  buffer_load_dwordx4 a[4:7], v251, s[4:7], s51 offen offset:3072 sc1
  s_cmp_eq_u32 s39, 5
  s_cselect_b32 s3, 3670016, 0
  s_sub_u32 s86, s86, s3
  s_sub_u32 s87, s87, s3
  s_add_u32 s50, s86, 1179648
  s_add_u32 m0, s49, 4096
  v_mfma_f32_16x16x32_bf16 v[40:43], v[116:119], a[200:203], v[40:43]
  ds_read_b64_tr_b16 v[112:113], v228 offset:28672
  v_mfma_f32_16x16x32_bf16 v[44:47], v[116:119], a[204:207], v[44:47]
  buffer_load_dwordx4 v241, s[16:19], s50 offen lds
  ds_read_b64_tr_b16 v[114:115], v228 offset:30720
  s_waitcnt lgkmcnt(10)
  v_mfma_f32_16x16x32_bf16 v[48:51], v[120:123], a[200:203], v[48:51]
  ds_read_b64_tr_b16 v[116:117], v229 offset:28672
  v_mfma_f32_16x16x32_bf16 v[52:55], v[120:123], a[204:207], v[52:55]
  ds_read_b64_tr_b16 v[118:119], v229 offset:30720
  s_add_u32 s51, s46, 26624
  v_mfma_f32_16x16x32_bf16 v[56:59], v[124:127], a[200:203], v[56:59]
  ds_read_b64_tr_b16 v[120:121], v230 offset:28672
  v_mfma_f32_16x16x32_bf16 v[60:63], v[124:127], a[204:207], v[60:63]
  buffer_load_dwordx4 a[8:11], v251, s[4:7], s51 offen offset:0 sc1
  ds_read_b64_tr_b16 v[122:123], v230 offset:30720
  s_waitcnt lgkmcnt(10)
  v_mfma_f32_16x16x32_bf16 v[64:67], v[128:131], a[200:203], v[64:67]
  ds_read_b64_tr_b16 v[124:125], v231 offset:28672
  v_mfma_f32_16x16x32_bf16 v[68:71], v[128:131], a[204:207], v[68:71]
  ds_read_b64_tr_b16 v[126:127], v231 offset:30720
  s_nop 0
  buffer_load_dwordx4 a[12:15], v251, s[4:7], s51 offen offset:1024 sc1
  s_add_u32 s50, s86, 1245184
  s_add_u32 m0, s49, 8192
  v_mfma_f32_16x16x32_bf16 v[72:75], v[132:135], a[200:203], v[72:75]
  ds_read_b64_tr_b16 v[128:129], v228 offset:32768
  v_mfma_f32_16x16x32_bf16 v[76:79], v[132:135], a[204:207], v[76:79]
  buffer_load_dwordx4 v241, s[16:19], s50 offen lds
  ds_read_b64_tr_b16 v[130:131], v228 offset:34816
  s_waitcnt lgkmcnt(10)
  v_mfma_f32_16x16x32_bf16 v[80:83], v[136:139], a[200:203], v[80:83]
  ds_read_b64_tr_b16 v[132:133], v229 offset:32768
  v_mfma_f32_16x16x32_bf16 v[84:87], v[136:139], a[204:207], v[84:87]
  ds_read_b64_tr_b16 v[134:135], v229 offset:34816
  s_cmp_eq_u32 s39, 5
  s_cselect_b32 s3, 114688, 0
  s_sub_u32 s46, s46, s3
  s_add_u32 s51, s46, 36864
  v_mfma_f32_16x16x32_bf16 v[88:91], v[140:143], a[200:203], v[88:91]
  ds_read_b64_tr_b16 v[136:137], v230 offset:32768
  v_mfma_f32_16x16x32_bf16 v[92:95], v[140:143], a[204:207], v[92:95]
  buffer_load_dwordx4 a[16:19], v251, s[4:7], s51 offen offset:0 sc1
  ds_read_b64_tr_b16 v[138:139], v230 offset:34816
  s_waitcnt vmcnt(45) lgkmcnt(10)
  v_mfma_f32_16x16x32_bf16 v[32:35], v[112:115], a[208:211], v[32:35]
  ds_read_b64_tr_b16 v[140:141], v231 offset:32768
  v_mfma_f32_16x16x32_bf16 v[36:39], v[112:115], a[212:215], v[36:39]
  ds_read_b64_tr_b16 v[142:143], v231 offset:34816
  s_nop 0
  buffer_load_dwordx4 a[20:23], v251, s[4:7], s51 offen offset:1024 sc1
  s_add_u32 s50, s86, 1310720
  s_add_u32 m0, s49, 12288
  v_mfma_f32_16x16x32_bf16 v[40:43], v[116:119], a[208:211], v[40:43]
  buffer_load_dwordx4 v241, s[16:19], s50 offen lds
  s_waitcnt vmcnt(27)
  s_barrier
  ds_read_b64_tr_b16 v[112:113], v228 offset:36864
  v_mfma_f32_16x16x32_bf16 v[44:47], v[116:119], a[212:215], v[44:47]
  ds_read_b64_tr_b16 v[114:115], v228 offset:38912
  s_waitcnt lgkmcnt(10)
  v_mfma_f32_16x16x32_bf16 v[48:51], v[120:123], a[208:211], v[48:51]
  ds_read_b64_tr_b16 v[116:117], v229 offset:36864
  v_mfma_f32_16x16x32_bf16 v[52:55], v[120:123], a[212:215], v[52:55]
  ds_read_b64_tr_b16 v[118:119], v229 offset:38912
  v_mfma_f32_16x16x32_bf16 v[56:59], v[124:127], a[208:211], v[56:59]
  ds_read_b64_tr_b16 v[120:121], v230 offset:36864
  v_mfma_f32_16x16x32_bf16 v[60:63], v[124:127], a[212:215], v[60:63]
  buffer_load_dwordx4 a[24:27], v251, s[4:7], s51 offen offset:2048 sc1
  ds_read_b64_tr_b16 v[122:123], v230 offset:38912
  s_waitcnt lgkmcnt(10)
  v_mfma_f32_16x16x32_bf16 v[64:67], v[128:131], a[208:211], v[64:67]
  ds_read_b64_tr_b16 v[124:125], v231 offset:36864
  v_mfma_f32_16x16x32_bf16 v[68:71], v[128:131], a[212:215], v[68:71]
  ds_read_b64_tr_b16 v[126:127], v231 offset:38912
  s_nop 0
  buffer_load_dwordx4 a[28:31], v251, s[4:7], s51 offen offset:3072 sc1
  s_cmp_eq_u32 s39, 4
  s_cselect_b32 s3, 3670016, 0
  s_sub_u32 s86, s86, s3
  s_sub_u32 s87, s87, s3
  s_add_u32 s50, s87, 1638400
  s_add_u32 m0, s49, 16384
  v_mfma_f32_16x16x32_bf16 v[72:75], v[132:135], a[208:211], v[72:75]
  ds_read_b64_tr_b16 v[128:129], v228 offset:40960
  v_mfma_f32_16x16x32_bf16 v[76:79], v[132:135], a[212:215], v[76:79]
  buffer_load_dwordx4 v241, s[16:19], s50 offen lds
  ds_read_b64_tr_b16 v[130:131], v228 offset:43008
  s_waitcnt lgkmcnt(10)
  v_mfma_f32_16x16x32_bf16 v[80:83], v[136:139], a[208:211], v[80:83]
  ds_read_b64_tr_b16 v[132:133], v229 offset:40960
  v_mfma_f32_16x16x32_bf16 v[84:87], v[136:139], a[212:215], v[84:87]
  ds_read_b64_tr_b16 v[134:135], v229 offset:43008
  s_add_u32 s51, s46, 40960
  v_mfma_f32_16x16x32_bf16 v[88:91], v[140:143], a[208:211], v[88:91]
  ds_read_b64_tr_b16 v[136:137], v230 offset:40960
  v_mfma_f32_16x16x32_bf16 v[92:95], v[140:143], a[212:215], v[92:95]
  buffer_load_dwordx4 a[32:35], v251, s[4:7], s51 offen offset:0 sc1
  ds_read_b64_tr_b16 v[138:139], v230 offset:43008
  s_waitcnt lgkmcnt(10)
  v_mfma_f32_16x16x32_bf16 v[32:35], v[112:115], a[216:219], v[32:35]
  ds_read_b64_tr_b16 v[140:141], v231 offset:40960
  v_mfma_f32_16x16x32_bf16 v[36:39], v[112:115], a[220:223], v[36:39]
  ds_read_b64_tr_b16 v[142:143], v231 offset:43008
  s_nop 0
  buffer_load_dwordx4 a[36:39], v251, s[4:7], s51 offen offset:1024 sc1
  s_add_u32 s50, s87, 1703936
  s_add_u32 m0, s49, 20480
  v_mfma_f32_16x16x32_bf16 v[40:43], v[116:119], a[216:219], v[40:43]
  ds_read_b64_tr_b16 v[112:113], v228 offset:45056
  v_mfma_f32_16x16x32_bf16 v[44:47], v[116:119], a[220:223], v[44:47]
  buffer_load_dwordx4 v241, s[16:19], s50 offen lds
  ds_read_b64_tr_b16 v[114:115], v228 offset:47104
  s_waitcnt lgkmcnt(10)
  v_mfma_f32_16x16x32_bf16 v[48:51], v[120:123], a[216:219], v[48:51]
  ds_read_b64_tr_b16 v[116:117], v229 offset:45056
  v_mfma_f32_16x16x32_bf16 v[52:55], v[120:123], a[220:223], v[52:55]
  ds_read_b64_tr_b16 v[118:119], v229 offset:47104
  s_cmp_eq_u32 s39, 4
  s_cselect_b32 s3, 114688, 0
  s_sub_u32 s46, s46, s3
  s_add_u32 s51, s46, 51200
  v_mfma_f32_16x16x32_bf16 v[56:59], v[124:127], a[216:219], v[56:59]
  ds_read_b64_tr_b16 v[120:121], v230 offset:45056
  v_mfma_f32_16x16x32_bf16 v[60:63], v[124:127], a[220:223], v[60:63]
  buffer_load_dwordx4 a[40:43], v251, s[4:7], s51 offen offset:0 sc1
  ds_read_b64_tr_b16 v[122:123], v230 offset:47104
  s_waitcnt lgkmcnt(10)
  v_mfma_f32_16x16x32_bf16 v[64:67], v[128:131], a[216:219], v[64:67]
  ds_read_b64_tr_b16 v[124:125], v231 offset:45056
  v_mfma_f32_16x16x32_bf16 v[68:71], v[128:131], a[220:223], v[68:71]
  ds_read_b64_tr_b16 v[126:127], v231 offset:47104
  s_nop 0
  buffer_load_dwordx4 a[44:47], v251, s[4:7], s51 offen offset:1024 sc1
  s_add_u32 s50, s87, 1769472
  s_add_u32 m0, s49, 24576
  v_mfma_f32_16x16x32_bf16 v[72:75], v[132:135], a[216:219], v[72:75]
  ds_read_b64_tr_b16 v[128:129], v228 offset:49152
  v_mfma_f32_16x16x32_bf16 v[76:79], v[132:135], a[220:223], v[76:79]
  buffer_load_dwordx4 v241, s[16:19], s50 offen lds
  ds_read_b64_tr_b16 v[130:131], v228 offset:51200
  s_waitcnt lgkmcnt(10)
  v_mfma_f32_16x16x32_bf16 v[80:83], v[136:139], a[216:219], v[80:83]
  ds_read_b64_tr_b16 v[132:133], v229 offset:49152
  v_mfma_f32_16x16x32_bf16 v[84:87], v[136:139], a[220:223], v[84:87]
  ds_read_b64_tr_b16 v[134:135], v229 offset:51200
  v_mfma_f32_16x16x32_bf16 v[88:91], v[140:143], a[216:219], v[88:91]
  ds_read_b64_tr_b16 v[136:137], v230 offset:49152
  v_mfma_f32_16x16x32_bf16 v[92:95], v[140:143], a[220:223], v[92:95]
  buffer_load_dwordx4 a[48:51], v251, s[4:7], s51 offen offset:2048 sc1
  ds_read_b64_tr_b16 v[138:139], v230 offset:51200
  s_waitcnt vmcnt(32) lgkmcnt(10)
  v_mfma_f32_16x16x32_bf16 v[32:35], v[112:115], a[224:227], v[32:35]
  ds_read_b64_tr_b16 v[140:141], v231 offset:49152
  v_mfma_f32_16x16x32_bf16 v[36:39], v[112:115], a[228:231], v[36:39]
  ds_read_b64_tr_b16 v[142:143], v231 offset:51200
  s_nop 0
  buffer_load_dwordx4 a[52:55], v251, s[4:7], s51 offen offset:3072 sc1
  s_cmp_eq_u32 s39, 3
  s_cselect_b32 s3, 3670016, 0
  s_sub_u32 s86, s86, s3
  s_sub_u32 s87, s87, s3
  s_add_u32 s50, s86, 2097152
  s_add_u32 m0, s49, 28672
  v_mfma_f32_16x16x32_bf16 v[40:43], v[116:119], a[224:227], v[40:43]
  buffer_load_dwordx4 v241, s[16:19], s50 offen lds
  s_waitcnt vmcnt(21)
  s_barrier
  ds_read_b64_tr_b16 v[112:113], v228 offset:53248
  v_mfma_f32_16x16x32_bf16 v[44:47], v[116:119], a[228:231], v[44:47]
  ds_read_b64_tr_b16 v[114:115], v228 offset:55296
  s_waitcnt lgkmcnt(10)
  v_mfma_f32_16x16x32_bf16 v[48:51], v[120:123], a[224:227], v[48:51]
  ds_read_b64_tr_b16 v[116:117], v229 offset:53248
  v_mfma_f32_16x16x32_bf16 v[52:55], v[120:123], a[228:231], v[52:55]
  ds_read_b64_tr_b16 v[118:119], v229 offset:55296
  s_add_u32 s51, s46, 55296
  v_mfma_f32_16x16x32_bf16 v[56:59], v[124:127], a[224:227], v[56:59]
  ds_read_b64_tr_b16 v[120:121], v230 offset:53248
  v_mfma_f32_16x16x32_bf16 v[60:63], v[124:127], a[228:231], v[60:63]
  buffer_load_dwordx4 a[56:59], v251, s[4:7], s51 offen offset:0 sc1
  ds_read_b64_tr_b16 v[122:123], v230 offset:55296
  s_waitcnt lgkmcnt(10)
  v_mfma_f32_16x16x32_bf16 v[32:35], v[128:131], a[232:235], v[32:35]
  ds_read_b64_tr_b16 v[124:125], v231 offset:53248
  v_mfma_f32_16x16x32_bf16 v[36:39], v[128:131], a[236:239], v[36:39]
  ds_read_b64_tr_b16 v[126:127], v231 offset:55296
  s_nop 0
  buffer_load_dwordx4 a[60:63], v251, s[4:7], s51 offen offset:1024 sc1
  s_add_u32 s50, s86, 2162688
  s_add_u32 m0, s49, 32768
  v_mfma_f32_16x16x32_bf16 v[40:43], v[132:135], a[232:235], v[40:43]
  ds_read_b64_tr_b16 v[128:129], v228 offset:57344
  v_mfma_f32_16x16x32_bf16 v[44:47], v[132:135], a[236:239], v[44:47]
  buffer_load_dwordx4 v241, s[16:19], s50 offen lds
  ds_read_b64_tr_b16 v[130:131], v228 offset:59392
  s_waitcnt lgkmcnt(10)
  v_mfma_f32_16x16x32_bf16 v[48:51], v[136:139], a[232:235], v[48:51]
  ds_read_b64_tr_b16 v[132:133], v229 offset:57344
  v_mfma_f32_16x16x32_bf16 v[52:55], v[136:139], a[236:239], v[52:55]
  ds_read_b64_tr_b16 v[134:135], v229 offset:59392
  s_cmp_eq_u32 s39, 3
  s_cselect_b32 s3, 114688, 0
  s_sub_u32 s46, s46, s3
  s_add_u32 s51, s46, 65536
  v_mfma_f32_16x16x32_bf16 v[56:59], v[140:143], a[232:235], v[56:59]
  ds_read_b64_tr_b16 v[136:137], v230 offset:57344
  v_mfma_f32_16x16x32_bf16 v[60:63], v[140:143], a[236:239], v[60:63]
  buffer_load_dwordx4 a[64:67], v251, s[4:7], s51 offen offset:0 sc1
  ds_read_b64_tr_b16 v[138:139], v230 offset:59392
  s_waitcnt lgkmcnt(10)
  v_mfma_f32_16x16x32_bf16 v[32:35], v[112:115], a[240:243], v[32:35]
  ds_read_b64_tr_b16 v[140:141], v231 offset:57344
  v_mfma_f32_16x16x32_bf16 v[36:39], v[112:115], a[244:247], v[36:39]
  ds_read_b64_tr_b16 v[142:143], v231 offset:59392
  s_nop 0
  buffer_load_dwordx4 a[68:71], v251, s[4:7], s51 offen offset:1024 sc1
  s_add_u32 s50, s86, 2228224
  s_add_u32 m0, s49, 36864
  v_mfma_f32_16x16x32_bf16 v[40:43], v[116:119], a[240:243], v[40:43]
  ds_read_b64_tr_b16 v[112:113], v228 offset:61440
  v_mfma_f32_16x16x32_bf16 v[44:47], v[116:119], a[244:247], v[44:47]
  buffer_load_dwordx4 v241, s[16:19], s50 offen lds
  ds_read_b64_tr_b16 v[114:115], v228 offset:63488
  s_waitcnt lgkmcnt(10)
  v_mfma_f32_16x16x32_bf16 v[48:51], v[120:123], a[240:243], v[48:51]
  ds_read_b64_tr_b16 v[116:117], v229 offset:61440
  v_mfma_f32_16x16x32_bf16 v[52:55], v[120:123], a[244:247], v[52:55]
  ds_read_b64_tr_b16 v[118:119], v229 offset:63488
  v_mfma_f32_16x16x32_bf16 v[56:59], v[124:127], a[240:243], v[56:59]
  ds_read_b64_tr_b16 v[120:121], v230 offset:61440
  v_mfma_f32_16x16x32_bf16 v[60:63], v[124:127], a[244:247], v[60:63]
  buffer_load_dwordx4 a[72:75], v251, s[4:7], s51 offen offset:2048 sc1
  ds_read_b64_tr_b16 v[122:123], v230 offset:63488
  s_waitcnt lgkmcnt(10)
  v_mfma_f32_16x16x32_bf16 v[32:35], v[128:131], a[248:251], v[32:35]
  ds_read_b64_tr_b16 v[124:125], v231 offset:61440
  v_mfma_f32_16x16x32_bf16 v[36:39], v[128:131], a[252:255], v[36:39]
  ds_read_b64_tr_b16 v[126:127], v231 offset:63488
  s_nop 0
  buffer_load_dwordx4 a[76:79], v251, s[4:7], s51 offen offset:3072 sc1
  s_cmp_eq_u32 s39, 2
  s_cselect_b32 s3, 3670016, 0
  s_sub_u32 s86, s86, s3
  s_sub_u32 s87, s87, s3
  s_add_u32 s50, s87, 2555904
  s_add_u32 m0, s49, 40960
  v_mfma_f32_16x16x32_bf16 v[40:43], v[132:135], a[248:251], v[40:43]
  ds_read_b64_tr_b16 v[128:129], v224 offset:0
  v_mfma_f32_16x16x32_bf16 v[44:47], v[132:135], a[252:255], v[44:47]
  buffer_load_dwordx4 v241, s[16:19], s50 offen lds
  ds_read_b64_tr_b16 v[130:131], v224 offset:2048
  s_waitcnt lgkmcnt(10)
  v_mfma_f32_16x16x32_bf16 v[48:51], v[136:139], a[248:251], v[48:51]
  ds_read_b64_tr_b16 v[132:133], v225 offset:0
  v_mfma_f32_16x16x32_bf16 v[52:55], v[136:139], a[252:255], v[52:55]
  ds_read_b64_tr_b16 v[134:135], v225 offset:2048
  s_add_u32 s51, s46, 69632
  v_mfma_f32_16x16x32_bf16 v[56:59], v[140:143], a[248:251], v[56:59]
  ds_read_b64_tr_b16 v[136:137], v226 offset:0
  v_mfma_f32_16x16x32_bf16 v[60:63], v[140:143], a[252:255], v[60:63]
  buffer_load_dwordx4 a[80:83], v251, s[4:7], s51 offen offset:0 sc1
  ds_read_b64_tr_b16 v[138:139], v226 offset:2048
  s_waitcnt vmcnt(29) lgkmcnt(10)
  v_mfma_f32_16x16x32_bf16 v[32:35], v[112:115], a[0:3], v[32:35]
  ds_read_b64_tr_b16 v[140:141], v227 offset:0
  v_mfma_f32_16x16x32_bf16 v[36:39], v[112:115], a[4:7], v[36:39]
  ds_read_b64_tr_b16 v[142:143], v227 offset:2048
  s_nop 0
  buffer_load_dwordx4 a[84:87], v251, s[4:7], s51 offen offset:1024 sc1
  s_add_u32 s50, s87, 2621440
  s_add_u32 m0, s49, 45056
  v_mfma_f32_16x16x32_bf16 v[40:43], v[116:119], a[0:3], v[40:43]
  buffer_load_dwordx4 v241, s[16:19], s50 offen lds
  s_waitcnt vmcnt(21)
  s_barrier
  ds_read_b64_tr_b16 v[112:113], v224 offset:4096
  v_mfma_f32_16x16x32_bf16 v[44:47], v[116:119], a[4:7], v[44:47]
  ds_read_b64_tr_b16 v[114:115], v224 offset:6144
  s_waitcnt lgkmcnt(10)
  v_mfma_f32_16x16x32_bf16 v[48:51], v[120:123], a[0:3], v[48:51]
  ds_read_b64_tr_b16 v[116:117], v225 offset:4096
  v_mfma_f32_16x16x32_bf16 v[52:55], v[120:123], a[4:7], v[52:55]
  ds_read_b64_tr_b16 v[118:119], v225 offset:6144
  s_cmp_eq_u32 s39, 2
  s_cselect_b32 s3, 114688, 0
  s_sub_u32 s46, s46, s3
  s_add_u32 s51, s46, 79872
  v_mfma_f32_16x16x32_bf16 v[56:59], v[124:127], a[0:3], v[56:59]
  ds_read_b64_tr_b16 v[120:121], v226 offset:4096
  v_mfma_f32_16x16x32_bf16 v[60:63], v[124:127], a[4:7], v[60:63]
  buffer_load_dwordx4 a[88:91], v251, s[4:7], s51 offen offset:0 sc1
  ds_read_b64_tr_b16 v[122:123], v226 offset:6144
  s_waitcnt lgkmcnt(10)
  v_mfma_f32_16x16x32_bf16 v[32:35], v[128:131], a[8:11], v[32:35]
  ds_read_b64_tr_b16 v[124:125], v227 offset:4096
  v_mfma_f32_16x16x32_bf16 v[36:39], v[128:131], a[12:15], v[36:39]
  ds_read_b64_tr_b16 v[126:127], v227 offset:6144
  s_nop 0
  buffer_load_dwordx4 a[92:95], v251, s[4:7], s51 offen offset:1024 sc1
  s_add_u32 s50, s87, 2686976
  s_add_u32 m0, s49, 49152
  v_mfma_f32_16x16x32_bf16 v[40:43], v[132:135], a[8:11], v[40:43]
  ds_read_b64_tr_b16 v[128:129], v224 offset:8192
  v_mfma_f32_16x16x32_bf16 v[44:47], v[132:135], a[12:15], v[44:47]
  buffer_load_dwordx4 v241, s[16:19], s50 offen lds
  ds_read_b64_tr_b16 v[130:131], v224 offset:10240
  s_waitcnt lgkmcnt(10)
  v_mfma_f32_16x16x32_bf16 v[48:51], v[136:139], a[8:11], v[48:51]
  ds_read_b64_tr_b16 v[132:133], v225 offset:8192
  v_mfma_f32_16x16x32_bf16 v[52:55], v[136:139], a[12:15], v[52:55]
  ds_read_b64_tr_b16 v[134:135], v225 offset:10240
  v_mfma_f32_16x16x32_bf16 v[56:59], v[140:143], a[8:11], v[56:59]
  ds_read_b64_tr_b16 v[136:137], v226 offset:8192
  v_mfma_f32_16x16x32_bf16 v[60:63], v[140:143], a[12:15], v[60:63]
  buffer_load_dwordx4 a[96:99], v251, s[4:7], s51 offen offset:2048 sc1
  ds_read_b64_tr_b16 v[138:139], v226 offset:10240
  s_waitcnt lgkmcnt(10)
  v_mfma_f32_16x16x32_bf16 v[32:35], v[112:115], a[16:19], v[32:35]
  ds_read_b64_tr_b16 v[140:141], v227 offset:8192
  v_mfma_f32_16x16x32_bf16 v[36:39], v[112:115], a[20:23], v[36:39]
  ds_read_b64_tr_b16 v[142:143], v227 offset:10240
  s_nop 0
  buffer_load_dwordx4 a[100:103], v251, s[4:7], s51 offen offset:3072 sc1
  s_cmp_eq_u32 s39, 1
  s_cselect_b32 s3, 3670016, 0
  s_sub_u32 s86, s86, s3
  s_sub_u32 s87, s87, s3
  s_add_u32 s50, s86, 3014656
  s_add_u32 m0, s49, 53248
  v_mfma_f32_16x16x32_bf16 v[40:43], v[116:119], a[16:19], v[40:43]
  ds_read_b64_tr_b16 v[112:113], v224 offset:12288
  v_mfma_f32_16x16x32_bf16 v[44:47], v[116:119], a[20:23], v[44:47]
  buffer_load_dwordx4 v241, s[16:19], s50 offen lds
  ds_read_b64_tr_b16 v[114:115], v224 offset:14336
  s_waitcnt lgkmcnt(10)
  v_mfma_f32_16x16x32_bf16 v[48:51], v[120:123], a[16:19], v[48:51]
  ds_read_b64_tr_b16 v[116:117], v225 offset:12288
  v_mfma_f32_16x16x32_bf16 v[52:55], v[120:123], a[20:23], v[52:55]
  ds_read_b64_tr_b16 v[118:119], v225 offset:14336
  s_add_u32 s51, s46, 83968
  v_mfma_f32_16x16x32_bf16 v[56:59], v[124:127], a[16:19], v[56:59]
  ds_read_b64_tr_b16 v[120:121], v226 offset:12288
  v_mfma_f32_16x16x32_bf16 v[60:63], v[124:127], a[20:23], v[60:63]
  buffer_load_dwordx4 a[104:107], v251, s[4:7], s51 offen offset:0 sc1
  ds_read_b64_tr_b16 v[122:123], v226 offset:14336
  s_waitcnt lgkmcnt(10)
  v_mfma_f32_16x16x32_bf16 v[32:35], v[128:131], a[24:27], v[32:35]
  ds_read_b64_tr_b16 v[124:125], v227 offset:12288
  v_mfma_f32_16x16x32_bf16 v[36:39], v[128:131], a[28:31], v[36:39]
  ds_read_b64_tr_b16 v[126:127], v227 offset:14336
  s_nop 0
  buffer_load_dwordx4 a[108:111], v251, s[4:7], s51 offen offset:1024 sc1
  s_add_u32 s50, s86, 3080192
  s_add_u32 m0, s49, 57344
  v_mfma_f32_16x16x32_bf16 v[40:43], v[132:135], a[24:27], v[40:43]
  ds_read_b64_tr_b16 v[128:129], v224 offset:16384
  v_mfma_f32_16x16x32_bf16 v[44:47], v[132:135], a[28:31], v[44:47]
  buffer_load_dwordx4 v241, s[16:19], s50 offen lds
  ds_read_b64_tr_b16 v[130:131], v224 offset:18432
  s_waitcnt lgkmcnt(10)
  v_mfma_f32_16x16x32_bf16 v[48:51], v[136:139], a[24:27], v[48:51]
  ds_read_b64_tr_b16 v[132:133], v225 offset:16384
  v_mfma_f32_16x16x32_bf16 v[52:55], v[136:139], a[28:31], v[52:55]
  ds_read_b64_tr_b16 v[134:135], v225 offset:18432
  s_cmp_eq_u32 s39, 1
  s_cselect_b32 s3, 114688, 0
  s_sub_u32 s46, s46, s3
  s_add_u32 s51, s46, 94208
  v_mfma_f32_16x16x32_bf16 v[56:59], v[140:143], a[24:27], v[56:59]
  ds_read_b64_tr_b16 v[136:137], v226 offset:16384
  v_mfma_f32_16x16x32_bf16 v[60:63], v[140:143], a[28:31], v[60:63]
  buffer_load_dwordx4 a[112:115], v251, s[4:7], s51 offen offset:0 sc1
  ds_read_b64_tr_b16 v[138:139], v226 offset:18432
  s_waitcnt vmcnt(29) lgkmcnt(10)
  v_mfma_f32_16x16x32_bf16 v[32:35], v[112:115], a[32:35], v[32:35]
  ds_read_b64_tr_b16 v[140:141], v227 offset:16384
  v_mfma_f32_16x16x32_bf16 v[36:39], v[112:115], a[36:39], v[36:39]
  ds_read_b64_tr_b16 v[142:143], v227 offset:18432
  s_nop 0
  buffer_load_dwordx4 a[116:119], v251, s[4:7], s51 offen offset:1024 sc1
  s_add_u32 s50, s86, 3145728
  s_add_u32 m0, s49, 61440
  v_mfma_f32_16x16x32_bf16 v[40:43], v[116:119], a[32:35], v[40:43]
  buffer_load_dwordx4 v241, s[16:19], s50 offen lds
  s_waitcnt vmcnt(21)
  s_barrier
  ds_read_b64_tr_b16 v[112:113], v224 offset:20480
  v_mfma_f32_16x16x32_bf16 v[44:47], v[116:119], a[36:39], v[44:47]
  ds_read_b64_tr_b16 v[114:115], v224 offset:22528
  s_waitcnt lgkmcnt(10)
  v_mfma_f32_16x16x32_bf16 v[48:51], v[120:123], a[32:35], v[48:51]
  ds_read_b64_tr_b16 v[116:117], v225 offset:20480
  v_mfma_f32_16x16x32_bf16 v[52:55], v[120:123], a[36:39], v[52:55]
  ds_read_b64_tr_b16 v[118:119], v225 offset:22528
  v_mfma_f32_16x16x32_bf16 v[56:59], v[124:127], a[32:35], v[56:59]
  ds_read_b64_tr_b16 v[120:121], v226 offset:20480
  v_mfma_f32_16x16x32_bf16 v[60:63], v[124:127], a[36:39], v[60:63]
  buffer_load_dwordx4 a[120:123], v251, s[4:7], s51 offen offset:2048 sc1
  ds_read_b64_tr_b16 v[122:123], v226 offset:22528
  s_waitcnt lgkmcnt(10)
  v_mfma_f32_16x16x32_bf16 v[32:35], v[128:131], a[40:43], v[32:35]
  ds_read_b64_tr_b16 v[124:125], v227 offset:20480
  v_mfma_f32_16x16x32_bf16 v[36:39], v[128:131], a[44:47], v[36:39]
  ds_read_b64_tr_b16 v[126:127], v227 offset:22528
  s_nop 0
  buffer_load_dwordx4 a[124:127], v251, s[4:7], s51 offen offset:3072 sc1
  s_mul_i32 s98, s39, 458752
  s_add_u32 s98, s98, 458752
  s_bitcmp1_b32 s39, 0
  s_cselect_b32 s3, 4294705152, 0
  s_cselect_b32 s48, 0, 4294705152
  s_add_u32 s99, s98, s3
  s_add_u32 s98, s98, s48
  s_cmp_eq_u32 s39, 7
  s_cselect_b32 s3, 3670016, 0
  s_sub_u32 s98, s98, s3
  s_sub_u32 s99, s99, s3
  s_add_u32 s50, s98, 262144
  s_add_u32 m0, s49, 65536
  v_mfma_f32_16x16x32_bf16 v[40:43], v[132:135], a[40:43], v[40:43]
  ds_read_b64_tr_b16 v[128:129], v224 offset:24576
  v_mfma_f32_16x16x32_bf16 v[44:47], v[132:135], a[44:47], v[44:47]
  buffer_load_dwordx4 v241, s[28:31], s50 offen lds
  ds_read_b64_tr_b16 v[130:131], v224 offset:26624
  s_waitcnt lgkmcnt(10)
  v_mfma_f32_16x16x32_bf16 v[48:51], v[136:139], a[40:43], v[48:51]
  ds_read_b64_tr_b16 v[132:133], v225 offset:24576
  v_mfma_f32_16x16x32_bf16 v[52:55], v[136:139], a[44:47], v[52:55]
  ds_read_b64_tr_b16 v[134:135], v225 offset:26624
  s_add_u32 s51, s46, 98304
  v_mfma_f32_16x16x32_bf16 v[56:59], v[140:143], a[40:43], v[56:59]
  ds_read_b64_tr_b16 v[136:137], v226 offset:24576
  v_mfma_f32_16x16x32_bf16 v[60:63], v[140:143], a[44:47], v[60:63]
  buffer_load_dwordx4 a[128:131], v251, s[4:7], s51 offen offset:0 sc1
  ds_read_b64_tr_b16 v[138:139], v226 offset:26624
  s_waitcnt lgkmcnt(10)
  v_mfma_f32_16x16x32_bf16 v[32:35], v[112:115], a[48:51], v[32:35]
  ds_read_b64_tr_b16 v[140:141], v227 offset:24576
  v_mfma_f32_16x16x32_bf16 v[36:39], v[112:115], a[52:55], v[36:39]
  ds_read_b64_tr_b16 v[142:143], v227 offset:26624
  s_nop 0
  buffer_load_dwordx4 a[132:135], v251, s[4:7], s51 offen offset:1024 sc1
  s_add_u32 s50, s98, 327680
  s_add_u32 m0, s49, 69632
  v_mfma_f32_16x16x32_bf16 v[40:43], v[116:119], a[48:51], v[40:43]
  ds_read_b64_tr_b16 v[112:113], v224 offset:28672
  v_mfma_f32_16x16x32_bf16 v[44:47], v[116:119], a[52:55], v[44:47]
  buffer_load_dwordx4 v241, s[28:31], s50 offen lds
  ds_read_b64_tr_b16 v[114:115], v224 offset:30720
  s_waitcnt lgkmcnt(10)
  v_mfma_f32_16x16x32_bf16 v[48:51], v[120:123], a[48:51], v[48:51]
  ds_read_b64_tr_b16 v[116:117], v225 offset:28672
  v_mfma_f32_16x16x32_bf16 v[52:55], v[120:123], a[52:55], v[52:55]
  ds_read_b64_tr_b16 v[118:119], v225 offset:30720
  s_add_u32 s50, s98, 393216
  s_add_u32 m0, s49, 73728
  v_mfma_f32_16x16x32_bf16 v[56:59], v[124:127], a[48:51], v[56:59]
  ds_read_b64_tr_b16 v[120:121], v226 offset:28672
  v_mfma_f32_16x16x32_bf16 v[60:63], v[124:127], a[52:55], v[60:63]
  buffer_load_dwordx4 v241, s[28:31], s50 offen lds
  ds_read_b64_tr_b16 v[122:123], v226 offset:30720
  s_waitcnt lgkmcnt(10)
  v_mfma_f32_16x16x32_bf16 v[32:35], v[128:131], a[56:59], v[32:35]
  ds_read_b64_tr_b16 v[124:125], v227 offset:28672
  v_mfma_f32_16x16x32_bf16 v[36:39], v[128:131], a[60:63], v[36:39]
  ds_read_b64_tr_b16 v[126:127], v227 offset:30720
  v_mfma_f32_16x16x32_bf16 v[40:43], v[132:135], a[56:59], v[40:43]
  ds_read_b64_tr_b16 v[128:129], v224 offset:32768
  v_mfma_f32_16x16x32_bf16 v[44:47], v[132:135], a[60:63], v[44:47]
  ds_read_b64_tr_b16 v[130:131], v224 offset:34816
  s_cmp_lt_u32 s57, 8
  s_cbranch_scc1 sequential_preLN__spectral_fnet__dense_activation_squared_relu__prompt_kernel_hfix21
  s_mov_b32 s3, 0x07060100
  v_perm_b32 v216, v201, v216, s3
  v_perm_b32 v201, v200, v201, s3
  v_mov_b32 v200, v216
  v_perm_b32 v217, v203, v217, s3
  v_perm_b32 v203, v202, v203, s3
  v_mov_b32 v202, v217
  v_perm_b32 v218, v205, v218, s3
  v_perm_b32 v205, v204, v205, s3
  v_mov_b32 v204, v218
  v_perm_b32 v219, v207, v219, s3
  v_perm_b32 v207, v206, v207, s3
  v_mov_b32 v206, v219
  v_perm_b32 v220, v209, v220, s3
  v_perm_b32 v209, v208, v209, s3
  v_mov_b32 v208, v220
  v_perm_b32 v221, v211, v221, s3
  v_perm_b32 v211, v210, v211, s3
  v_mov_b32 v210, v221
  v_perm_b32 v222, v213, v222, s3
  v_perm_b32 v213, v212, v213, s3
  v_mov_b32 v212, v222
  v_perm_b32 v223, v215, v223, s3
  v_perm_b32 v215, v214, v215, s3
  v_mov_b32 v214, v223
  v_swap_b32 v200, v212
  v_swap_b32 v201, v213
  v_swap_b32 v202, v214
  v_swap_b32 v203, v215
  v_swap_b32 v204, v208
  v_swap_b32 v205, v209
  v_swap_b32 v206, v210
  v_swap_b32 v207, v211
sequential_preLN__spectral_fnet__dense_activation_squared_relu__prompt_kernel_hfix21:
  v_lshl_or_b32 v144, v144, 16, v144
  s_waitcnt lgkmcnt(10)
  v_mfma_f32_16x16x32_bf16 v[48:51], v[136:139], a[56:59], v[48:51]
  ds_read_b64_tr_b16 v[132:133], v225 offset:32768
  v_mfma_f32_16x16x32_bf16 v[52:55], v[136:139], a[60:63], v[52:55]
  ds_read_b64_tr_b16 v[134:135], v225 offset:34816
  v_lshl_or_b32 v146, v146, 16, v146
  s_cmp_eq_u32 s39, 6
  s_cselect_b32 s3, 3670016, 0
  s_sub_u32 s98, s98, s3
  s_sub_u32 s99, s99, s3
  s_add_u32 s50, s99, 720896
  s_add_u32 m0, s49, 77824
  v_mfma_f32_16x16x32_bf16 v[56:59], v[140:143], a[56:59], v[56:59]
  ds_read_b64_tr_b16 v[136:137], v226 offset:32768
  v_mfma_f32_16x16x32_bf16 v[60:63], v[140:143], a[60:63], v[60:63]
  buffer_load_dwordx4 v241, s[28:31], s50 offen lds
  ds_read_b64_tr_b16 v[138:139], v226 offset:34816
  v_lshl_or_b32 v148, v148, 16, v148
  s_waitcnt vmcnt(27) lgkmcnt(10)
  v_mfma_f32_16x16x32_bf16 v[32:35], v[112:115], a[64:67], v[32:35]
  ds_read_b64_tr_b16 v[140:141], v227 offset:32768
  v_mfma_f32_16x16x32_bf16 v[36:39], v[112:115], a[68:71], v[36:39]
  ds_read_b64_tr_b16 v[142:143], v227 offset:34816
  v_lshl_or_b32 v150, v150, 16, v150
  s_add_u32 s50, s99, 786432
  s_add_u32 m0, s49, 81920
  v_mfma_f32_16x16x32_bf16 v[40:43], v[116:119], a[64:67], v[40:43]
  buffer_load_dwordx4 v241, s[28:31], s50 offen lds
  s_waitcnt vmcnt(18)
  s_barrier
  ds_read_b64_tr_b16 v[112:113], v224 offset:36864
  v_mfma_f32_16x16x32_bf16 v[44:47], v[116:119], a[68:71], v[44:47]
  ds_read_b64_tr_b16 v[114:115], v224 offset:38912
  v_mfma_f32_16x16x16_bf16 v[64:67], v[144:145], v[234:235], v[64:67]
  v_mfma_f32_16x16x16_bf16 v[68:71], v[144:145], v[236:237], v[68:71]
  s_waitcnt lgkmcnt(10)
  v_mfma_f32_16x16x32_bf16 v[48:51], v[120:123], a[64:67], v[48:51]
  ds_read_b64_tr_b16 v[116:117], v225 offset:36864
  v_mfma_f32_16x16x32_bf16 v[52:55], v[120:123], a[68:71], v[52:55]
  ds_read_b64_tr_b16 v[118:119], v225 offset:38912
  v_mfma_f32_16x16x16_bf16 v[72:75], v[146:147], v[234:235], v[72:75]
  v_mfma_f32_16x16x16_bf16 v[76:79], v[146:147], v[236:237], v[76:79]
  s_add_u32 s50, s99, 851968
  s_add_u32 m0, s49, 86016
  v_mfma_f32_16x16x32_bf16 v[56:59], v[124:127], a[64:67], v[56:59]
  ds_read_b64_tr_b16 v[120:121], v226 offset:36864
  v_mfma_f32_16x16x32_bf16 v[60:63], v[124:127], a[68:71], v[60:63]
  buffer_load_dwordx4 v241, s[28:31], s50 offen lds
  ds_read_b64_tr_b16 v[122:123], v226 offset:38912
  v_mfma_f32_16x16x16_bf16 v[80:83], v[148:149], v[234:235], v[80:83]
  v_mfma_f32_16x16x16_bf16 v[84:87], v[148:149], v[236:237], v[84:87]
  s_waitcnt lgkmcnt(10)
  v_mfma_f32_16x16x32_bf16 v[32:35], v[128:131], a[72:75], v[32:35]
  ds_read_b64_tr_b16 v[124:125], v227 offset:36864
  v_mfma_f32_16x16x32_bf16 v[36:39], v[128:131], a[76:79], v[36:39]
  ds_read_b64_tr_b16 v[126:127], v227 offset:38912
  v_mfma_f32_16x16x16_bf16 v[88:91], v[150:151], v[234:235], v[88:91]
  v_mfma_f32_16x16x16_bf16 v[92:95], v[150:151], v[236:237], v[92:95]
  s_cmp_eq_u32 s39, 5
  s_cselect_b32 s3, 3670016, 0
  s_sub_u32 s98, s98, s3
  s_sub_u32 s99, s99, s3
  s_add_u32 s50, s98, 1179648
  s_add_u32 m0, s49, 90112
  v_mfma_f32_16x16x32_bf16 v[40:43], v[132:135], a[72:75], v[40:43]
  ds_read_b64_tr_b16 v[128:129], v224 offset:40960
  v_mfma_f32_16x16x32_bf16 v[44:47], v[132:135], a[76:79], v[44:47]
  buffer_load_dwordx4 v241, s[28:31], s50 offen lds
  ds_read_b64_tr_b16 v[130:131], v224 offset:43008
  v_lshlrev_b32 v0, 16, v200
  s_waitcnt lgkmcnt(10)
  v_mfma_f32_16x16x32_bf16 v[48:51], v[136:139], a[72:75], v[48:51]
  ds_read_b64_tr_b16 v[132:133], v225 offset:40960
  v_mfma_f32_16x16x32_bf16 v[52:55], v[136:139], a[76:79], v[52:55]
  ds_read_b64_tr_b16 v[134:135], v225 offset:43008
  v_and_b32 v1, 0xffff0000, v200
  s_add_u32 s50, s98, 1245184
  s_add_u32 m0, s49, 94208
  v_mfma_f32_16x16x32_bf16 v[56:59], v[140:143], a[72:75], v[56:59]
  ds_read_b64_tr_b16 v[136:137], v226 offset:40960
  v_mfma_f32_16x16x32_bf16 v[60:63], v[140:143], a[76:79], v[60:63]
  buffer_load_dwordx4 v241, s[28:31], s50 offen lds
  ds_read_b64_tr_b16 v[138:139], v226 offset:43008
  v_lshlrev_b32 v2, 16, v201
  s_waitcnt lgkmcnt(10)
  v_mfma_f32_16x16x32_bf16 v[32:35], v[112:115], a[80:83], v[32:35]
  ds_read_b64_tr_b16 v[140:141], v227 offset:40960
  v_mfma_f32_16x16x32_bf16 v[36:39], v[112:115], a[84:87], v[36:39]
  ds_read_b64_tr_b16 v[142:143], v227 offset:43008
  v_and_b32 v3, 0xffff0000, v201
  s_add_u32 s50, s98, 1310720
  s_add_u32 m0, s49, 98304
  v_mfma_f32_16x16x32_bf16 v[40:43], v[116:119], a[80:83], v[40:43]
  ds_read_b64_tr_b16 v[112:113], v224 offset:45056
  v_mfma_f32_16x16x32_bf16 v[44:47], v[116:119], a[84:87], v[44:47]
  buffer_load_dwordx4 v241, s[28:31], s50 offen lds
  ds_read_b64_tr_b16 v[114:115], v224 offset:47104
  v_lshlrev_b32 v4, 16, v202
  s_waitcnt lgkmcnt(10)
  v_mfma_f32_16x16x32_bf16 v[48:51], v[120:123], a[80:83], v[48:51]
  ds_read_b64_tr_b16 v[116:117], v225 offset:45056
  v_mfma_f32_16x16x32_bf16 v[52:55], v[120:123], a[84:87], v[52:55]
  ds_read_b64_tr_b16 v[118:119], v225 offset:47104
  v_and_b32 v5, 0xffff0000, v202
  s_cmp_eq_u32 s39, 4
  s_cselect_b32 s3, 3670016, 0
  s_sub_u32 s98, s98, s3
  s_sub_u32 s99, s99, s3
  s_add_u32 s50, s99, 1638400
  s_add_u32 m0, s49, 102400
  v_mfma_f32_16x16x32_bf16 v[56:59], v[124:127], a[80:83], v[56:59]
  ds_read_b64_tr_b16 v[120:121], v226 offset:45056
  v_mfma_f32_16x16x32_bf16 v[60:63], v[124:127], a[84:87], v[60:63]
  buffer_load_dwordx4 v241, s[28:31], s50 offen lds
  ds_read_b64_tr_b16 v[122:123], v226 offset:47104
  v_lshlrev_b32 v6, 16, v203
  s_waitcnt lgkmcnt(10)
  v_mfma_f32_16x16x32_bf16 v[32:35], v[128:131], a[88:91], v[32:35]
  ds_read_b64_tr_b16 v[124:125], v227 offset:45056
  v_mfma_f32_16x16x32_bf16 v[36:39], v[128:131], a[92:95], v[36:39]
  ds_read_b64_tr_b16 v[126:127], v227 offset:47104
  v_and_b32 v7, 0xffff0000, v203
  s_add_u32 s50, s99, 1703936
  s_add_u32 m0, s49, 106496
  v_mfma_f32_16x16x32_bf16 v[40:43], v[132:135], a[88:91], v[40:43]
  ds_read_b64_tr_b16 v[128:129], v224 offset:49152
  v_mfma_f32_16x16x32_bf16 v[44:47], v[132:135], a[92:95], v[44:47]
  buffer_load_dwordx4 v241, s[28:31], s50 offen lds
  ds_read_b64_tr_b16 v[130:131], v224 offset:51200
  v_lshlrev_b32 v8, 16, v204
  s_waitcnt lgkmcnt(10)
  v_mfma_f32_16x16x32_bf16 v[48:51], v[136:139], a[88:91], v[48:51]
  ds_read_b64_tr_b16 v[132:133], v225 offset:49152
  v_mfma_f32_16x16x32_bf16 v[52:55], v[136:139], a[92:95], v[52:55]
  ds_read_b64_tr_b16 v[134:135], v225 offset:51200
  v_and_b32 v9, 0xffff0000, v204
  s_add_u32 s50, s99, 1769472
  s_add_u32 m0, s49, 110592
  v_mfma_f32_16x16x32_bf16 v[56:59], v[140:143], a[88:91], v[56:59]
  ds_read_b64_tr_b16 v[136:137], v226 offset:49152
  v_mfma_f32_16x16x32_bf16 v[60:63], v[140:143], a[92:95], v[60:63]
  buffer_load_dwordx4 v241, s[28:31], s50 offen lds
  ds_read_b64_tr_b16 v[138:139], v226 offset:51200
  v_lshlrev_b32 v10, 16, v205
  s_waitcnt vmcnt(23) lgkmcnt(10)
  v_mfma_f32_16x16x32_bf16 v[32:35], v[112:115], a[96:99], v[32:35]
  ds_read_b64_tr_b16 v[140:141], v227 offset:49152
  v_mfma_f32_16x16x32_bf16 v[36:39], v[112:115], a[100:103], v[36:39]
  ds_read_b64_tr_b16 v[142:143], v227 offset:51200
  v_and_b32 v11, 0xffff0000, v205
  s_cmp_eq_u32 s39, 3
  s_cselect_b32 s3, 3670016, 0
  s_sub_u32 s98, s98, s3
  s_sub_u32 s99, s99, s3
  s_add_u32 s50, s98, 2097152
  s_add_u32 m0, s49, 114688
  v_mfma_f32_16x16x32_bf16 v[40:43], v[116:119], a[96:99], v[40:43]
  buffer_load_dwordx4 v241, s[28:31], s50 offen lds
  s_waitcnt vmcnt(14)
  s_barrier
  ds_read_b64_tr_b16 v[112:113], v224 offset:53248
  v_mfma_f32_16x16x32_bf16 v[44:47], v[116:119], a[100:103], v[44:47]
  ds_read_b64_tr_b16 v[114:115], v224 offset:55296
  v_lshlrev_b32 v12, 16, v206
  s_waitcnt lgkmcnt(10)
  v_mfma_f32_16x16x32_bf16 v[48:51], v[120:123], a[96:99], v[48:51]
  ds_read_b64_tr_b16 v[116:117], v225 offset:53248
  v_mfma_f32_16x16x32_bf16 v[52:55], v[120:123], a[100:103], v[52:55]
  ds_read_b64_tr_b16 v[118:119], v225 offset:55296
  v_and_b32 v13, 0xffff0000, v206
  s_add_u32 s50, s98, 2162688
  s_add_u32 m0, s49, 118784
  v_mfma_f32_16x16x32_bf16 v[56:59], v[124:127], a[96:99], v[56:59]
  ds_read_b64_tr_b16 v[120:121], v226 offset:53248
  v_mfma_f32_16x16x32_bf16 v[60:63], v[124:127], a[100:103], v[60:63]
  buffer_load_dwordx4 v241, s[28:31], s50 offen lds
  ds_read_b64_tr_b16 v[122:123], v226 offset:55296
  v_lshlrev_b32 v14, 16, v207
  s_waitcnt lgkmcnt(10)
  v_mfma_f32_16x16x32_bf16 v[32:35], v[128:131], a[104:107], v[32:35]
  ds_read_b64_tr_b16 v[124:125], v227 offset:53248
  v_mfma_f32_16x16x32_bf16 v[36:39], v[128:131], a[108:111], v[36:39]
  ds_read_b64_tr_b16 v[126:127], v227 offset:55296
  v_and_b32 v15, 0xffff0000, v207
  s_add_u32 s50, s98, 2228224
  s_add_u32 m0, s49, 122880
  v_mfma_f32_16x16x32_bf16 v[40:43], v[132:135], a[104:107], v[40:43]
  ds_read_b64_tr_b16 v[128:129], v224 offset:57344
  v_mfma_f32_16x16x32_bf16 v[44:47], v[132:135], a[108:111], v[44:47]
  buffer_load_dwordx4 v241, s[28:31], s50 offen lds
  ds_read_b64_tr_b16 v[130:131], v224 offset:59392
  v_lshlrev_b32 v16, 16, v208
  s_waitcnt lgkmcnt(10)
  v_mfma_f32_16x16x32_bf16 v[48:51], v[136:139], a[104:107], v[48:51]
  ds_read_b64_tr_b16 v[132:133], v225 offset:57344
  v_mfma_f32_16x16x32_bf16 v[52:55], v[136:139], a[108:111], v[52:55]
  ds_read_b64_tr_b16 v[134:135], v225 offset:59392
  v_and_b32 v17, 0xffff0000, v208
  s_cmp_eq_u32 s39, 2
  s_cselect_b32 s3, 3670016, 0
  s_sub_u32 s98, s98, s3
  s_sub_u32 s99, s99, s3
  s_add_u32 s50, s99, 2555904
  s_add_u32 m0, s49, 126976
  v_mfma_f32_16x16x32_bf16 v[56:59], v[140:143], a[104:107], v[56:59]
  ds_read_b64_tr_b16 v[136:137], v226 offset:57344
  v_mfma_f32_16x16x32_bf16 v[60:63], v[140:143], a[108:111], v[60:63]
  buffer_load_dwordx4 v241, s[28:31], s50 offen lds
  ds_read_b64_tr_b16 v[138:139], v226 offset:59392
  v_lshlrev_b32 v18, 16, v209
  s_waitcnt lgkmcnt(10)
  v_mfma_f32_16x16x32_bf16 v[32:35], v[112:115], a[112:115], v[32:35]
  ds_read_b64_tr_b16 v[140:141], v227 offset:57344
  v_mfma_f32_16x16x32_bf16 v[36:39], v[112:115], a[116:119], v[36:39]
  ds_read_b64_tr_b16 v[142:143], v227 offset:59392
  v_and_b32 v19, 0xffff0000, v209
  s_add_u32 s50, s99, 2621440
  s_add_u32 m0, s49, 0
  v_mfma_f32_16x16x32_bf16 v[40:43], v[116:119], a[112:115], v[40:43]
  ds_read_b64_tr_b16 v[112:113], v224 offset:61440
  v_mfma_f32_16x16x32_bf16 v[44:47], v[116:119], a[116:119], v[44:47]
  buffer_load_dwordx4 v241, s[28:31], s50 offen lds
  ds_read_b64_tr_b16 v[114:115], v224 offset:63488
  v_lshlrev_b32 v20, 16, v210
  s_waitcnt lgkmcnt(10)
  v_mfma_f32_16x16x32_bf16 v[48:51], v[120:123], a[112:115], v[48:51]
  ds_read_b64_tr_b16 v[116:117], v225 offset:61440
  v_mfma_f32_16x16x32_bf16 v[52:55], v[120:123], a[116:119], v[52:55]
  ds_read_b64_tr_b16 v[118:119], v225 offset:63488
  v_and_b32 v21, 0xffff0000, v210
  s_add_u32 s50, s99, 2686976
  s_add_u32 m0, s49, 4096
  v_mfma_f32_16x16x32_bf16 v[56:59], v[124:127], a[112:115], v[56:59]
  ds_read_b64_tr_b16 v[120:121], v226 offset:61440
  v_mfma_f32_16x16x32_bf16 v[60:63], v[124:127], a[116:119], v[60:63]
  buffer_load_dwordx4 v241, s[28:31], s50 offen lds
  ds_read_b64_tr_b16 v[122:123], v226 offset:63488
  v_lshlrev_b32 v22, 16, v211
  s_waitcnt lgkmcnt(10)
  v_mfma_f32_16x16x32_bf16 v[32:35], v[128:131], a[120:123], v[32:35]
  ds_read_b64_tr_b16 v[124:125], v227 offset:61440
  v_mfma_f32_16x16x32_bf16 v[36:39], v[128:131], a[124:127], v[36:39]
  ds_read_b64_tr_b16 v[126:127], v227 offset:63488
  v_and_b32 v23, 0xffff0000, v211
  s_cmp_eq_u32 s39, 1
  s_cselect_b32 s3, 3670016, 0
  s_sub_u32 s98, s98, s3
  s_sub_u32 s99, s99, s3
  s_add_u32 s50, s98, 3014656
  s_add_u32 m0, s49, 8192
  v_mfma_f32_16x16x32_bf16 v[40:43], v[132:135], a[120:123], v[40:43]
  ds_read_b64_tr_b16 v[128:129], v228 offset:0
  v_mfma_f32_16x16x32_bf16 v[44:47], v[132:135], a[124:127], v[44:47]
  buffer_load_dwordx4 v241, s[28:31], s50 offen lds
  ds_read_b64_tr_b16 v[130:131], v228 offset:2048
  v_lshlrev_b32 v24, 16, v212
  s_waitcnt lgkmcnt(10)
  v_mfma_f32_16x16x32_bf16 v[48:51], v[136:139], a[120:123], v[48:51]
  ds_read_b64_tr_b16 v[132:133], v229 offset:0
  v_mfma_f32_16x16x32_bf16 v[52:55], v[136:139], a[124:127], v[52:55]
  ds_read_b64_tr_b16 v[134:135], v229 offset:2048
  v_and_b32 v25, 0xffff0000, v212
  s_add_u32 s50, s98, 3080192
  s_add_u32 m0, s49, 12288
  v_mfma_f32_16x16x32_bf16 v[56:59], v[140:143], a[120:123], v[56:59]
  ds_read_b64_tr_b16 v[136:137], v230 offset:0
  v_mfma_f32_16x16x32_bf16 v[60:63], v[140:143], a[124:127], v[60:63]
  buffer_load_dwordx4 v241, s[28:31], s50 offen lds
  ds_read_b64_tr_b16 v[138:139], v230 offset:2048
  v_lshlrev_b32 v26, 16, v213
  s_waitcnt vmcnt(19) lgkmcnt(10)
  v_mfma_f32_16x16x32_bf16 v[32:35], v[112:115], a[128:131], v[32:35]
  ds_read_b64_tr_b16 v[140:141], v231 offset:0
  v_mfma_f32_16x16x32_bf16 v[36:39], v[112:115], a[132:135], v[36:39]
  ds_read_b64_tr_b16 v[142:143], v231 offset:2048
  v_and_b32 v27, 0xffff0000, v213
  s_add_u32 s50, s98, 3145728
  s_add_u32 m0, s49, 16384
  v_mfma_f32_16x16x32_bf16 v[40:43], v[116:119], a[128:131], v[40:43]
  buffer_load_dwordx4 v241, s[28:31], s50 offen lds
  s_waitcnt vmcnt(16)
  s_barrier
  ds_read_b64_tr_b16 v[112:113], v228 offset:4096
  v_mfma_f32_16x16x32_bf16 v[44:47], v[116:119], a[132:135], v[44:47]
  ds_read_b64_tr_b16 v[114:115], v228 offset:6144
  v_lshlrev_b32 v28, 16, v214
  s_waitcnt lgkmcnt(10)
  v_mfma_f32_16x16x32_bf16 v[48:51], v[120:123], a[128:131], v[48:51]
  ds_read_b64_tr_b16 v[116:117], v229 offset:4096
  v_mfma_f32_16x16x32_bf16 v[52:55], v[120:123], a[132:135], v[52:55]
  ds_read_b64_tr_b16 v[118:119], v229 offset:6144
  v_and_b32 v29, 0xffff0000, v214
  v_mfma_f32_16x16x32_bf16 v[56:59], v[124:127], a[128:131], v[56:59]
  ds_read_b64_tr_b16 v[120:121], v230 offset:4096
  v_mfma_f32_16x16x32_bf16 v[60:63], v[124:127], a[132:135], v[60:63]
  ds_read_b64_tr_b16 v[122:123], v230 offset:6144
  v_lshlrev_b32 v30, 16, v215
  s_waitcnt lgkmcnt(10)
  v_mfma_f32_16x16x32_bf16 v[64:67], v[128:131], a[224:227], v[64:67]
  ds_read_b64_tr_b16 v[124:125], v231 offset:4096
  v_mfma_f32_16x16x32_bf16 v[68:71], v[128:131], a[228:231], v[68:71]
  ds_read_b64_tr_b16 v[126:127], v231 offset:6144
  v_and_b32 v31, 0xffff0000, v215
  v_mfma_f32_16x16x32_bf16 v[72:75], v[132:135], a[224:227], v[72:75]
  ds_read_b64_tr_b16 v[128:129], v228 offset:8192
  v_mfma_f32_16x16x32_bf16 v[76:79], v[132:135], a[228:231], v[76:79]
  ds_read_b64_tr_b16 v[130:131], v228 offset:10240
  s_waitcnt lgkmcnt(10)
  v_mfma_f32_16x16x32_bf16 v[80:83], v[136:139], a[224:227], v[80:83]
  ds_read_b64_tr_b16 v[132:133], v229 offset:8192
  v_mfma_f32_16x16x32_bf16 v[84:87], v[136:139], a[228:231], v[84:87]
  ds_read_b64_tr_b16 v[134:135], v229 offset:10240
  v_mfma_f32_16x16x32_bf16 v[88:91], v[140:143], a[224:227], v[88:91]
  ds_read_b64_tr_b16 v[136:137], v230 offset:8192
  v_mfma_f32_16x16x32_bf16 v[92:95], v[140:143], a[228:231], v[92:95]
  ds_read_b64_tr_b16 v[138:139], v230 offset:10240
  s_waitcnt lgkmcnt(10)
  v_mfma_f32_16x16x32_bf16 v[64:67], v[112:115], a[232:235], v[64:67]
  ds_read_b64_tr_b16 v[140:141], v231 offset:8192
  v_mfma_f32_16x16x32_bf16 v[68:71], v[112:115], a[236:239], v[68:71]
  ds_read_b64_tr_b16 v[142:143], v231 offset:10240
  v_mfma_f32_16x16x32_bf16 v[72:75], v[116:119], a[232:235], v[72:75]
  ds_read_b64_tr_b16 v[112:113], v228 offset:12288
  v_mfma_f32_16x16x32_bf16 v[76:79], v[116:119], a[236:239], v[76:79]
  ds_read_b64_tr_b16 v[114:115], v228 offset:14336
  v_cvt_pk_bf16_f32 v32, v32, v33
  v_cvt_pk_bf16_f32 v33, v34, v35
  v_cvt_pk_bf16_f32 v34, v36, v37
  v_cvt_pk_bf16_f32 v35, v38, v39
  buffer_store_dwordx4 v[32:35], v251, s[32:35], s14 offen offset:0 sc1
  s_waitcnt lgkmcnt(10)
  v_mfma_f32_16x16x32_bf16 v[80:83], v[120:123], a[232:235], v[80:83]
  ds_read_b64_tr_b16 v[116:117], v229 offset:12288
  v_mfma_f32_16x16x32_bf16 v[84:87], v[120:123], a[236:239], v[84:87]
  ds_read_b64_tr_b16 v[118:119], v229 offset:14336
  v_mfma_f32_16x16x32_bf16 v[88:91], v[124:127], a[232:235], v[88:91]
  ds_read_b64_tr_b16 v[120:121], v230 offset:12288
  v_mfma_f32_16x16x32_bf16 v[92:95], v[124:127], a[236:239], v[92:95]
  ds_read_b64_tr_b16 v[122:123], v230 offset:14336
  s_waitcnt lgkmcnt(10)
  v_mfma_f32_16x16x32_bf16 v[64:67], v[128:131], a[240:243], v[64:67]
  ds_read_b64_tr_b16 v[124:125], v231 offset:12288
  v_mfma_f32_16x16x32_bf16 v[68:71], v[128:131], a[244:247], v[68:71]
  ds_read_b64_tr_b16 v[126:127], v231 offset:14336
  v_mfma_f32_16x16x32_bf16 v[72:75], v[132:135], a[240:243], v[72:75]
  ds_read_b64_tr_b16 v[128:129], v228 offset:16384
  v_mfma_f32_16x16x32_bf16 v[76:79], v[132:135], a[244:247], v[76:79]
  ds_read_b64_tr_b16 v[130:131], v228 offset:18432
  s_waitcnt lgkmcnt(10)
  v_mfma_f32_16x16x32_bf16 v[80:83], v[136:139], a[240:243], v[80:83]
  ds_read_b64_tr_b16 v[132:133], v229 offset:16384
  v_mfma_f32_16x16x32_bf16 v[84:87], v[136:139], a[244:247], v[84:87]
  ds_read_b64_tr_b16 v[134:135], v229 offset:18432
  v_mfma_f32_16x16x32_bf16 v[88:91], v[140:143], a[240:243], v[88:91]
  ds_read_b64_tr_b16 v[136:137], v230 offset:16384
  v_mfma_f32_16x16x32_bf16 v[92:95], v[140:143], a[244:247], v[92:95]
  ds_read_b64_tr_b16 v[138:139], v230 offset:18432
  v_cvt_pk_bf16_f32 v40, v40, v41
  v_cvt_pk_bf16_f32 v41, v42, v43
  v_cvt_pk_bf16_f32 v42, v44, v45
  v_cvt_pk_bf16_f32 v43, v46, v47
  buffer_store_dwordx4 v[40:43], v251, s[32:35], s14 offen offset:1024 sc1
  s_waitcnt lgkmcnt(10)
  v_mfma_f32_16x16x32_bf16 v[64:67], v[112:115], a[248:251], v[64:67]
  ds_read_b64_tr_b16 v[140:141], v231 offset:16384
  v_mfma_f32_16x16x32_bf16 v[68:71], v[112:115], a[252:255], v[68:71]
  ds_read_b64_tr_b16 v[142:143], v231 offset:18432
  v_mfma_f32_16x16x32_bf16 v[72:75], v[116:119], a[248:251], v[72:75]
  s_waitcnt vmcnt(14)
  s_barrier
  ds_read_b64_tr_b16 v[112:113], v228 offset:20480
  v_mfma_f32_16x16x32_bf16 v[76:79], v[116:119], a[252:255], v[76:79]
  ds_read_b64_tr_b16 v[114:115], v228 offset:22528
  s_waitcnt lgkmcnt(10)
  v_mfma_f32_16x16x32_bf16 v[80:83], v[120:123], a[248:251], v[80:83]
  ds_read_b64_tr_b16 v[116:117], v229 offset:20480
  v_mfma_f32_16x16x32_bf16 v[84:87], v[120:123], a[252:255], v[84:87]
  ds_read_b64_tr_b16 v[118:119], v229 offset:22528
  v_mfma_f32_16x16x32_bf16 v[88:91], v[124:127], a[248:251], v[88:91]
  ds_read_b64_tr_b16 v[120:121], v230 offset:20480
  v_mfma_f32_16x16x32_bf16 v[92:95], v[124:127], a[252:255], v[92:95]
  ds_read_b64_tr_b16 v[122:123], v230 offset:22528
  s_waitcnt lgkmcnt(10)
  v_mfma_f32_16x16x32_bf16 v[64:67], v[128:131], a[0:3], v[64:67]
  ds_read_b64_tr_b16 v[124:125], v231 offset:20480
  v_mfma_f32_16x16x32_bf16 v[68:71], v[128:131], a[4:7], v[68:71]
  ds_read_b64_tr_b16 v[126:127], v231 offset:22528
  v_mfma_f32_16x16x32_bf16 v[72:75], v[132:135], a[0:3], v[72:75]
  ds_read_b64_tr_b16 v[128:129], v228 offset:24576
  v_mfma_f32_16x16x32_bf16 v[76:79], v[132:135], a[4:7], v[76:79]
  ds_read_b64_tr_b16 v[130:131], v228 offset:26624
  v_cvt_pk_bf16_f32 v48, v48, v49
  v_cvt_pk_bf16_f32 v49, v50, v51
  v_cvt_pk_bf16_f32 v50, v52, v53
  v_cvt_pk_bf16_f32 v51, v54, v55
  buffer_store_dwordx4 v[48:51], v251, s[32:35], s14 offen offset:2048 sc1
  s_waitcnt lgkmcnt(10)
  v_mfma_f32_16x16x32_bf16 v[80:83], v[136:139], a[0:3], v[80:83]
  ds_read_b64_tr_b16 v[132:133], v229 offset:24576
  v_mfma_f32_16x16x32_bf16 v[84:87], v[136:139], a[4:7], v[84:87]
  ds_read_b64_tr_b16 v[134:135], v229 offset:26624
  v_mfma_f32_16x16x32_bf16 v[88:91], v[140:143], a[0:3], v[88:91]
  ds_read_b64_tr_b16 v[136:137], v230 offset:24576
  v_mfma_f32_16x16x32_bf16 v[92:95], v[140:143], a[4:7], v[92:95]
  ds_read_b64_tr_b16 v[138:139], v230 offset:26624
  s_waitcnt lgkmcnt(10)
  v_mfma_f32_16x16x32_bf16 v[64:67], v[112:115], a[8:11], v[64:67]
  ds_read_b64_tr_b16 v[140:141], v231 offset:24576
  v_mfma_f32_16x16x32_bf16 v[68:71], v[112:115], a[12:15], v[68:71]
  ds_read_b64_tr_b16 v[142:143], v231 offset:26624
  v_mfma_f32_16x16x32_bf16 v[72:75], v[116:119], a[8:11], v[72:75]
  ds_read_b64_tr_b16 v[112:113], v228 offset:28672
  v_mfma_f32_16x16x32_bf16 v[76:79], v[116:119], a[12:15], v[76:79]
  ds_read_b64_tr_b16 v[114:115], v228 offset:30720
  s_waitcnt lgkmcnt(10)
  v_mfma_f32_16x16x32_bf16 v[80:83], v[120:123], a[8:11], v[80:83]
  ds_read_b64_tr_b16 v[116:117], v229 offset:28672
  v_mfma_f32_16x16x32_bf16 v[84:87], v[120:123], a[12:15], v[84:87]
  ds_read_b64_tr_b16 v[118:119], v229 offset:30720
  v_mfma_f32_16x16x32_bf16 v[88:91], v[124:127], a[8:11], v[88:91]
  ds_read_b64_tr_b16 v[120:121], v230 offset:28672
  v_mfma_f32_16x16x32_bf16 v[92:95], v[124:127], a[12:15], v[92:95]
  ds_read_b64_tr_b16 v[122:123], v230 offset:30720
  v_cvt_pk_bf16_f32 v56, v56, v57
  v_cvt_pk_bf16_f32 v57, v58, v59
  v_cvt_pk_bf16_f32 v58, v60, v61
  v_cvt_pk_bf16_f32 v59, v62, v63
  buffer_store_dwordx4 v[56:59], v251, s[32:35], s14 offen offset:3072 sc1
  s_waitcnt lgkmcnt(10)
  v_mfma_f32_16x16x32_bf16 v[64:67], v[128:131], a[16:19], v[64:67]
  ds_read_b64_tr_b16 v[124:125], v231 offset:28672
  v_mfma_f32_16x16x32_bf16 v[68:71], v[128:131], a[20:23], v[68:71]
  ds_read_b64_tr_b16 v[126:127], v231 offset:30720
  v_mfma_f32_16x16x32_bf16 v[72:75], v[132:135], a[16:19], v[72:75]
  ds_read_b64_tr_b16 v[128:129], v228 offset:32768
  v_mfma_f32_16x16x32_bf16 v[76:79], v[132:135], a[20:23], v[76:79]
  ds_read_b64_tr_b16 v[130:131], v228 offset:34816
  s_waitcnt lgkmcnt(10)
  v_mfma_f32_16x16x32_bf16 v[80:83], v[136:139], a[16:19], v[80:83]
  ds_read_b64_tr_b16 v[132:133], v229 offset:32768
  v_mfma_f32_16x16x32_bf16 v[84:87], v[136:139], a[20:23], v[84:87]
  ds_read_b64_tr_b16 v[134:135], v229 offset:34816
  v_mfma_f32_16x16x32_bf16 v[88:91], v[140:143], a[16:19], v[88:91]
  ds_read_b64_tr_b16 v[136:137], v230 offset:32768
  v_mfma_f32_16x16x32_bf16 v[92:95], v[140:143], a[20:23], v[92:95]
  ds_read_b64_tr_b16 v[138:139], v230 offset:34816
  s_waitcnt lgkmcnt(10)
  v_mfma_f32_16x16x32_bf16 v[64:67], v[112:115], a[24:27], v[64:67]
  ds_read_b64_tr_b16 v[140:141], v231 offset:32768
  v_mfma_f32_16x16x32_bf16 v[68:71], v[112:115], a[28:31], v[68:71]
  ds_read_b64_tr_b16 v[142:143], v231 offset:34816
  v_mfma_f32_16x16x32_bf16 v[72:75], v[116:119], a[24:27], v[72:75]
  s_waitcnt vmcnt(12)
  s_barrier
  ds_read_b64_tr_b16 v[112:113], v228 offset:36864
  v_mfma_f32_16x16x32_bf16 v[76:79], v[116:119], a[28:31], v[76:79]
  ds_read_b64_tr_b16 v[114:115], v228 offset:38912
  s_waitcnt lgkmcnt(10)
  v_mfma_f32_16x16x32_bf16 v[80:83], v[120:123], a[24:27], v[80:83]
  ds_read_b64_tr_b16 v[116:117], v229 offset:36864
  v_mfma_f32_16x16x32_bf16 v[84:87], v[120:123], a[28:31], v[84:87]
  ds_read_b64_tr_b16 v[118:119], v229 offset:38912
  v_mfma_f32_16x16x32_bf16 v[88:91], v[124:127], a[24:27], v[88:91]
  ds_read_b64_tr_b16 v[120:121], v230 offset:36864
  v_mfma_f32_16x16x32_bf16 v[92:95], v[124:127], a[28:31], v[92:95]
  ds_read_b64_tr_b16 v[122:123], v230 offset:38912
  s_waitcnt lgkmcnt(10)
  v_mfma_f32_16x16x32_bf16 v[64:67], v[128:131], a[32:35], v[64:67]
  ds_read_b64_tr_b16 v[124:125], v231 offset:36864
  v_mfma_f32_16x16x32_bf16 v[68:71], v[128:131], a[36:39], v[68:71]
  ds_read_b64_tr_b16 v[126:127], v231 offset:38912
  v_mfma_f32_16x16x32_bf16 v[72:75], v[132:135], a[32:35], v[72:75]
  ds_read_b64_tr_b16 v[128:129], v228 offset:40960
  v_mfma_f32_16x16x32_bf16 v[76:79], v[132:135], a[36:39], v[76:79]
  ds_read_b64_tr_b16 v[130:131], v228 offset:43008
  s_waitcnt lgkmcnt(10)
  v_mfma_f32_16x16x32_bf16 v[80:83], v[136:139], a[32:35], v[80:83]
  ds_read_b64_tr_b16 v[132:133], v229 offset:40960
  v_mfma_f32_16x16x32_bf16 v[84:87], v[136:139], a[36:39], v[84:87]
  ds_read_b64_tr_b16 v[134:135], v229 offset:43008
  v_mfma_f32_16x16x32_bf16 v[88:91], v[140:143], a[32:35], v[88:91]
  ds_read_b64_tr_b16 v[136:137], v230 offset:40960
  v_mfma_f32_16x16x32_bf16 v[92:95], v[140:143], a[36:39], v[92:95]
  ds_read_b64_tr_b16 v[138:139], v230 offset:43008
  s_waitcnt lgkmcnt(10)
  v_mfma_f32_16x16x32_bf16 v[64:67], v[112:115], a[40:43], v[64:67]
  ds_read_b64_tr_b16 v[140:141], v231 offset:40960
  v_mfma_f32_16x16x32_bf16 v[68:71], v[112:115], a[44:47], v[68:71]
  ds_read_b64_tr_b16 v[142:143], v231 offset:43008
  v_mfma_f32_16x16x32_bf16 v[72:75], v[116:119], a[40:43], v[72:75]
  ds_read_b64_tr_b16 v[112:113], v228 offset:45056
  v_mfma_f32_16x16x32_bf16 v[76:79], v[116:119], a[44:47], v[76:79]
  ds_read_b64_tr_b16 v[114:115], v228 offset:47104
  s_waitcnt vmcnt(0)
  v_mov_b32 v96, s42
  v_mov_b32 v97, s43
  v_mov_b32 v98, 0
  v_mov_b32 v99, 0
  s_mov_b64 exec, 15
  buffer_store_dwordx4 v[96:99], v251, s[8:11], s52 offen sc1
  s_mov_b64 exec, -1
  s_waitcnt lgkmcnt(10)
  v_mfma_f32_16x16x32_bf16 v[80:83], v[120:123], a[40:43], v[80:83]
  ds_read_b64_tr_b16 v[116:117], v229 offset:45056
  v_mfma_f32_16x16x32_bf16 v[84:87], v[120:123], a[44:47], v[84:87]
  ds_read_b64_tr_b16 v[118:119], v229 offset:47104
  v_mfma_f32_16x16x32_bf16 v[88:91], v[124:127], a[40:43], v[88:91]
  ds_read_b64_tr_b16 v[120:121], v230 offset:45056
  v_mfma_f32_16x16x32_bf16 v[92:95], v[124:127], a[44:47], v[92:95]
  ds_read_b64_tr_b16 v[122:123], v230 offset:47104
  s_waitcnt lgkmcnt(10)
  v_mfma_f32_16x16x32_bf16 v[64:67], v[128:131], a[48:51], v[64:67]
  ds_read_b64_tr_b16 v[124:125], v231 offset:45056
  v_mfma_f32_16x16x32_bf16 v[68:71], v[128:131], a[52:55], v[68:71]
  ds_read_b64_tr_b16 v[126:127], v231 offset:47104
  v_mfma_f32_16x16x32_bf16 v[72:75], v[132:135], a[48:51], v[72:75]
  ds_read_b64_tr_b16 v[128:129], v228 offset:49152
  v_mfma_f32_16x16x32_bf16 v[76:79], v[132:135], a[52:55], v[76:79]
  ds_read_b64_tr_b16 v[130:131], v228 offset:51200
  s_waitcnt lgkmcnt(10)
  v_mfma_f32_16x16x32_bf16 v[80:83], v[136:139], a[48:51], v[80:83]
  ds_read_b64_tr_b16 v[132:133], v229 offset:49152
  v_mfma_f32_16x16x32_bf16 v[84:87], v[136:139], a[52:55], v[84:87]
  ds_read_b64_tr_b16 v[134:135], v229 offset:51200
  v_mfma_f32_16x16x32_bf16 v[88:91], v[140:143], a[48:51], v[88:91]
  ds_read_b64_tr_b16 v[136:137], v230 offset:49152
  v_mfma_f32_16x16x32_bf16 v[92:95], v[140:143], a[52:55], v[92:95]
  ds_read_b64_tr_b16 v[138:139], v230 offset:51200
  s_waitcnt lgkmcnt(10)
  v_mfma_f32_16x16x32_bf16 v[64:67], v[112:115], a[56:59], v[64:67]
  ds_read_b64_tr_b16 v[140:141], v231 offset:49152
  v_mfma_f32_16x16x32_bf16 v[68:71], v[112:115], a[60:63], v[68:71]
  ds_read_b64_tr_b16 v[142:143], v231 offset:51200
  v_mfma_f32_16x16x32_bf16 v[72:75], v[116:119], a[56:59], v[72:75]
  s_barrier
  ds_read_b64_tr_b16 v[112:113], v228 offset:53248
  v_mfma_f32_16x16x32_bf16 v[76:79], v[116:119], a[60:63], v[76:79]
  ds_read_b64_tr_b16 v[114:115], v228 offset:55296
  s_waitcnt lgkmcnt(10)
  v_mfma_f32_16x16x32_bf16 v[80:83], v[120:123], a[56:59], v[80:83]
  ds_read_b64_tr_b16 v[116:117], v229 offset:53248
  v_mfma_f32_16x16x32_bf16 v[84:87], v[120:123], a[60:63], v[84:87]
  ds_read_b64_tr_b16 v[118:119], v229 offset:55296
  v_mfma_f32_16x16x32_bf16 v[88:91], v[124:127], a[56:59], v[88:91]
  ds_read_b64_tr_b16 v[120:121], v230 offset:53248
  v_mfma_f32_16x16x32_bf16 v[92:95], v[124:127], a[60:63], v[92:95]
  ds_read_b64_tr_b16 v[122:123], v230 offset:55296
  s_waitcnt lgkmcnt(10)
  v_mfma_f32_16x16x32_bf16 v[64:67], v[128:131], a[64:67], v[64:67]
  ds_read_b64_tr_b16 v[124:125], v231 offset:53248
  v_mfma_f32_16x16x32_bf16 v[68:71], v[128:131], a[68:71], v[68:71]
  ds_read_b64_tr_b16 v[126:127], v231 offset:55296
  v_mfma_f32_16x16x32_bf16 v[72:75], v[132:135], a[64:67], v[72:75]
  ds_read_b64_tr_b16 v[128:129], v228 offset:57344
  v_mfma_f32_16x16x32_bf16 v[76:79], v[132:135], a[68:71], v[76:79]
  ds_read_b64_tr_b16 v[130:131], v228 offset:59392
  buffer_load_dwordx2 v[108:109], v100, s[8:11], s58 offen sc1
  s_waitcnt lgkmcnt(10)
  v_mfma_f32_16x16x32_bf16 v[80:83], v[136:139], a[64:67], v[80:83]
  ds_read_b64_tr_b16 v[132:133], v229 offset:57344
  v_mfma_f32_16x16x32_bf16 v[84:87], v[136:139], a[68:71], v[84:87]
  ds_read_b64_tr_b16 v[134:135], v229 offset:59392
  v_mfma_f32_16x16x32_bf16 v[88:91], v[140:143], a[64:67], v[88:91]
  ds_read_b64_tr_b16 v[136:137], v230 offset:57344
  v_mfma_f32_16x16x32_bf16 v[92:95], v[140:143], a[68:71], v[92:95]
  ds_read_b64_tr_b16 v[138:139], v230 offset:59392
  s_waitcnt lgkmcnt(10)
  v_mfma_f32_16x16x32_bf16 v[64:67], v[112:115], a[72:75], v[64:67]
  ds_read_b64_tr_b16 v[140:141], v231 offset:57344
  v_mfma_f32_16x16x32_bf16 v[68:71], v[112:115], a[76:79], v[68:71]
  ds_read_b64_tr_b16 v[142:143], v231 offset:59392
  v_mfma_f32_16x16x32_bf16 v[72:75], v[116:119], a[72:75], v[72:75]
  ds_read_b64_tr_b16 v[112:113], v228 offset:61440
  v_mfma_f32_16x16x32_bf16 v[76:79], v[116:119], a[76:79], v[76:79]
  ds_read_b64_tr_b16 v[114:115], v228 offset:63488
  s_waitcnt lgkmcnt(10)
  v_mfma_f32_16x16x32_bf16 v[80:83], v[120:123], a[72:75], v[80:83]
  ds_read_b64_tr_b16 v[116:117], v229 offset:61440
  v_mfma_f32_16x16x32_bf16 v[84:87], v[120:123], a[76:79], v[84:87]
  ds_read_b64_tr_b16 v[118:119], v229 offset:63488
  v_mfma_f32_16x16x32_bf16 v[88:91], v[124:127], a[72:75], v[88:91]
  ds_read_b64_tr_b16 v[120:121], v230 offset:61440
  v_mfma_f32_16x16x32_bf16 v[92:95], v[124:127], a[76:79], v[92:95]
  ds_read_b64_tr_b16 v[122:123], v230 offset:63488
  s_waitcnt lgkmcnt(10)
  v_mfma_f32_16x16x32_bf16 v[64:67], v[128:131], a[80:83], v[64:67]
  ds_read_b64_tr_b16 v[124:125], v231 offset:61440
  v_mfma_f32_16x16x32_bf16 v[68:71], v[128:131], a[84:87], v[68:71]
  ds_read_b64_tr_b16 v[126:127], v231 offset:63488
  v_mfma_f32_16x16x32_bf16 v[72:75], v[132:135], a[80:83], v[72:75]
  ds_read_b64_tr_b16 v[128:129], v224 offset:0
  v_mfma_f32_16x16x32_bf16 v[76:79], v[132:135], a[84:87], v[76:79]
  ds_read_b64_tr_b16 v[130:131], v224 offset:2048
  s_waitcnt lgkmcnt(10)
  v_mfma_f32_16x16x32_bf16 v[80:83], v[136:139], a[80:83], v[80:83]
  ds_read_b64_tr_b16 v[132:133], v225 offset:0
  v_mfma_f32_16x16x32_bf16 v[84:87], v[136:139], a[84:87], v[84:87]
  ds_read_b64_tr_b16 v[134:135], v225 offset:2048
  v_mfma_f32_16x16x32_bf16 v[88:91], v[140:143], a[80:83], v[88:91]
  ds_read_b64_tr_b16 v[136:137], v226 offset:0
  v_mfma_f32_16x16x32_bf16 v[92:95], v[140:143], a[84:87], v[92:95]
  ds_read_b64_tr_b16 v[138:139], v226 offset:2048
  s_waitcnt lgkmcnt(10)
  v_mfma_f32_16x16x32_bf16 v[64:67], v[112:115], a[88:91], v[64:67]
  ds_read_b64_tr_b16 v[140:141], v227 offset:0
  v_mfma_f32_16x16x32_bf16 v[68:71], v[112:115], a[92:95], v[68:71]
  ds_read_b64_tr_b16 v[142:143], v227 offset:2048
  v_mfma_f32_16x16x32_bf16 v[72:75], v[116:119], a[88:91], v[72:75]
  s_barrier
  ds_read_b64_tr_b16 v[112:113], v224 offset:4096
  v_mfma_f32_16x16x32_bf16 v[76:79], v[116:119], a[92:95], v[76:79]
  ds_read_b64_tr_b16 v[114:115], v224 offset:6144
  s_waitcnt lgkmcnt(10)
  v_mfma_f32_16x16x32_bf16 v[80:83], v[120:123], a[88:91], v[80:83]
  ds_read_b64_tr_b16 v[116:117], v225 offset:4096
  v_mfma_f32_16x16x32_bf16 v[84:87], v[120:123], a[92:95], v[84:87]
  ds_read_b64_tr_b16 v[118:119], v225 offset:6144
  v_mfma_f32_16x16x32_bf16 v[88:91], v[124:127], a[88:91], v[88:91]
  ds_read_b64_tr_b16 v[120:121], v226 offset:4096
  v_mfma_f32_16x16x32_bf16 v[92:95], v[124:127], a[92:95], v[92:95]
  ds_read_b64_tr_b16 v[122:123], v226 offset:6144
  s_waitcnt vmcnt(0)
  s_mov_b32 s47, 262144
sequential_preLN__spectral_fnet__dense_activation_squared_relu__prompt_kernel_poll23:
  v_cmp_ne_u64 vcc, s[42:43], v[108:109]
  s_sub_u32 s47, s47, 1
  s_cbranch_scc1 sequential_preLN__spectral_fnet__dense_activation_squared_relu__prompt_kernel_pok24
  s_cmp_eq_u64 vcc, 0
  s_cbranch_scc1 sequential_preLN__spectral_fnet__dense_activation_squared_relu__prompt_kernel_pok24
  s_sleep 1
  s_mov_b64 exec, vcc
  buffer_load_dwordx2 v[108:109], v100, s[8:11], s58 offen sc1
  s_mov_b64 exec, -1
  s_waitcnt vmcnt(0)
  s_branch sequential_preLN__spectral_fnet__dense_activation_squared_relu__prompt_kernel_poll23
sequential_preLN__spectral_fnet__dense_activation_squared_relu__prompt_kernel_pok24:
  buffer_load_dwordx4 v[200:203], v251, s[32:35], s15 offen offset:0 sc1
  buffer_load_dwordx4 v[204:207], v251, s[32:35], s15 offen offset:1024 sc1
  buffer_load_dwordx4 v[208:211], v251, s[32:35], s15 offen offset:2048 sc1
  buffer_load_dwordx4 v[212:215], v251, s[32:35], s15 offen offset:3072 sc1
  s_waitcnt lgkmcnt(10)
  v_mfma_f32_16x16x32_bf16 v[64:67], v[128:131], a[96:99], v[64:67]
  ds_read_b64_tr_b16 v[124:125], v227 offset:4096
  v_mfma_f32_16x16x32_bf16 v[68:71], v[128:131], a[100:103], v[68:71]
  ds_read_b64_tr_b16 v[126:127], v227 offset:6144
  v_mfma_f32_16x16x32_bf16 v[72:75], v[132:135], a[96:99], v[72:75]
  ds_read_b64_tr_b16 v[128:129], v224 offset:8192
  v_mfma_f32_16x16x32_bf16 v[76:79], v[132:135], a[100:103], v[76:79]
  ds_read_b64_tr_b16 v[130:131], v224 offset:10240
  s_waitcnt lgkmcnt(10)
  v_mfma_f32_16x16x32_bf16 v[80:83], v[136:139], a[96:99], v[80:83]
  ds_read_b64_tr_b16 v[132:133], v225 offset:8192
  v_mfma_f32_16x16x32_bf16 v[84:87], v[136:139], a[100:103], v[84:87]
  ds_read_b64_tr_b16 v[134:135], v225 offset:10240
  v_mfma_f32_16x16x32_bf16 v[88:91], v[140:143], a[96:99], v[88:91]
  ds_read_b64_tr_b16 v[136:137], v226 offset:8192
  v_mfma_f32_16x16x32_bf16 v[92:95], v[140:143], a[100:103], v[92:95]
  ds_read_b64_tr_b16 v[138:139], v226 offset:10240
  s_waitcnt lgkmcnt(10)
  v_mfma_f32_16x16x32_bf16 v[64:67], v[112:115], a[104:107], v[64:67]
  ds_read_b64_tr_b16 v[140:141], v227 offset:8192
  v_mfma_f32_16x16x32_bf16 v[68:71], v[112:115], a[108:111], v[68:71]
  ds_read_b64_tr_b16 v[142:143], v227 offset:10240
  v_mfma_f32_16x16x32_bf16 v[72:75], v[116:119], a[104:107], v[72:75]
  ds_read_b64_tr_b16 v[112:113], v224 offset:12288
  v_mfma_f32_16x16x32_bf16 v[76:79], v[116:119], a[108:111], v[76:79]
  ds_read_b64_tr_b16 v[114:115], v224 offset:14336
  s_waitcnt lgkmcnt(10)
  v_mfma_f32_16x16x32_bf16 v[80:83], v[120:123], a[104:107], v[80:83]
  ds_read_b64_tr_b16 v[116:117], v225 offset:12288
  v_mfma_f32_16x16x32_bf16 v[84:87], v[120:123], a[108:111], v[84:87]
  ds_read_b64_tr_b16 v[118:119], v225 offset:14336
  v_mfma_f32_16x16x32_bf16 v[88:91], v[124:127], a[104:107], v[88:91]
  ds_read_b64_tr_b16 v[120:121], v226 offset:12288
  v_mfma_f32_16x16x32_bf16 v[92:95], v[124:127], a[108:111], v[92:95]
  ds_read_b64_tr_b16 v[122:123], v226 offset:14336
  s_waitcnt lgkmcnt(10)
  v_mfma_f32_16x16x32_bf16 v[64:67], v[128:131], a[112:115], v[64:67]
  ds_read_b64_tr_b16 v[124:125], v227 offset:12288
  v_mfma_f32_16x16x32_bf16 v[68:71], v[128:131], a[116:119], v[68:71]
  ds_read_b64_tr_b16 v[126:127], v227 offset:14336
  v_mfma_f32_16x16x32_bf16 v[72:75], v[132:135], a[112:115], v[72:75]
  ds_read_b64_tr_b16 v[128:129], v224 offset:16384
  v_mfma_f32_16x16x32_bf16 v[76:79], v[132:135], a[116:119], v[76:79]
  ds_read_b64_tr_b16 v[130:131], v224 offset:18432
  s_waitcnt lgkmcnt(10)
  v_mfma_f32_16x16x32_bf16 v[80:83], v[136:139], a[112:115], v[80:83]
  ds_read_b64_tr_b16 v[132:133], v225 offset:16384
  v_mfma_f32_16x16x32_bf16 v[84:87], v[136:139], a[116:119], v[84:87]
  ds_read_b64_tr_b16 v[134:135], v225 offset:18432
  v_mfma_f32_16x16x32_bf16 v[88:91], v[140:143], a[112:115], v[88:91]
  ds_read_b64_tr_b16 v[136:137], v226 offset:16384
  v_mfma_f32_16x16x32_bf16 v[92:95], v[140:143], a[116:119], v[92:95]
  ds_read_b64_tr_b16 v[138:139], v226 offset:18432
  s_waitcnt lgkmcnt(10)
  v_mfma_f32_16x16x32_bf16 v[64:67], v[112:115], a[120:123], v[64:67]
  ds_read_b64_tr_b16 v[140:141], v227 offset:16384
  v_mfma_f32_16x16x32_bf16 v[68:71], v[112:115], a[124:127], v[68:71]
  ds_read_b64_tr_b16 v[142:143], v227 offset:18432
  v_mfma_f32_16x16x32_bf16 v[72:75], v[116:119], a[120:123], v[72:75]
  v_mfma_f32_16x16x32_bf16 v[76:79], v[116:119], a[124:127], v[76:79]
  s_waitcnt lgkmcnt(8)
  v_mfma_f32_16x16x32_bf16 v[80:83], v[120:123], a[120:123], v[80:83]
  v_mfma_f32_16x16x32_bf16 v[84:87], v[120:123], a[124:127], v[84:87]
  v_mfma_f32_16x16x32_bf16 v[88:91], v[124:127], a[120:123], v[88:91]
  v_mfma_f32_16x16x32_bf16 v[92:95], v[124:127], a[124:127], v[92:95]
  s_waitcnt lgkmcnt(4)
  v_mfma_f32_16x16x32_bf16 v[64:67], v[128:131], a[128:131], v[64:67]
  v_mfma_f32_16x16x32_bf16 v[68:71], v[128:131], a[132:135], v[68:71]
  v_mfma_f32_16x16x32_bf16 v[72:75], v[132:135], a[128:131], v[72:75]
  v_mfma_f32_16x16x32_bf16 v[76:79], v[132:135], a[132:135], v[76:79]
  s_waitcnt lgkmcnt(0)
  v_mfma_f32_16x16x32_bf16 v[80:83], v[136:139], a[128:131], v[80:83]
  v_mfma_f32_16x16x32_bf16 v[84:87], v[136:139], a[132:135], v[84:87]
  v_mfma_f32_16x16x32_bf16 v[88:91], v[140:143], a[128:131], v[88:91]
  v_mfma_f32_16x16x32_bf16 v[92:95], v[140:143], a[132:135], v[92:95]
  s_waitcnt vmcnt(0)
  s_nop 5
  v_lshlrev_b32 v32, 16, v200
  v_and_b32 v33, 0xffff0000, v200
  v_lshlrev_b32 v34, 16, v201
  v_and_b32 v35, 0xffff0000, v201
  v_pk_add_f32 v[64:65], v[64:65], v[32:33]
  v_pk_add_f32 v[66:67], v[66:67], v[34:35]
  v_pk_fma_f32 v[64:65], v[64:65], v[254:255], v[0:1] op_sel:[0,0,0] op_sel_hi:[1,0,1]
  v_pk_fma_f32 v[66:67], v[66:67], v[254:255], v[2:3] op_sel:[0,0,0] op_sel_hi:[1,0,1]
  v_cvt_pk_bf16_f32 v112, v64, v65
  v_cvt_pk_bf16_f32 v113, v66, v67
  v_lshlrev_b32 v40, 16, v204
  v_and_b32 v41, 0xffff0000, v204
  v_lshlrev_b32 v42, 16, v205
  v_and_b32 v43, 0xffff0000, v205
  v_pk_add_f32 v[72:73], v[72:73], v[40:41]
  v_pk_add_f32 v[74:75], v[74:75], v[42:43]
  v_pk_fma_f32 v[72:73], v[72:73], v[254:255], v[8:9] op_sel:[0,0,0] op_sel_hi:[1,0,1]
  v_pk_fma_f32 v[74:75], v[74:75], v[254:255], v[10:11] op_sel:[0,0,0] op_sel_hi:[1,0,1]
  v_cvt_pk_bf16_f32 v114, v72, v73
  v_cvt_pk_bf16_f32 v115, v74, v75
  s_nop 1
  v_permlane16_swap_b32 v112, v114
  v_permlane16_swap_b32 v113, v115
  buffer_store_dwordx4 v[112:115], v244, s[20:23], s12 offen offset:0
  v_lshlrev_b32 v36, 16, v202
  v_and_b32 v37, 0xffff0000, v202
  v_lshlrev_b32 v38, 16, v203
  v_and_b32 v39, 0xffff0000, v203
  v_pk_add_f32 v[68:69], v[68:69], v[36:37]
  v_pk_add_f32 v[70:71], v[70:71], v[38:39]
  v_pk_fma_f32 v[68:69], v[68:69], v[254:255], v[4:5] op_sel:[0,1,0] op_sel_hi:[1,1,1]
  v_pk_fma_f32 v[70:71], v[70:71], v[254:255], v[6:7] op_sel:[0,1,0] op_sel_hi:[1,1,1]
  v_cvt_pk_bf16_f32 v116, v68, v69
  v_cvt_pk_bf16_f32 v117, v70, v71
  v_lshlrev_b32 v44, 16, v206
  v_and_b32 v45, 0xffff0000, v206
  v_lshlrev_b32 v46, 16, v207
  v_and_b32 v47, 0xffff0000, v207
  v_pk_add_f32 v[76:77], v[76:77], v[44:45]
  v_pk_add_f32 v[78:79], v[78:79], v[46:47]
  v_pk_fma_f32 v[76:77], v[76:77], v[254:255], v[12:13] op_sel:[0,1,0] op_sel_hi:[1,1,1]
  v_pk_fma_f32 v[78:79], v[78:79], v[254:255], v[14:15] op_sel:[0,1,0] op_sel_hi:[1,1,1]
  v_cvt_pk_bf16_f32 v118, v76, v77
  v_cvt_pk_bf16_f32 v119, v78, v79
  s_nop 1
  v_permlane16_swap_b32 v116, v118
  v_permlane16_swap_b32 v117, v119
  buffer_store_dwordx4 v[116:119], v244, s[20:23], s13 offen offset:0
  v_lshlrev_b32 v48, 16, v208
  v_and_b32 v49, 0xffff0000, v208
  v_lshlrev_b32 v50, 16, v209
  v_and_b32 v51, 0xffff0000, v209
  v_pk_add_f32 v[80:81], v[80:81], v[48:49]
  v_pk_add_f32 v[82:83], v[82:83], v[50:51]
  v_pk_fma_f32 v[80:81], v[80:81], v[254:255], v[16:17] op_sel:[0,0,0] op_sel_hi:[1,0,1]
  v_pk_fma_f32 v[82:83], v[82:83], v[254:255], v[18:19] op_sel:[0,0,0] op_sel_hi:[1,0,1]
  v_cvt_pk_bf16_f32 v120, v80, v81
  v_cvt_pk_bf16_f32 v121, v82, v83
  v_lshlrev_b32 v56, 16, v212
  v_and_b32 v57, 0xffff0000, v212
  v_lshlrev_b32 v58, 16, v213
  v_and_b32 v59, 0xffff0000, v213
  v_pk_add_f32 v[88:89], v[88:89], v[56:57]
  v_pk_add_f32 v[90:91], v[90:91], v[58:59]
  v_pk_fma_f32 v[88:89], v[88:89], v[254:255], v[24:25] op_sel:[0,0,0] op_sel_hi:[1,0,1]
  v_pk_fma_f32 v[90:91], v[90:91], v[254:255], v[26:27] op_sel:[0,0,0] op_sel_hi:[1,0,1]
  v_cvt_pk_bf16_f32 v122, v88, v89
  v_cvt_pk_bf16_f32 v123, v90, v91
  s_nop 1
  v_permlane16_swap_b32 v120, v122
  v_permlane16_swap_b32 v121, v123
  buffer_store_dwordx4 v[120:123], v244, s[20:23], s12 offen offset:64
  v_lshlrev_b32 v52, 16, v210
  v_and_b32 v53, 0xffff0000, v210
  v_lshlrev_b32 v54, 16, v211
  v_and_b32 v55, 0xffff0000, v211
  v_pk_add_f32 v[84:85], v[84:85], v[52:53]
  v_pk_add_f32 v[86:87], v[86:87], v[54:55]
  v_pk_fma_f32 v[84:85], v[84:85], v[254:255], v[20:21] op_sel:[0,1,0] op_sel_hi:[1,1,1]
  v_pk_fma_f32 v[86:87], v[86:87], v[254:255], v[22:23] op_sel:[0,1,0] op_sel_hi:[1,1,1]
  v_cvt_pk_bf16_f32 v124, v84, v85
  v_cvt_pk_bf16_f32 v125, v86, v87
  v_lshlrev_b32 v60, 16, v214
  v_and_b32 v61, 0xffff0000, v214
  v_lshlrev_b32 v62, 16, v215
  v_and_b32 v63, 0xffff0000, v215
  v_pk_add_f32 v[92:93], v[92:93], v[60:61]
  v_pk_add_f32 v[94:95], v[94:95], v[62:63]
  v_pk_fma_f32 v[92:93], v[92:93], v[254:255], v[28:29] op_sel:[0,1,0] op_sel_hi:[1,1,1]
  v_pk_fma_f32 v[94:95], v[94:95], v[254:255], v[30:31] op_sel:[0,1,0] op_sel_hi:[1,1,1]
  v_cvt_pk_bf16_f32 v126, v92, v93
  v_cvt_pk_bf16_f32 v127, v94, v95
  s_nop 1
  v_permlane16_swap_b32 v124, v126
  v_permlane16_swap_b32 v125, v127
  buffer_store_dwordx4 v[124:127], v244, s[20:23], s13 offen offset:64
sequential_preLN__spectral_fnet__dense_activation_squared_relu__prompt_kernel_end:
  s_endpgm

.section .rodata,"a"
.p2align 6
.amdhsa_kernel sequential_preLN__spectral_fnet__dense_activation_squared_relu__prompt_kernel
  .amdhsa_next_free_vgpr 512
  .amdhsa_next_free_sgpr 102
  .amdhsa_accum_offset 256
  .amdhsa_group_segment_fixed_size 0
  .amdhsa_kernarg_size 104
  .amdhsa_user_sgpr_count 2
  .amdhsa_user_sgpr_kernarg_segment_ptr 1
  .amdhsa_system_sgpr_workgroup_id_x 1
  .amdhsa_float_denorm_mode_32 3
.end_amdhsa_kernel
```
